```python
import torch

def _softmax(x, axis=-1):
    return torch.softmax(x, dim=axis)
def _gelu(x):
    return torch.nn.functional.gelu(x, approximate="tanh")
def _silu(x):
    return torch.nn.functional.silu(x)
def _sigmoid(x):
    return torch.sigmoid(x)
def _layernorm(x, axis=-1, eps=1e-5):
    m = x.mean(dim=axis, keepdim=True)
    v = x.var(dim=axis, keepdim=True, unbiased=False)
    return (x - m) / torch.sqrt(v + eps)
def _scatter_add(tgt, idx, src, axis=0):
    return tgt.clone().index_add_(axis, idx, src)
def _segment_sum(src, seg, n):
    out = torch.zeros((n,) + src.shape[1:], dtype=src.dtype)
    return out.index_add_(0, seg, src)
def _pad(x, pw):
    flat = tuple(v for pair in reversed(pw) for v in pair)
    return torch.nn.functional.pad(x, flat)

kernel_name = 'recurrent_scan__sliding_block__glu_gated_glu__prompt'

def setup_inputs():

    _w = (lambda a: (lambda t: t.to(torch.bfloat16) if t.is_floating_point() else t)(torch.as_tensor(a)))
    def _A_setup():
        B, S, D = 1, 2048, 512
        return {
            "x": _w((lambda *s: torch.randn(*s, dtype=torch.bfloat16) * 0.05)(B, S, D)),
            "wqkv": _w((lambda *s: torch.randn(*s, dtype=torch.bfloat16) * 0.05)(D, 3 * D)),
            "wo": _w((lambda *s: torch.randn(*s, dtype=torch.bfloat16) * 0.05)(D, D)),
        }
    _A_in = _A_setup()

    def _B_setup():
        B, S, D, F = 1, 2048, 512, 1792
        return {
            "x": _w((lambda *s: torch.randn(*s, dtype=torch.bfloat16) * 0.05)(B, S, D)),
            "w_gate": _w((lambda *s: torch.randn(*s, dtype=torch.bfloat16) * 0.05)(D, F)),
            "w_up": _w((lambda *s: torch.randn(*s, dtype=torch.bfloat16) * 0.05)(D, F)),
            "w_down": _w((lambda *s: torch.randn(*s, dtype=torch.bfloat16) * 0.05)(F, D)),
        }
    _B_in = _B_setup()

    return {
        "A_x": _A_in["x"],
        "A_wqkv": _A_in["wqkv"],
        "A_wo": _A_in["wo"],
        "B_x": _B_in["x"],
        "B_w_gate": _B_in["w_gate"],
        "B_w_up": _B_in["w_up"],
        "B_w_down": _B_in["w_down"],
    }

def reference(A_x, A_wqkv, A_wo, B_x, B_w_gate, B_w_up, B_w_down):
    def _A_ref(x, wqkv, wo):
        B, S, D = x.shape
        H = 32; Dh = D // H; W = 256
        qkv = (lambda x, *d: x.permute(*d))((x @ wqkv).reshape(B, S, 3, H, Dh), 2, 0, 3, 1, 4)
        q, k, v = qkv[0], qkv[1], qkv[2]
        scores = torch.einsum("bhqd,bhkd->bhqk", q, k) * (Dh ** -0.5)
        idx = torch.arange(S)
        mask = (idx[:, None] - idx[None, :] >= 0) & (idx[:, None] - idx[None, :] < W)
        scores = torch.where(mask[None, None], scores, -1e9)
        p = _softmax(scores, axis=-1)
        o = torch.einsum("bhqk,bhkd->bhqd", p, v)
        return (lambda x, *d: x.permute(*d))(o, 0, 2, 1, 3).reshape(B, S, D) @ wo

    def _B_ref(x, w_gate, w_up, w_down):
        g = torch.einsum("bsd,df->bsf", x, w_gate)
        u = torch.einsum("bsd,df->bsf", x, w_up)
        h = _sigmoid(g) * u
        return torch.einsum("bsf,fd->bsd", h, w_down)

    x = A_x
    xn = _layernorm(x, axis=-1)
    s = _A_ref(xn, A_wqkv, A_wo)
    g = _silu(_B_ref(xn, B_w_gate, B_w_up, B_w_down))
    return x + s * g
```

```asm
; @launch grid=(256,1,1) block=(256,1,1) lds=163840
.amdgcn_target "amdgcn-amd-amdhsa--gfx950"
.text
.globl recurrent_scan__sliding_block__glu_gated_glu__prompt_kernel
.p2align 8
.type recurrent_scan__sliding_block__glu_gated_glu__prompt_kernel,@function
recurrent_scan__sliding_block__glu_gated_glu__prompt_kernel:
  s_cmp_ge_u32 s2, 256
  s_cbranch_scc1 L_exit
  s_load_dwordx16 s[4:19], s[0:1], 0
  s_load_dwordx4 s[20:23], s[0:1], 64
  v_lshrrev_b32 v1, 6, v0
  v_and_b32 v2, 63, v0
  s_lshr_b32 s92, s2, 3
  v_readfirstlane_b32 s52, v1
  s_bfe_u32 s58, s2, 0x10002
  s_and_b32 s59, s2, 3
  s_and_b32 s69, s92, 3
  s_lshl_b32 s53, s58, 2
  s_add_u32 s93, s53, s59
  s_add_u32 s53, s53, s69
  s_lshr_b32 s74, s92, 4
  s_bfe_u32 s70, s92, 0x20002
  s_lshl_b32 s54, s59, 2
  s_add_u32 s54, s54, s70
  s_lshl_b32 s55, s74, 4
  s_add_u32 s55, s55, s54
  s_add_u32 s77, s69, s70
  s_lshl_b32 s77, s77, 1
  s_xor_b32 s58, s58, s74
  s_add_u32 s77, s77, s58
  s_and_b32 s77, s77, 7
  s_mov_b32 s57, s77
  v_lshrrev_b32 v3, 3, v2
  v_and_b32 v4, 7, v2
  v_lshrrev_b32 v9, 1, v3
  v_xor_b32 v9, v9, v4
  v_lshlrev_b32 v9, 4, v9
  v_lshl_add_u32 v5, v3, 10, v9
  v_xor_b32 v6, 64, v5
  s_lshl_b32 s58, s57, 7
  v_add_u32 v7, s58, v5
  v_add_u32 v8, s58, v6
  s_lshl_b32 s58, s53, 3
  s_add_u32 s59, s58, s52
  s_lshl_b32 s60, s59, 15
  s_sub_u32 s59, s58, s52
  s_add_u32 s59, s59, 7
  s_lshl_b32 s64, s59, 15
  s_add_u32 s61, s60, 7168
  s_add_u32 s62, s60, 14336
  s_add_u32 s63, s60, 21504
  s_add_u32 s65, s64, 7168
  s_add_u32 s66, s64, 14336
  s_add_u32 s67, s64, 21504
  s_lshl_b32 s75, s52, 13
  s_lshl_b32 s58, s53, 7
  s_lshl_b32 s59, s55, 2
  s_add_u32 s58, s58, s59
  s_add_u32 s58, s58, s52
  s_lshl_b32 s59, s58, 11
  v_lshl_add_u32 v10, v2, 4, s59
  v_mov_b32 v11, 0
  s_mov_b32 s26, 0x200000
  s_mov_b32 s27, 0x20000
  s_mov_b32 s38, 17825792
  s_mov_b32 s39, 0x20000
  s_mov_b32 s31, 0x20000
  s_mov_b32 s35, 0x20000
  s_mov_b32 s34, 1835008
  s_lshl_b32 s80, s58, 4
  s_cmp_eq_u32 s74, 0
  s_waitcnt lgkmcnt(0)
  s_mov_b32 s24, s4
  s_mov_b32 s25, s5
  s_mov_b32 s36, s22
  s_mov_b32 s37, s23
  s_mov_b32 s32, s14
  s_mov_b32 s33, s15
  buffer_load_dword v12, v11, s[36:39], 0 offen sc1
  buffer_load_dwordx4 v[144:147], v10, s[24:27], 0 offen
  buffer_load_dwordx4 v[148:151], v10, s[24:27], 0 offen offset:1024
  s_cbranch_scc0 L_qrole
  s_mov_b32 s28, s12
  s_mov_b32 s29, s13
  s_mov_b32 s30, 1835008
  s_lshr_b32 s58, s54, 2
  s_mul_i32 s58, s58, 7
  s_and_b32 s59, s54, 3
  s_lshl_b32 s69, s59, 1
  s_add_u32 s78, s58, s69
  s_lshl_b32 s69, s78, 7
  s_mul_i32 s70, s52, 57344
  s_add_u32 s69, s69, s70
  v_bfe_u32 v9, v2, 4, 1
  v_lshlrev_b32 v9, 1, v9
  v_xor_b32 v9, v9, v4
  v_lshl_add_u32 v9, v9, 4, s69
  v_mul_u32_u24 v26, 3584, v3
  v_add_u32 v26, v26, v9
  v_xor_b32 v27, 64, v26
  s_mul_i32 s69, s57, 229376
  v_add_u32 v24, s69, v26
  v_add_u32 v25, s69, v27
  s_mov_b32 s68, 27648
  s_lshl_b32 s76, s52, 11
  s_add_u32 m0, s76, 81920
  s_nop 0
  buffer_load_dwordx4 v24, s[28:31], 0 offen offset:0 lds
  buffer_load_dwordx4 v24, s[28:31], s68 offen offset:1024 lds
  s_add_u32 m0, s76, 90112
  s_nop 0
  buffer_load_dwordx4 v25, s[32:35], 0 offen offset:0 lds
  buffer_load_dwordx4 v25, s[32:35], s68 offen offset:1024 lds
  s_add_u32 m0, s75, 49152
  s_nop 0
  buffer_load_dwordx4 v7, s[24:27], s60 offen offset:0 lds
  s_getpc_b64 s[100:101]
L_pc1:
  s_sub_u32 s100, s100, L_pc1-recurrent_scan__sliding_block__glu_gated_glu__prompt_kernel
  s_subb_u32 s101, s101, 0
  v_min_u32 v9, 23, v0
  s_mul_i32 s58, s92, 24
  v_add_u32 v9, s58, v9
  v_lshlrev_b32 v9, 7, v9
  v_min_u32 v9, L_codeend-recurrent_scan__sliding_block__glu_gated_glu__prompt_kernel-4, v9
  global_load_dword v159, v9, s[100:101]
  s_lshr_b32 s58, s54, 2
  s_mul_i32 s58, s58, 28
  s_and_b32 s59, s54, 1
  s_bfe_u32 s69, s54, 0x10001
  s_lshl_b32 s70, s59, 3
  s_add_u32 s79, s58, s70
  s_mul_i32 s70, s69, 10
  s_add_u32 s79, s79, s70
  s_add_u32 s79, s79, 4
  s_mul_i32 s70, s69, 14
  s_add_u32 s70, s70, s58
  s_add_u32 s70, s70, s59
  s_add_u32 s94, s70, 6
  s_lshl_b32 s78, s78, 2
  v_lshrrev_b32 v32, 2, v2
  v_mul_u32_u24 v32, 3584, v32
  v_and_b32 v33, 3, v2
  s_mul_i32 s58, s52, 57344
  s_lshl_b32 s59, s79, 5
  s_add_u32 s58, s58, s59
  v_lshl_add_u32 v33, v33, 4, s58
  v_add_u32 v28, v32, v33
  v_xor_b32 v33, 32, v33
  v_add_u32 v29, v32, v33
  s_and_b32 s58, s52, 1
  s_cselect_b32 s96, s14, s12
  s_cselect_b32 s97, s15, s13
  s_mov_b32 s98, 1835008
  s_mov_b32 s99, 0x20000
  s_lshl_b32 s59, s58, 2
  v_lshrrev_b32 v32, 1, v2
  v_xor_b32 v32, s59, v32
  v_mul_u32_u24 v32, 3584, v32
  s_lshr_b32 s59, s52, 1
  s_mul_i32 s69, s59, 114688
  s_lshl_b32 s70, s94, 5
  s_add_u32 s69, s69, s70
  v_and_b32 v33, 1, v2
  v_lshl_add_u32 v33, v33, 4, s69
  v_add_u32 v11, v32, v33
  s_lshl_b32 s59, s59, 11
  s_lshl_b32 s58, s58, 10
  s_add_u32 s82, s58, s59
  s_lshl_b32 s72, s93, 2
  s_and_b32 s58, s92, 3
  s_add_u32 s72, s72, s58
  s_lshr_b32 s73, s92, 2
  s_lshl_b32 s58, s58, 1
  s_add_u32 s58, s58, s73
  s_lshl_b32 s58, s58, 1
  s_lshr_b32 s59, s52, 1
  s_and_b32 s69, s52, 1
  v_mov_b32 v36, v2
  v_add_u32 v32, s58, v36
  v_and_b32 v32, 15, v32
  v_lshrrev_b32 v33, 2, v32
  v_mul_u32_u24 v33, 28, v33
  v_and_b32 v34, 3, v32
  v_lshl_add_u32 v3, v34, 3, v33
  v_add_u32 v3, s59, v3
  v_bfe_u32 v35, v36, 4, 1
  v_lshl_add_u32 v3, v35, 1, v3
  v_cmp_le_u32 vcc, 48, v36
  v_add_u32 v35, 8, v32
  v_and_b32 v35, 15, v35
  v_cndmask_b32 v35, v32, v35, vcc
  v_mov_b32 v34, s59
  v_cndmask_b32 v34, v34, 0, vcc
  v_lshrrev_b32 v33, 2, v35
  v_mul_u32_u24 v33, 28, v33
  v_add_u32 v34, v34, v33
  v_and_b32 v33, 1, v35
  v_lshl_add_u32 v34, v33, 3, v34
  v_bfe_u32 v33, v35, 1, 1
  v_mul_u32_u24 v33, 10, v33
  v_add3_u32 v34, v34, v33, 4
  v_cmp_le_u32 vcc, 32, v36
  s_nop 1
  v_cndmask_b32 v3, v3, v34, vcc
  v_lshrrev_b32 v33, 2, v35
  v_mul_u32_u24 v33, 28, v33
  v_and_b32 v34, 1, v35
  v_add3_u32 v34, v34, v33, 6
  v_bfe_u32 v33, v35, 1, 1
  v_mul_u32_u24 v33, 14, v33
  v_add_u32 v34, v34, v33
  v_cmp_le_u32 vcc, 56, v36
  s_nop 1
  v_cndmask_b32 v3, v3, v34, vcc
  v_add_u32 v33, 8, v32
  v_and_b32 v33, 15, v33
  v_lshlrev_b32 v33, 1, v33
  v_addc_co_u32 v33, vcc, 0, v33, vcc
  v_or_b32 v33, 0x1000, v33
  s_cmp_eq_u32 s59, 0
  s_cselect_b32 s70, 40, 0x100
  v_cmp_le_u32 vcc, s70, v36
  s_nop 1
  v_cndmask_b32 v3, v3, v33, vcc
  s_lshl_b32 s70, s72, 1
  s_add_u32 s70, s70, s69
  s_mul_i32 s71, s70, 112
  s_add_u32 s71, s71, 8192
  s_lshl_b32 s70, s70, 5
  s_add_u32 s70, s70, 1024
  v_cmp_le_u32 vcc, 0x1000, v3
  v_mov_b32 v32, s71
  v_mov_b32 v33, s70
  v_cndmask_b32 v32, v32, v33, vcc
  v_add_u32 v3, v3, v32
  v_lshlrev_b32 v3, 10, v3
  v_add_u32 v36, 64, v2
  v_add_u32 v32, s58, v36
  v_and_b32 v32, 15, v32
  v_lshrrev_b32 v33, 2, v32
  v_mul_u32_u24 v33, 28, v33
  v_and_b32 v34, 3, v32
  v_lshl_add_u32 v4, v34, 3, v33
  v_add_u32 v4, s59, v4
  v_bfe_u32 v35, v36, 4, 1
  v_lshl_add_u32 v4, v35, 1, v4
  v_cmp_le_u32 vcc, 48, v36
  v_add_u32 v35, 8, v32
  v_and_b32 v35, 15, v35
  v_cndmask_b32 v35, v32, v35, vcc
  v_mov_b32 v34, s59
  v_cndmask_b32 v34, v34, 0, vcc
  v_lshrrev_b32 v33, 2, v35
  v_mul_u32_u24 v33, 28, v33
  v_add_u32 v34, v34, v33
  v_and_b32 v33, 1, v35
  v_lshl_add_u32 v34, v33, 3, v34
  v_bfe_u32 v33, v35, 1, 1
  v_mul_u32_u24 v33, 10, v33
  v_add3_u32 v34, v34, v33, 4
  v_cmp_le_u32 vcc, 32, v36
  s_nop 1
  v_cndmask_b32 v4, v4, v34, vcc
  v_lshrrev_b32 v33, 2, v35
  v_mul_u32_u24 v33, 28, v33
  v_and_b32 v34, 1, v35
  v_add3_u32 v34, v34, v33, 6
  v_bfe_u32 v33, v35, 1, 1
  v_mul_u32_u24 v33, 14, v33
  v_add_u32 v34, v34, v33
  v_cmp_le_u32 vcc, 56, v36
  s_nop 1
  v_cndmask_b32 v4, v4, v34, vcc
  v_add_u32 v33, 8, v32
  v_and_b32 v33, 15, v33
  v_lshlrev_b32 v33, 1, v33
  v_addc_co_u32 v33, vcc, 0, v33, vcc
  v_or_b32 v33, 0x1000, v33
  s_cmp_eq_u32 s59, 0
  s_cselect_b32 s70, 40, 0x100
  v_cmp_le_u32 vcc, s70, v36
  s_nop 1
  v_cndmask_b32 v4, v4, v33, vcc
  s_lshl_b32 s70, s72, 1
  s_add_u32 s70, s70, s69
  s_mul_i32 s71, s70, 112
  s_add_u32 s71, s71, 8192
  s_lshl_b32 s70, s70, 5
  s_add_u32 s70, s70, 1024
  v_cmp_le_u32 vcc, 0x1000, v4
  v_mov_b32 v32, s71
  v_mov_b32 v33, s70
  v_cndmask_b32 v32, v32, v33, vcc
  v_add_u32 v4, v4, v32
  v_lshlrev_b32 v4, 10, v4
  v_lshl_add_u32 v36, v2, 1, s69
  v_add_u32 v32, s58, v36
  v_and_b32 v32, 15, v32
  v_lshrrev_b32 v33, 2, v32
  v_mul_u32_u24 v33, 28, v33
  v_and_b32 v34, 3, v32
  v_lshl_add_u32 v9, v34, 3, v33
  v_add_u32 v9, s59, v9
  v_bfe_u32 v35, v36, 4, 1
  v_lshl_add_u32 v9, v35, 1, v9
  v_cmp_le_u32 vcc, 48, v36
  v_add_u32 v35, 8, v32
  v_and_b32 v35, 15, v35
  v_cndmask_b32 v35, v32, v35, vcc
  v_mov_b32 v34, s59
  v_cndmask_b32 v34, v34, 0, vcc
  v_lshrrev_b32 v33, 2, v35
  v_mul_u32_u24 v33, 28, v33
  v_add_u32 v34, v34, v33
  v_and_b32 v33, 1, v35
  v_lshl_add_u32 v34, v33, 3, v34
  v_bfe_u32 v33, v35, 1, 1
  v_mul_u32_u24 v33, 10, v33
  v_add3_u32 v34, v34, v33, 4
  v_cmp_le_u32 vcc, 32, v36
  s_nop 1
  v_cndmask_b32 v9, v9, v34, vcc
  v_lshrrev_b32 v33, 2, v35
  v_mul_u32_u24 v33, 28, v33
  v_and_b32 v34, 1, v35
  v_add3_u32 v34, v34, v33, 6
  v_bfe_u32 v33, v35, 1, 1
  v_mul_u32_u24 v33, 14, v33
  v_add_u32 v34, v34, v33
  v_cmp_le_u32 vcc, 56, v36
  s_nop 1
  v_cndmask_b32 v9, v9, v34, vcc
  v_add_u32 v33, 8, v32
  v_and_b32 v33, 15, v33
  v_lshlrev_b32 v33, 1, v33
  v_addc_co_u32 v33, vcc, 0, v33, vcc
  v_or_b32 v33, 0x1000, v33
  s_cmp_eq_u32 s59, 0
  s_cselect_b32 s70, 40, 0x100
  v_cmp_le_u32 vcc, s70, v36
  s_nop 1
  v_cndmask_b32 v9, v9, v33, vcc
  v_and_b32 v9, 0xfff, v9
  v_lshlrev_b32 v9, 14, v9
  s_mov_b32 s40, s16
  s_mov_b32 s41, s17
  s_mov_b32 s42, 1835008
  s_mov_b32 s43, 0x20000
  s_cmp_eq_u32 s59, 0
  s_cselect_b32 s44, s8, s16
  s_cselect_b32 s45, s9, s17
  s_mov_b32 s46, 524288
  s_cselect_b32 s46, s46, s42
  s_mov_b32 s47, 0x20000
  s_mov_b32 s48, s18
  s_mov_b32 s49, s19
  s_mov_b32 s50, 0x200000
  s_mov_b32 s51, 0x20000
  v_and_b32 v32, 31, v2
  v_bfe_u32 v33, v2, 1, 3
  v_lshrrev_b32 v34, 5, v2
  v_xor_b32 v33, v33, v34
  s_add_u32 s58, s75, 49152
  v_lshl_add_u32 v32, v32, 7, s58
  v_xor_b32 v34, 0, v33
  v_lshl_add_u32 v16, v34, 4, v32
  v_xor_b32 v34, 2, v33
  v_lshl_add_u32 v17, v34, 4, v32
  v_xor_b32 v34, 4, v33
  v_lshl_add_u32 v18, v34, 4, v32
  v_xor_b32 v34, 6, v33
  v_lshl_add_u32 v19, v34, 4, v32
  v_bfe_u32 v32, v2, 4, 1
  v_bfe_u32 v33, v2, 2, 2
  v_lshrrev_b32 v34, 5, v2
  v_lshl_add_u32 v34, v34, 3, v33
  v_lshlrev_b32 v34, 7, v34
  v_lshl_add_u32 v34, v32, 13, v34
  v_and_b32 v35, 1, v2
  v_lshl_add_u32 v34, v35, 3, v34
  v_add_u32 v34, 81920, v34
  v_bfe_u32 v35, v2, 1, 1
  v_and_b32 v33, 2, v33
  v_or_b32 v35, v35, v33
  v_lshl_or_b32 v35, v32, 2, v35
  v_xor_b32 v36, 0, v35
  v_lshl_add_u32 v20, v36, 4, v34
  v_xor_b32 v36, 2, v35
  v_lshl_add_u32 v21, v36, 4, v34
  v_xor_b32 v36, 4, v35
  v_lshl_add_u32 v22, v36, 4, v34
  v_xor_b32 v36, 6, v35
  v_lshl_add_u32 v23, v36, 4, v34
  s_lshl_b32 s58, s52, 1
  v_xor_b32 v36, s58, v35
  v_lshl_add_u32 v15, v36, 4, v34
  v_mov_b32 v84, 0x3f803f80
  v_mov_b32 v85, 0x3f803f80
  v_mov_b32 v86, 0x3f803f80
  v_mov_b32 v87, 0x3f803f80
  v_and_b32 v36, 31, v2
  s_add_u32 s58, s78, s52
  s_lshl_b32 s58, s58, 10
  s_lshl_b32 s59, s53, 7
  s_add_u32 s59, s59, 32768
  s_add_u32 s58, s58, s59
  v_lshl_add_u32 v88, v36, 2, s58
  s_add_u32 s58, s79, s52
  s_cmp_lt_u32 s52, 2
  s_cselect_b32 s58, s58, s94
  s_lshl_b32 s58, s58, 10
  s_add_u32 s58, s58, s59
  s_cmp_eq_u32 s52, 3
  s_cselect_b32 s58, 1073741824, s58
  v_lshl_add_u32 v89, v36, 2, s58
  s_lshl_b32 s58, s53, 7
  s_add_u32 s58, s58, 4096
  v_lshl_add_u32 v36, v2, 2, s58
  s_lshl_b32 s58, s55, 2
  s_add_u32 s58, s58, 5120
  v_and_b32 v37, 7, v2
  v_lshl_add_u32 v37, v37, 7, s58
  v_cmp_gt_u32 vcc, 32, v2
  s_nop 1
  v_cndmask_b32 v90, v37, v36, vcc
  v_and_b32 v36, 31, v2
  s_lshr_b32 s58, s60, 7
  s_add_u32 s58, s58, 16384
  v_lshl_add_u32 v96, v36, 3, s58
  s_lshr_b32 s58, s64, 7
  s_add_u32 s58, s58, 16384
  v_lshl_add_u32 v97, v36, 3, s58
  v_bfe_u32 v33, v2, 2, 2
  v_lshrrev_b32 v34, 5, v2
  v_lshl_add_u32 v34, v34, 3, v33
  v_and_b32 v35, 3, v2
  v_lshlrev_b32 v35, 3, v35
  v_lshl_add_u32 v35, v32, 10, v35
  v_lshl_add_u32 v36, v34, 6, v35
  v_lshl_add_u32 v36, v32, 5, v36
  v_add_u32 v104, 147456, v36
  v_xor_b32 v105, 32, v104
  v_lshl_add_u32 v36, v34, 5, v35
  v_lshl_add_u32 v36, v32, 7, v36
  v_add_u32 v106, 155648, v36
  v_xor_b32 v107, 128, v106
  s_cmp_eq_u32 s52, 1
  s_cselect_b64 vcc, -1, 0
  v_cndmask_b32 v100, v104, v105, vcc
  v_add_u32 v101, 256, v100
  s_cmp_ge_u32 s52, 2
  s_cselect_b64 vcc, -1, 0
  v_cndmask_b32 v100, v100, v106, vcc
  v_cndmask_b32 v101, v101, v107, vcc
  v_lshrrev_b32 v32, 3, v2
  v_and_b32 v33, 7, v2
  v_bfe_u32 v122, v2, 4, 1
  v_lshlrev_b32 v122, 2, v122
  v_xor_b32 v122, v122, v33
  v_lshlrev_b32 v122, 4, v122
  v_lshl_add_u32 v122, v32, 10, v122
  s_lshl_b32 s58, s73, 7
  v_add_u32 v122, s58, v122
  v_add_u32 v123, 7168, v122
  v_lshlrev_b32 v126, 4, v2
  v_bfe_u32 v32, v2, 2, 2
  v_lshrrev_b32 v33, 5, v2
  v_lshl_add_u32 v32, v33, 2, v32
  v_lshlrev_b32 v124, 7, v32
  v_bfe_u32 v32, v2, 3, 1
  v_lshl_add_u32 v124, v32, 6, v124
  v_bfe_u32 v32, v2, 4, 1
  v_lshl_add_u32 v124, v32, 5, v124
  v_and_b32 v32, 3, v2
  v_lshl_add_u32 v124, v32, 3, v124
  s_lshr_b32 s58, s52, 1
  s_mul_i32 s58, s58, 4160
  v_xor_b32 v124, s58, v124
  v_xor_b32 v125, 64, v124
  v_and_b32 v32, 15, v2
  s_lshl_b32 s58, s93, 7
  v_lshl_add_u32 v127, v32, 2, s58
  s_lshl_b32 s81, s52, 11
  buffer_load_dwordx4 v8, s[24:27], s61 offen offset:1024 lds
  buffer_load_dwordx4 v7, s[24:27], s62 offen offset:2048 lds
  buffer_load_dwordx4 v8, s[24:27], s63 offen offset:3072 lds
  s_add_u32 m0, s75, 53248
  s_nop 0
  buffer_load_dwordx4 v7, s[24:27], s64 offen offset:0 lds
  buffer_load_dwordx4 v8, s[24:27], s65 offen offset:1024 lds
  buffer_load_dwordx4 v7, s[24:27], s66 offen offset:2048 lds
  buffer_load_dwordx4 v8, s[24:27], s67 offen offset:3072 lds
  s_add_u32 s57, s57, 1
  s_and_b32 s57, s57, 7
  s_lshl_b32 s58, s57, 7
  v_add_u32 v7, s58, v5
  v_add_u32 v8, s58, v6
  s_mul_i32 s58, s57, 229376
  v_add_u32 v24, s58, v26
  v_add_u32 v25, s58, v27
  s_waitcnt vmcnt(14)
  v_lshlrev_b32 v32, 16, v144
  v_and_b32 v33, 0xffff0000, v144
  v_lshlrev_b32 v34, 16, v145
  v_and_b32 v35, 0xffff0000, v145
  v_lshlrev_b32 v36, 16, v146
  v_and_b32 v37, 0xffff0000, v146
  v_lshlrev_b32 v38, 16, v147
  v_and_b32 v39, 0xffff0000, v147
  s_waitcnt vmcnt(13)
  v_lshlrev_b32 v40, 16, v148
  v_and_b32 v41, 0xffff0000, v148
  v_lshlrev_b32 v42, 16, v149
  v_and_b32 v43, 0xffff0000, v149
  v_lshlrev_b32 v44, 16, v150
  v_and_b32 v45, 0xffff0000, v150
  v_lshlrev_b32 v46, 16, v151
  v_and_b32 v47, 0xffff0000, v151
  v_add_f32 v48, v32, v33
  v_add_f32 v48, v48, v34
  v_add_f32 v48, v48, v35
  v_add_f32 v48, v48, v36
  v_add_f32 v48, v48, v37
  v_add_f32 v48, v48, v38
  v_add_f32 v48, v48, v39
  v_add_f32 v49, v40, v41
  v_add_f32 v49, v49, v42
  v_add_f32 v49, v49, v43
  v_add_f32 v49, v49, v44
  v_add_f32 v49, v49, v45
  v_add_f32 v49, v49, v46
  v_add_f32 v49, v49, v47
  v_add_f32_dpp v48, v48, v48 quad_perm:[1,0,3,2] row_mask:0xf bank_mask:0xf
  s_nop 0
  v_add_f32_dpp v49, v49, v49 quad_perm:[1,0,3,2] row_mask:0xf bank_mask:0xf
  v_add_f32_dpp v48, v48, v48 quad_perm:[2,3,0,1] row_mask:0xf bank_mask:0xf
  s_nop 0
  v_add_f32_dpp v49, v49, v49 quad_perm:[2,3,0,1] row_mask:0xf bank_mask:0xf
  v_add_f32_dpp v48, v48, v48 row_half_mirror row_mask:0xf bank_mask:0xf
  s_nop 0
  v_add_f32_dpp v49, v49, v49 row_half_mirror row_mask:0xf bank_mask:0xf
  v_add_f32_dpp v48, v48, v48 row_mirror row_mask:0xf bank_mask:0xf
  s_nop 0
  v_add_f32_dpp v49, v49, v49 row_mirror row_mask:0xf bank_mask:0xf
  v_mov_b32 v50, v48
  v_mov_b32 v51, v49
  s_nop 0
  v_permlane16_swap_b32 v48, v50
  v_permlane16_swap_b32 v49, v51
  v_add_f32 v48, v48, v50
  v_add_f32 v49, v49, v51
  v_mov_b32 v50, v48
  v_mov_b32 v51, v49
  s_nop 0
  v_permlane32_swap_b32 v48, v50
  v_permlane32_swap_b32 v49, v51
  v_add_f32 v48, v48, v50
  v_add_f32 v49, v49, v51
  v_mul_f32 v48, 0x3b000000, v48
  v_mul_f32 v49, 0x3b000000, v49
  v_sub_f32 v32, v32, v48
  v_sub_f32 v40, v40, v49
  v_sub_f32 v33, v33, v48
  v_sub_f32 v41, v41, v49
  v_sub_f32 v34, v34, v48
  v_sub_f32 v42, v42, v49
  v_sub_f32 v35, v35, v48
  v_sub_f32 v43, v43, v49
  v_sub_f32 v36, v36, v48
  v_sub_f32 v44, v44, v49
  v_sub_f32 v37, v37, v48
  v_sub_f32 v45, v45, v49
  v_sub_f32 v38, v38, v48
  v_sub_f32 v46, v46, v49
  v_sub_f32 v39, v39, v48
  v_sub_f32 v47, v47, v49
  v_mul_f32 v52, v32, v32
  v_mul_f32 v53, v40, v40
  v_fmac_f32 v52, v33, v33
  v_fmac_f32 v53, v41, v41
  v_fmac_f32 v52, v34, v34
  v_fmac_f32 v53, v42, v42
  v_fmac_f32 v52, v35, v35
  v_fmac_f32 v53, v43, v43
  v_fmac_f32 v52, v36, v36
  v_fmac_f32 v53, v44, v44
  v_fmac_f32 v52, v37, v37
  v_fmac_f32 v53, v45, v45
  v_fmac_f32 v52, v38, v38
  v_fmac_f32 v53, v46, v46
  v_fmac_f32 v52, v39, v39
  v_fmac_f32 v53, v47, v47
  s_nop 0
  v_add_f32_dpp v52, v52, v52 quad_perm:[1,0,3,2] row_mask:0xf bank_mask:0xf
  v_add_f32_dpp v53, v53, v53 quad_perm:[1,0,3,2] row_mask:0xf bank_mask:0xf
  s_nop 0
  v_add_f32_dpp v52, v52, v52 quad_perm:[2,3,0,1] row_mask:0xf bank_mask:0xf
  v_add_f32_dpp v53, v53, v53 quad_perm:[2,3,0,1] row_mask:0xf bank_mask:0xf
  s_nop 0
  v_add_f32_dpp v52, v52, v52 row_half_mirror row_mask:0xf bank_mask:0xf
  v_add_f32_dpp v53, v53, v53 row_half_mirror row_mask:0xf bank_mask:0xf
  s_nop 0
  v_add_f32_dpp v52, v52, v52 row_mirror row_mask:0xf bank_mask:0xf
  v_add_f32_dpp v53, v53, v53 row_mirror row_mask:0xf bank_mask:0xf
  v_mov_b32 v50, v52
  v_mov_b32 v51, v53
  s_nop 0
  v_permlane16_swap_b32 v52, v50
  v_permlane16_swap_b32 v53, v51
  v_add_f32 v52, v52, v50
  v_add_f32 v53, v53, v51
  v_mov_b32 v50, v52
  v_mov_b32 v51, v53
  s_nop 0
  v_permlane32_swap_b32 v52, v50
  v_permlane32_swap_b32 v53, v51
  v_add_f32 v52, v52, v50
  v_add_f32 v53, v53, v51
  v_mul_f32 v52, 0x3b000000, v52
  v_mul_f32 v53, 0x3b000000, v53
  v_cvt_pk_bf16_f32 v54, v52, v53
  v_cvt_pk_bf16_f32 v56, -v48, -v48
  v_cvt_pk_bf16_f32 v58, -v49, -v49
  v_lshlrev_b32 v52, 16, v54
  v_and_b32 v53, 0xffff0000, v54
  v_add_f32 v52, 0x3727c5ac, v52
  v_add_f32 v53, 0x3727c5ac, v53
  v_cvt_pk_bf16_f32 v54, v52, v53
  v_lshlrev_b32 v52, 16, v54
  v_and_b32 v53, 0xffff0000, v54
  v_sqrt_f32 v52, v52
  v_sqrt_f32 v53, v53
  v_cmp_eq_u32 vcc, 0, v2
  v_cvt_pk_bf16_f32 v54, v52, v53
  v_mov_b32 v50, 1073741824
  v_mov_b32 v51, s80
  v_lshlrev_b32 v57, 16, v54
  v_and_b32 v59, 0xffff0000, v54
  v_cndmask_b32 v50, v50, v51, vcc
  s_mov_b32 s71, 16384
  buffer_store_dwordx4 v[56:59], v50, s[36:39], s71 offen sc1
  v_readfirstlane_b32 s56, v12
  s_lshl_b32 s58, s53, 5
  s_add_u32 s58, s58, s55
  s_lshl_b32 s58, s58, 2
  s_mul_i32 s56, s56, 1664525
  s_add_u32 s56, s56, 1013904223
  v_cmp_eq_u32 vcc, 0, v0
  v_mov_b32 v14, 1073741824
  v_mov_b32 v13, s58
  v_cndmask_b32 v14, v14, v13, vcc
  v_mov_b32 v13, s56
  s_add_u32 m0, s76, 131072
  s_nop 0
  buffer_load_dwordx4 v24, s[28:31], 0 offen offset:0 lds
  buffer_load_dwordx4 v24, s[28:31], s68 offen offset:1024 lds
  s_add_u32 m0, s76, 139264
  s_nop 0
  buffer_load_dwordx4 v25, s[32:35], 0 offen offset:0 lds
  buffer_load_dwordx4 v25, s[32:35], s68 offen offset:1024 lds
  s_add_u32 m0, s75, 98304
  s_nop 0
  buffer_load_dwordx4 v7, s[24:27], s60 offen offset:0 lds
  buffer_load_dwordx4 v8, s[24:27], s61 offen offset:1024 lds
  s_mov_b32 s80, s94
  s_waitcnt vmcnt(6)
  s_barrier
  s_mov_b32 s71, 4096
  buffer_store_dword v13, v14, s[36:39], s71 offen sc1
  ds_read_b64_tr_b16 v[32:33], v20 offset:0
  ds_read_b64_tr_b16 v[34:35], v20 offset:512
  ds_read_b128 a[0:3], v16 offset:0
  ds_read_b64_tr_b16 v[36:37], v21 offset:0
  ds_read_b64_tr_b16 v[38:39], v21 offset:512
  ds_read_b128 a[4:7], v16 offset:4096
  ds_read_b64_tr_b16 v[40:41], v22 offset:0
  ds_read_b64_tr_b16 v[42:43], v22 offset:512
  ds_read_b64_tr_b16 v[44:45], v23 offset:0
  ds_read_b64_tr_b16 v[46:47], v23 offset:512
  ds_read_b64_tr_b16 v[80:81], v15 offset:0
  ds_read_b64_tr_b16 v[82:83], v15 offset:512
  s_waitcnt lgkmcnt(0)
  v_mfma_f32_32x32x16_bf16 v[64:79], v[84:87], v[80:83], 0
  ds_read_b64_tr_b16 v[48:49], v20 offset:2048
  ds_read_b64_tr_b16 v[50:51], v20 offset:2560
  ds_read_b128 a[8:11], v17 offset:0
  v_and_b32 v120, 31, v2
  v_lshlrev_b32 v120, 2, v120
  v_lshrrev_b32 v121, 5, v2
  v_mfma_f32_32x32x16_bf16 v[128:143], v[32:35], a[0:3], 0
  ds_read_b64_tr_b16 v[52:53], v21 offset:2048
  ds_read_b64_tr_b16 v[54:55], v21 offset:2560
  ds_read_b128 a[12:15], v17 offset:4096
  v_lshl_add_u32 v120, v121, 9, v120
  v_add_u32 v120, 159744, v120
  v_lshlrev_b32 v121, 4, v2
  v_mfma_f32_32x32x16_bf16 v[144:159], v[32:35], a[4:7], 0
  ds_read_b64_tr_b16 v[56:57], v22 offset:2048
  ds_read_b64_tr_b16 v[58:59], v22 offset:2560
  ds_read_b64_tr_b16 v[60:61], v23 offset:2048
  v_add_u32 v121, 32768, v121
  buffer_load_dwordx4 v7, s[24:27], s62 offen offset:2048 lds
  v_mfma_f32_32x32x16_bf16 v[160:175], v[36:39], a[0:3], 0
  ds_read_b64_tr_b16 v[62:63], v23 offset:2560
  ds_read_b64_tr_b16 v[80:81], v15 offset:2048
  ds_read_b64_tr_b16 v[82:83], v15 offset:2560
  buffer_load_dwordx4 v8, s[24:27], s63 offen offset:3072 lds
  v_mfma_f32_32x32x16_bf16 v[176:191], v[36:39], a[4:7], 0
  v_mfma_f32_32x32x16_bf16 v[192:207], v[40:43], a[0:3], 0
  s_add_u32 m0, s75, 102400
  s_nop 0
  buffer_load_dwordx4 v7, s[24:27], s64 offen offset:0 lds
  v_mfma_f32_32x32x16_bf16 v[208:223], v[40:43], a[4:7], 0
  v_mfma_f32_32x32x16_bf16 v[224:239], v[44:47], a[0:3], 0
  buffer_load_dwordx4 v8, s[24:27], s65 offen offset:1024 lds
  v_mfma_f32_32x32x16_bf16 v[240:255], v[44:47], a[4:7], 0
  s_waitcnt lgkmcnt(0)
  v_mfma_f32_32x32x16_bf16 v[64:79], v[84:87], v[80:83], v[64:79]
  ds_read_b64_tr_b16 v[32:33], v20 offset:4096
  ds_read_b64_tr_b16 v[34:35], v20 offset:4608
  ds_read_b128 a[16:19], v18 offset:0
  buffer_load_dwordx4 v7, s[24:27], s66 offen offset:2048 lds
  v_mfma_f32_32x32x16_bf16 v[128:143], v[48:51], a[8:11], v[128:143]
  ds_read_b64_tr_b16 v[36:37], v21 offset:4096
  ds_read_b64_tr_b16 v[38:39], v21 offset:4608
  ds_read_b128 a[20:23], v18 offset:4096
  v_mfma_f32_32x32x16_bf16 v[144:159], v[48:51], a[12:15], v[144:159]
  ds_read_b64_tr_b16 v[40:41], v22 offset:4096
  ds_read_b64_tr_b16 v[42:43], v22 offset:4608
  ds_read_b64_tr_b16 v[44:45], v23 offset:4096
  buffer_load_dwordx4 v8, s[24:27], s67 offen offset:3072 lds
  v_mfma_f32_32x32x16_bf16 v[160:175], v[52:55], a[8:11], v[160:175]
  ds_read_b64_tr_b16 v[46:47], v23 offset:4608
  ds_read_b64_tr_b16 v[80:81], v15 offset:4096
  ds_read_b64_tr_b16 v[82:83], v15 offset:4608
  s_add_u32 s57, s57, 1
  s_and_b32 s57, s57, 7
  v_mfma_f32_32x32x16_bf16 v[176:191], v[52:55], a[12:15], v[176:191]
  s_lshl_b32 s58, s57, 7
  v_add_u32 v7, s58, v5
  v_add_u32 v8, s58, v6
  s_mul_i32 s58, s57, 229376
  v_add_u32 v24, s58, v26
  v_add_u32 v25, s58, v27
  v_mfma_f32_32x32x16_bf16 v[192:207], v[56:59], a[8:11], v[192:207]
  s_add_u32 m0, s76, 32768
  s_nop 0
  buffer_load_dwordx4 v24, s[28:31], 0 offen offset:0 lds
  v_mfma_f32_32x32x16_bf16 v[208:223], v[56:59], a[12:15], v[208:223]
  buffer_load_dwordx4 v24, s[28:31], s68 offen offset:1024 lds
  v_mfma_f32_32x32x16_bf16 v[224:239], v[60:63], a[8:11], v[224:239]
  v_mfma_f32_32x32x16_bf16 v[240:255], v[60:63], a[12:15], v[240:255]
  s_add_u32 m0, s76, 40960
  s_nop 0
  buffer_load_dwordx4 v25, s[32:35], 0 offen offset:0 lds
  s_waitcnt lgkmcnt(0)
  v_mfma_f32_32x32x16_bf16 v[64:79], v[84:87], v[80:83], v[64:79]
  ds_read_b64_tr_b16 v[48:49], v20 offset:6144
  ds_read_b64_tr_b16 v[50:51], v20 offset:6656
  ds_read_b128 a[24:27], v19 offset:0
  v_mfma_f32_32x32x16_bf16 v[128:143], v[32:35], a[16:19], v[128:143]
  ds_read_b64_tr_b16 v[52:53], v21 offset:6144
  ds_read_b64_tr_b16 v[54:55], v21 offset:6656
  ds_read_b128 a[28:31], v19 offset:4096
  buffer_load_dwordx4 v25, s[32:35], s68 offen offset:1024 lds
  v_mfma_f32_32x32x16_bf16 v[144:159], v[32:35], a[20:23], v[144:159]
  ds_read_b64_tr_b16 v[56:57], v22 offset:6144
  ds_read_b64_tr_b16 v[58:59], v22 offset:6656
  ds_read_b64_tr_b16 v[60:61], v23 offset:6144
  v_mfma_f32_32x32x16_bf16 v[160:175], v[36:39], a[16:19], v[160:175]
  ds_read_b64_tr_b16 v[62:63], v23 offset:6656
  ds_read_b64_tr_b16 v[80:81], v15 offset:6144
  ds_read_b64_tr_b16 v[82:83], v15 offset:6656
  s_add_u32 m0, s75, 0
  s_nop 0
  buffer_load_dwordx4 v7, s[24:27], s60 offen offset:0 lds
  v_mfma_f32_32x32x16_bf16 v[176:191], v[36:39], a[20:23], v[176:191]
  v_add_u32 v16, 49152, v16
  v_add_u32 v17, 49152, v17
  v_add_u32 v18, 49152, v18
  v_mfma_f32_32x32x16_bf16 v[192:207], v[40:43], a[16:19], v[192:207]
  v_add_u32 v19, 49152, v19
  v_add_u32 v20, 49152, v20
  v_add_u32 v21, 49152, v21
  buffer_load_dwordx4 v8, s[24:27], s61 offen offset:1024 lds
  v_mfma_f32_32x32x16_bf16 v[208:223], v[40:43], a[20:23], v[208:223]
  v_add_u32 v22, 49152, v22
  v_add_u32 v23, 49152, v23
  v_mfma_f32_32x32x16_bf16 v[224:239], v[44:47], a[16:19], v[224:239]
  buffer_load_dwordx4 v7, s[24:27], s62 offen offset:2048 lds
  v_mfma_f32_32x32x16_bf16 v[240:255], v[44:47], a[20:23], v[240:255]
  s_waitcnt lgkmcnt(0)
  v_mfma_f32_32x32x16_bf16 v[64:79], v[84:87], v[80:83], v[64:79]
  s_waitcnt vmcnt(7) lgkmcnt(0)
  s_barrier
  ds_read_b64_tr_b16 v[32:33], v20 offset:0
  ds_read_b64_tr_b16 v[34:35], v20 offset:512
  v_mfma_f32_32x32x16_bf16 v[128:143], v[48:51], a[24:27], v[128:143]
  ds_read_b128 a[32:35], v16 offset:0
  ds_read_b64_tr_b16 v[36:37], v21 offset:0
  ds_read_b64_tr_b16 v[38:39], v21 offset:512
  buffer_load_dwordx4 v8, s[24:27], s63 offen offset:3072 lds
  v_mfma_f32_32x32x16_bf16 v[144:159], v[48:51], a[28:31], v[144:159]
  ds_read_b128 a[36:39], v16 offset:4096
  ds_read_b64_tr_b16 v[40:41], v22 offset:0
  ds_read_b64_tr_b16 v[42:43], v22 offset:512
  s_add_u32 m0, s75, 4096
  s_nop 0
  buffer_load_dwordx4 v7, s[24:27], s64 offen offset:0 lds
  v_mfma_f32_32x32x16_bf16 v[160:175], v[52:55], a[24:27], v[160:175]
  ds_read_b64_tr_b16 v[44:45], v23 offset:0
  ds_read_b64_tr_b16 v[46:47], v23 offset:512
  v_mfma_f32_32x32x16_bf16 v[176:191], v[52:55], a[28:31], v[176:191]
  buffer_load_dwordx4 v8, s[24:27], s65 offen offset:1024 lds
  v_mfma_f32_32x32x16_bf16 v[192:207], v[56:59], a[24:27], v[192:207]
  v_mfma_f32_32x32x16_bf16 v[208:223], v[56:59], a[28:31], v[208:223]
  buffer_load_dwordx4 v7, s[24:27], s66 offen offset:2048 lds
  v_mfma_f32_32x32x16_bf16 v[224:239], v[60:63], a[24:27], v[224:239]
  v_mfma_f32_32x32x16_bf16 v[240:255], v[60:63], a[28:31], v[240:255]
  buffer_load_dwordx4 v8, s[24:27], s67 offen offset:3072 lds
  s_add_u32 s57, s57, 1
  s_and_b32 s57, s57, 7
  s_waitcnt lgkmcnt(7)
  v_mfma_f32_32x32x16_bf16 v[128:143], v[32:35], a[32:35], v[128:143]
  ds_read_b64_tr_b16 v[48:49], v20 offset:2048
  ds_read_b64_tr_b16 v[50:51], v20 offset:2560
  ds_read_b128 a[40:43], v17 offset:0
  v_and_b32 v65, 0xffff0000, v64
  v_sub_f32 v64, v64, v65
  v_cvt_pk_bf16_f32 v65, v65, v64
  s_waitcnt lgkmcnt(7)
  v_mfma_f32_32x32x16_bf16 v[144:159], v[32:35], a[36:39], v[144:159]
  ds_read_b64_tr_b16 v[52:53], v21 offset:2048
  ds_read_b64_tr_b16 v[54:55], v21 offset:2560
  ds_read_b128 a[44:47], v17 offset:4096
  buffer_store_dword v65, v88, s[36:39], 0 offen sc1
  v_mfma_f32_32x32x16_bf16 v[160:175], v[36:39], a[32:35], v[160:175]
  ds_read_b64_tr_b16 v[56:57], v22 offset:2048
  ds_read_b64_tr_b16 v[58:59], v22 offset:2560
  ds_read_b64_tr_b16 v[60:61], v23 offset:2048
  s_lshl_b32 s58, s57, 7
  v_add_u32 v7, s58, v5
  v_add_u32 v8, s58, v6
  v_mfma_f32_32x32x16_bf16 v[176:191], v[36:39], a[36:39], v[176:191]
  ds_read_b64_tr_b16 v[62:63], v23 offset:2560
  s_mul_i32 s58, s57, 229376
  v_add_u32 v24, s58, v26
  v_add_u32 v25, s58, v27
  s_waitcnt lgkmcnt(12)
  v_mfma_f32_32x32x16_bf16 v[192:207], v[40:43], a[32:35], v[192:207]
  s_add_u32 s59, s77, 0
  s_and_b32 s59, s59, 7
  s_mul_i32 s59, s59, 229376
  v_mfma_f32_32x32x16_bf16 v[208:223], v[40:43], a[36:39], v[208:223]
  s_add_u32 m0, s76, 147456
  s_nop 0
  buffer_load_dwordx4 v28, s[28:31], s59 offen lds
  s_waitcnt lgkmcnt(10)
  v_mfma_f32_32x32x16_bf16 v[224:239], v[44:47], a[32:35], v[224:239]
  s_add_u32 m0, s76, 148480
  s_nop 0
  buffer_load_dwordx4 v29, s[32:35], s59 offen lds
  v_mfma_f32_32x32x16_bf16 v[240:255], v[44:47], a[36:39], v[240:255]
  s_waitcnt lgkmcnt(7)
  v_mfma_f32_32x32x16_bf16 v[128:143], v[48:51], a[40:43], v[128:143]
  ds_read_b64_tr_b16 v[32:33], v20 offset:4096
  ds_read_b64_tr_b16 v[34:35], v20 offset:4608
  ds_read_b128 a[48:51], v18 offset:0
  s_waitcnt lgkmcnt(7)
  v_mfma_f32_32x32x16_bf16 v[144:159], v[48:51], a[44:47], v[144:159]
  ds_read_b64_tr_b16 v[36:37], v21 offset:4096
  ds_read_b64_tr_b16 v[38:39], v21 offset:4608
  ds_read_b128 a[52:55], v18 offset:4096
  v_mfma_f32_32x32x16_bf16 v[160:175], v[52:55], a[40:43], v[160:175]
  ds_read_b64_tr_b16 v[40:41], v22 offset:4096
  ds_read_b64_tr_b16 v[42:43], v22 offset:4608
  ds_read_b64_tr_b16 v[44:45], v23 offset:4096
  v_mfma_f32_32x32x16_bf16 v[176:191], v[52:55], a[44:47], v[176:191]
  ds_read_b64_tr_b16 v[46:47], v23 offset:4608
  s_add_u32 m0, s82, 155648
  s_nop 0
  buffer_load_dwordx4 v11, s[96:99], s59 offen lds
  s_waitcnt lgkmcnt(12)
  v_mfma_f32_32x32x16_bf16 v[192:207], v[56:59], a[40:43], v[192:207]
  s_add_u32 m0, s76, 81920
  s_nop 0
  buffer_load_dwordx4 v24, s[28:31], 0 offen offset:0 lds
  v_mfma_f32_32x32x16_bf16 v[208:223], v[56:59], a[44:47], v[208:223]
  s_waitcnt lgkmcnt(10)
  v_mfma_f32_32x32x16_bf16 v[224:239], v[60:63], a[40:43], v[224:239]
  buffer_load_dwordx4 v24, s[28:31], s68 offen offset:1024 lds
  v_mfma_f32_32x32x16_bf16 v[240:255], v[60:63], a[44:47], v[240:255]
  s_waitcnt lgkmcnt(7)
  v_mfma_f32_32x32x16_bf16 v[128:143], v[32:35], a[48:51], v[128:143]
  ds_read_b64_tr_b16 v[48:49], v20 offset:6144
  ds_read_b64_tr_b16 v[50:51], v20 offset:6656
  ds_read_b128 a[56:59], v19 offset:0
  s_add_u32 m0, s76, 90112
  s_nop 0
  buffer_load_dwordx4 v25, s[32:35], 0 offen offset:0 lds
  s_waitcnt lgkmcnt(7)
  v_mfma_f32_32x32x16_bf16 v[144:159], v[32:35], a[52:55], v[144:159]
  ds_read_b64_tr_b16 v[52:53], v21 offset:6144
  ds_read_b64_tr_b16 v[54:55], v21 offset:6656
  ds_read_b128 a[60:63], v19 offset:4096
  v_mfma_f32_32x32x16_bf16 v[160:175], v[36:39], a[48:51], v[160:175]
  ds_read_b64_tr_b16 v[56:57], v22 offset:6144
  ds_read_b64_tr_b16 v[58:59], v22 offset:6656
  ds_read_b64_tr_b16 v[60:61], v23 offset:6144
  buffer_load_dwordx4 v25, s[32:35], s68 offen offset:1024 lds
  v_mfma_f32_32x32x16_bf16 v[176:191], v[36:39], a[52:55], v[176:191]
  ds_read_b64_tr_b16 v[62:63], v23 offset:6656
  v_add_u32 v16, 4294868992, v16
  v_add_u32 v17, 4294868992, v17
  s_waitcnt lgkmcnt(12)
  v_mfma_f32_32x32x16_bf16 v[192:207], v[40:43], a[48:51], v[192:207]
  v_add_u32 v18, 4294868992, v18
  v_add_u32 v19, 4294868992, v19
  v_add_u32 v20, 4294868992, v20
  s_add_u32 m0, s75, 49152
  s_nop 0
  buffer_load_dwordx4 v7, s[24:27], s60 offen offset:0 lds
  v_mfma_f32_32x32x16_bf16 v[208:223], v[40:43], a[52:55], v[208:223]
  v_add_u32 v21, 4294868992, v21
  v_add_u32 v22, 4294868992, v22
  v_add_u32 v23, 4294868992, v23
  s_waitcnt lgkmcnt(10)
  v_mfma_f32_32x32x16_bf16 v[224:239], v[44:47], a[48:51], v[224:239]
  buffer_load_dwordx4 v8, s[24:27], s61 offen offset:1024 lds
  v_mfma_f32_32x32x16_bf16 v[240:255], v[44:47], a[52:55], v[240:255]
  s_waitcnt lgkmcnt(7)
  v_mfma_f32_32x32x16_bf16 v[128:143], v[48:51], a[56:59], v[128:143]
  s_waitcnt vmcnt(10) lgkmcnt(0)
  s_barrier
  ds_read_b64_tr_b16 v[32:33], v20 offset:0
  ds_read_b64_tr_b16 v[34:35], v20 offset:512
  v_mfma_f32_32x32x16_bf16 v[144:159], v[48:51], a[60:63], v[144:159]
  ds_read_b128 a[64:67], v16 offset:0
  ds_read_b64_tr_b16 v[36:37], v21 offset:0
  ds_read_b64_tr_b16 v[38:39], v21 offset:512
  buffer_load_dwordx4 v7, s[24:27], s62 offen offset:2048 lds
  v_mfma_f32_32x32x16_bf16 v[160:175], v[52:55], a[56:59], v[160:175]
  ds_read_b128 a[68:71], v16 offset:4096
  ds_read_b64_tr_b16 v[40:41], v22 offset:0
  ds_read_b64_tr_b16 v[42:43], v22 offset:512
  buffer_load_dwordx4 v8, s[24:27], s63 offen offset:3072 lds
  v_mfma_f32_32x32x16_bf16 v[176:191], v[52:55], a[60:63], v[176:191]
  ds_read_b64_tr_b16 v[44:45], v23 offset:0
  ds_read_b64_tr_b16 v[46:47], v23 offset:512
  v_mfma_f32_32x32x16_bf16 v[192:207], v[56:59], a[56:59], v[192:207]
  s_add_u32 m0, s75, 53248
  s_nop 0
  buffer_load_dwordx4 v7, s[24:27], s64 offen offset:0 lds
  v_mfma_f32_32x32x16_bf16 v[208:223], v[56:59], a[60:63], v[208:223]
  v_mfma_f32_32x32x16_bf16 v[224:239], v[60:63], a[56:59], v[224:239]
  buffer_load_dwordx4 v8, s[24:27], s65 offen offset:1024 lds
  v_mfma_f32_32x32x16_bf16 v[240:255], v[60:63], a[60:63], v[240:255]
  s_waitcnt lgkmcnt(7)
  v_mfma_f32_32x32x16_bf16 v[128:143], v[32:35], a[64:67], v[128:143]
  ds_read_b64_tr_b16 v[48:49], v20 offset:2048
  ds_read_b64_tr_b16 v[50:51], v20 offset:2560
  ds_read_b128 a[72:75], v17 offset:0
  buffer_load_dwordx4 v7, s[24:27], s66 offen offset:2048 lds
  s_waitcnt lgkmcnt(7)
  v_mfma_f32_32x32x16_bf16 v[144:159], v[32:35], a[68:71], v[144:159]
  ds_read_b64_tr_b16 v[52:53], v21 offset:2048
  ds_read_b64_tr_b16 v[54:55], v21 offset:2560
  ds_read_b128 a[76:79], v17 offset:4096
  v_mfma_f32_32x32x16_bf16 v[160:175], v[36:39], a[64:67], v[160:175]
  ds_read_b64_tr_b16 v[56:57], v22 offset:2048
  ds_read_b64_tr_b16 v[58:59], v22 offset:2560
  ds_read_b64_tr_b16 v[60:61], v23 offset:2048
  buffer_load_dwordx4 v8, s[24:27], s67 offen offset:3072 lds
  v_mfma_f32_32x32x16_bf16 v[176:191], v[36:39], a[68:71], v[176:191]
  ds_read_b64_tr_b16 v[62:63], v23 offset:2560
  s_add_u32 s57, s57, 1
  s_and_b32 s57, s57, 7
  s_lshl_b32 s58, s57, 7
  v_add_u32 v7, s58, v5
  v_add_u32 v8, s58, v6
  s_waitcnt lgkmcnt(12)
  v_mfma_f32_32x32x16_bf16 v[192:207], v[40:43], a[64:67], v[192:207]
  s_mul_i32 s58, s57, 229376
  v_add_u32 v24, s58, v26
  v_add_u32 v25, s58, v27
  s_add_u32 m0, s76, 131072
  s_nop 0
  buffer_load_dwordx4 v24, s[28:31], 0 offen offset:0 lds
  v_mfma_f32_32x32x16_bf16 v[208:223], v[40:43], a[68:71], v[208:223]
  s_waitcnt lgkmcnt(10)
  v_mfma_f32_32x32x16_bf16 v[224:239], v[44:47], a[64:67], v[224:239]
  buffer_load_dwordx4 v24, s[28:31], s68 offen offset:1024 lds
  v_mfma_f32_32x32x16_bf16 v[240:255], v[44:47], a[68:71], v[240:255]
  s_waitcnt lgkmcnt(7)
  v_mfma_f32_32x32x16_bf16 v[128:143], v[48:51], a[72:75], v[128:143]
  ds_read_b64_tr_b16 v[32:33], v20 offset:4096
  ds_read_b64_tr_b16 v[34:35], v20 offset:4608
  ds_read_b128 a[80:83], v18 offset:0
  s_add_u32 m0, s76, 139264
  s_nop 0
  buffer_load_dwordx4 v25, s[32:35], 0 offen offset:0 lds
  s_waitcnt lgkmcnt(7)
  v_mfma_f32_32x32x16_bf16 v[144:159], v[48:51], a[76:79], v[144:159]
  ds_read_b64_tr_b16 v[36:37], v21 offset:4096
  ds_read_b64_tr_b16 v[38:39], v21 offset:4608
  ds_read_b128 a[84:87], v18 offset:4096
  v_mfma_f32_32x32x16_bf16 v[160:175], v[52:55], a[72:75], v[160:175]
  ds_read_b64_tr_b16 v[40:41], v22 offset:4096
  ds_read_b64_tr_b16 v[42:43], v22 offset:4608
  ds_read_b64_tr_b16 v[44:45], v23 offset:4096
  buffer_load_dwordx4 v25, s[32:35], s68 offen offset:1024 lds
  v_mfma_f32_32x32x16_bf16 v[176:191], v[52:55], a[76:79], v[176:191]
  ds_read_b64_tr_b16 v[46:47], v23 offset:4608
  s_waitcnt lgkmcnt(12)
  v_mfma_f32_32x32x16_bf16 v[192:207], v[56:59], a[72:75], v[192:207]
  s_add_u32 m0, s75, 98304
  s_nop 0
  buffer_load_dwordx4 v7, s[24:27], s60 offen offset:0 lds
  v_mfma_f32_32x32x16_bf16 v[208:223], v[56:59], a[76:79], v[208:223]
  s_waitcnt lgkmcnt(10)
  v_mfma_f32_32x32x16_bf16 v[224:239], v[60:63], a[72:75], v[224:239]
  buffer_load_dwordx4 v8, s[24:27], s61 offen offset:1024 lds
  v_mfma_f32_32x32x16_bf16 v[240:255], v[60:63], a[76:79], v[240:255]
  s_waitcnt lgkmcnt(7)
  v_mfma_f32_32x32x16_bf16 v[128:143], v[32:35], a[80:83], v[128:143]
  ds_read_b64_tr_b16 v[48:49], v20 offset:6144
  ds_read_b64_tr_b16 v[50:51], v20 offset:6656
  ds_read_b128 a[88:91], v19 offset:0
  buffer_load_dwordx4 v7, s[24:27], s62 offen offset:2048 lds
  s_waitcnt lgkmcnt(7)
  v_mfma_f32_32x32x16_bf16 v[144:159], v[32:35], a[84:87], v[144:159]
  ds_read_b64_tr_b16 v[52:53], v21 offset:6144
  ds_read_b64_tr_b16 v[54:55], v21 offset:6656
  ds_read_b128 a[92:95], v19 offset:4096
  v_mfma_f32_32x32x16_bf16 v[160:175], v[36:39], a[80:83], v[160:175]
  ds_read_b64_tr_b16 v[56:57], v22 offset:6144
  ds_read_b64_tr_b16 v[58:59], v22 offset:6656
  ds_read_b64_tr_b16 v[60:61], v23 offset:6144
  buffer_load_dwordx4 v8, s[24:27], s63 offen offset:3072 lds
  v_mfma_f32_32x32x16_bf16 v[176:191], v[36:39], a[84:87], v[176:191]
  ds_read_b64_tr_b16 v[62:63], v23 offset:6656
  v_add_u32 v16, 49152, v16
  v_add_u32 v17, 49152, v17
  s_waitcnt lgkmcnt(12)
  v_mfma_f32_32x32x16_bf16 v[192:207], v[40:43], a[80:83], v[192:207]
  v_add_u32 v18, 49152, v18
  v_add_u32 v19, 49152, v19
  v_add_u32 v20, 49152, v20
  s_add_u32 m0, s75, 102400
  s_nop 0
  buffer_load_dwordx4 v7, s[24:27], s64 offen offset:0 lds
  v_mfma_f32_32x32x16_bf16 v[208:223], v[40:43], a[84:87], v[208:223]
  v_add_u32 v21, 49152, v21
  v_add_u32 v22, 49152, v22
  v_add_u32 v23, 49152, v23
  s_waitcnt lgkmcnt(10)
  v_mfma_f32_32x32x16_bf16 v[224:239], v[44:47], a[80:83], v[224:239]
  buffer_load_dwordx4 v8, s[24:27], s65 offen offset:1024 lds
  v_mfma_f32_32x32x16_bf16 v[240:255], v[44:47], a[84:87], v[240:255]
  s_waitcnt lgkmcnt(7)
  v_mfma_f32_32x32x16_bf16 v[128:143], v[48:51], a[88:91], v[128:143]
  s_waitcnt vmcnt(10) lgkmcnt(0)
  s_barrier
  ds_read_b64_tr_b16 v[32:33], v20 offset:0
  ds_read_b64_tr_b16 v[34:35], v20 offset:512
  v_mfma_f32_32x32x16_bf16 v[144:159], v[48:51], a[92:95], v[144:159]
  ds_read_b128 a[96:99], v16 offset:0
  ds_read_b64_tr_b16 v[36:37], v21 offset:0
  ds_read_b64_tr_b16 v[38:39], v21 offset:512
  s_mov_b32 s71, 5120
  buffer_store_dword v13, v14, s[36:39], s71 offen sc1
  v_mfma_f32_32x32x16_bf16 v[160:175], v[52:55], a[88:91], v[160:175]
  ds_read_b128 a[100:103], v16 offset:4096
  ds_read_b64_tr_b16 v[40:41], v22 offset:0
  ds_read_b64_tr_b16 v[42:43], v22 offset:512
  buffer_load_dwordx4 v7, s[24:27], s66 offen offset:2048 lds
  v_mfma_f32_32x32x16_bf16 v[176:191], v[52:55], a[92:95], v[176:191]
  ds_read_b64_tr_b16 v[44:45], v23 offset:0
  ds_read_b64_tr_b16 v[46:47], v23 offset:512
  v_mfma_f32_32x32x16_bf16 v[192:207], v[56:59], a[88:91], v[192:207]
  buffer_load_dwordx4 v8, s[24:27], s67 offen offset:3072 lds
  s_add_u32 s57, s57, 1
  s_and_b32 s57, s57, 7
  v_mfma_f32_32x32x16_bf16 v[208:223], v[56:59], a[92:95], v[208:223]
  s_lshl_b32 s58, s57, 7
  v_add_u32 v7, s58, v5
  v_add_u32 v8, s58, v6
  s_mul_i32 s58, s57, 229376
  v_add_u32 v24, s58, v26
  v_add_u32 v25, s58, v27
  v_mfma_f32_32x32x16_bf16 v[224:239], v[60:63], a[88:91], v[224:239]
  s_add_u32 m0, s76, 32768
  s_nop 0
  buffer_load_dwordx4 v24, s[28:31], 0 offen offset:0 lds
  v_mfma_f32_32x32x16_bf16 v[240:255], v[60:63], a[92:95], v[240:255]
  s_waitcnt lgkmcnt(7)
  v_mfma_f32_32x32x16_bf16 v[128:143], v[32:35], a[96:99], v[128:143]
  ds_read_b64_tr_b16 v[48:49], v20 offset:2048
  ds_read_b64_tr_b16 v[50:51], v20 offset:2560
  ds_read_b128 a[104:107], v17 offset:0
  buffer_load_dwordx4 v24, s[28:31], s68 offen offset:1024 lds
  s_waitcnt lgkmcnt(7)
  v_mfma_f32_32x32x16_bf16 v[144:159], v[32:35], a[100:103], v[144:159]
  ds_read_b64_tr_b16 v[52:53], v21 offset:2048
  ds_read_b64_tr_b16 v[54:55], v21 offset:2560
  ds_read_b128 a[108:111], v17 offset:4096
  v_mfma_f32_32x32x16_bf16 v[160:175], v[36:39], a[96:99], v[160:175]
  ds_read_b64_tr_b16 v[56:57], v22 offset:2048
  ds_read_b64_tr_b16 v[58:59], v22 offset:2560
  ds_read_b64_tr_b16 v[60:61], v23 offset:2048
  s_add_u32 m0, s76, 40960
  s_nop 0
  buffer_load_dwordx4 v25, s[32:35], 0 offen offset:0 lds
  v_mfma_f32_32x32x16_bf16 v[176:191], v[36:39], a[100:103], v[176:191]
  ds_read_b64_tr_b16 v[62:63], v23 offset:2560
  s_waitcnt lgkmcnt(12)
  v_mfma_f32_32x32x16_bf16 v[192:207], v[40:43], a[96:99], v[192:207]
  buffer_load_dwordx4 v25, s[32:35], s68 offen offset:1024 lds
  v_mfma_f32_32x32x16_bf16 v[208:223], v[40:43], a[100:103], v[208:223]
  s_waitcnt lgkmcnt(10)
  v_mfma_f32_32x32x16_bf16 v[224:239], v[44:47], a[96:99], v[224:239]
  s_add_u32 m0, s75, 0
  s_nop 0
  buffer_load_dwordx4 v7, s[24:27], s60 offen offset:0 lds
  v_mfma_f32_32x32x16_bf16 v[240:255], v[44:47], a[100:103], v[240:255]
  s_waitcnt lgkmcnt(7)
  v_mfma_f32_32x32x16_bf16 v[128:143], v[48:51], a[104:107], v[128:143]
  ds_read_b64_tr_b16 v[32:33], v20 offset:4096
  ds_read_b64_tr_b16 v[34:35], v20 offset:4608
  ds_read_b128 a[112:115], v18 offset:0
  buffer_load_dwordx4 v8, s[24:27], s61 offen offset:1024 lds
  s_waitcnt lgkmcnt(7)
  v_mfma_f32_32x32x16_bf16 v[144:159], v[48:51], a[108:111], v[144:159]
  ds_read_b64_tr_b16 v[36:37], v21 offset:4096
  ds_read_b64_tr_b16 v[38:39], v21 offset:4608
  ds_read_b128 a[116:119], v18 offset:4096
  v_mfma_f32_32x32x16_bf16 v[160:175], v[52:55], a[104:107], v[160:175]
  ds_read_b64_tr_b16 v[40:41], v22 offset:4096
  ds_read_b64_tr_b16 v[42:43], v22 offset:4608
  ds_read_b64_tr_b16 v[44:45], v23 offset:4096
  buffer_load_dwordx4 v7, s[24:27], s62 offen offset:2048 lds
  v_mfma_f32_32x32x16_bf16 v[176:191], v[52:55], a[108:111], v[176:191]
  ds_read_b64_tr_b16 v[46:47], v23 offset:4608
  s_waitcnt lgkmcnt(12)
  v_mfma_f32_32x32x16_bf16 v[192:207], v[56:59], a[104:107], v[192:207]
  buffer_load_dwordx4 v8, s[24:27], s63 offen offset:3072 lds
  v_mfma_f32_32x32x16_bf16 v[208:223], v[56:59], a[108:111], v[208:223]
  s_waitcnt lgkmcnt(10)
  v_mfma_f32_32x32x16_bf16 v[224:239], v[60:63], a[104:107], v[224:239]
  s_add_u32 m0, s75, 4096
  s_nop 0
  buffer_load_dwordx4 v7, s[24:27], s64 offen offset:0 lds
  v_mfma_f32_32x32x16_bf16 v[240:255], v[60:63], a[108:111], v[240:255]
  s_waitcnt lgkmcnt(7)
  v_mfma_f32_32x32x16_bf16 v[128:143], v[32:35], a[112:115], v[128:143]
  ds_read_b64_tr_b16 v[48:49], v20 offset:6144
  ds_read_b64_tr_b16 v[50:51], v20 offset:6656
  ds_read_b128 a[120:123], v19 offset:0
  buffer_load_dwordx4 v8, s[24:27], s65 offen offset:1024 lds
  s_waitcnt lgkmcnt(7)
  v_mfma_f32_32x32x16_bf16 v[144:159], v[32:35], a[116:119], v[144:159]
  ds_read_b64_tr_b16 v[52:53], v21 offset:6144
  ds_read_b64_tr_b16 v[54:55], v21 offset:6656
  ds_read_b128 a[124:127], v19 offset:4096
  v_mfma_f32_32x32x16_bf16 v[160:175], v[36:39], a[112:115], v[160:175]
  ds_read_b64_tr_b16 v[56:57], v22 offset:6144
  ds_read_b64_tr_b16 v[58:59], v22 offset:6656
  ds_read_b64_tr_b16 v[60:61], v23 offset:6144
  buffer_load_dwordx4 v7, s[24:27], s66 offen offset:2048 lds
  v_mfma_f32_32x32x16_bf16 v[176:191], v[36:39], a[116:119], v[176:191]
  ds_read_b64_tr_b16 v[62:63], v23 offset:6656
  v_add_u32 v16, 49152, v16
  v_add_u32 v17, 49152, v17
  s_waitcnt lgkmcnt(12)
  v_mfma_f32_32x32x16_bf16 v[192:207], v[40:43], a[112:115], v[192:207]
  v_add_u32 v18, 49152, v18
  v_add_u32 v19, 49152, v19
  v_add_u32 v20, 49152, v20
  buffer_load_dwordx4 v8, s[24:27], s67 offen offset:3072 lds
  v_mfma_f32_32x32x16_bf16 v[208:223], v[40:43], a[116:119], v[208:223]
  v_add_u32 v21, 49152, v21
  v_add_u32 v22, 49152, v22
  v_add_u32 v23, 49152, v23
  s_add_u32 s57, s57, 1
  s_and_b32 s57, s57, 7
  s_waitcnt lgkmcnt(10)
  v_mfma_f32_32x32x16_bf16 v[224:239], v[44:47], a[112:115], v[224:239]
  s_lshl_b32 s58, s57, 7
  v_add_u32 v7, s58, v5
  v_add_u32 v8, s58, v6
  s_mul_i32 s58, s57, 229376
  v_add_u32 v24, s58, v26
  v_add_u32 v25, s58, v27
  v_mfma_f32_32x32x16_bf16 v[240:255], v[44:47], a[116:119], v[240:255]
  s_waitcnt lgkmcnt(7)
  v_mfma_f32_32x32x16_bf16 v[128:143], v[48:51], a[120:123], v[128:143]
  s_waitcnt vmcnt(12) lgkmcnt(0)
  s_barrier
  ds_read_b64_tr_b16 v[32:33], v20 offset:0
  ds_read_b64_tr_b16 v[34:35], v20 offset:512
  v_mfma_f32_32x32x16_bf16 v[144:159], v[48:51], a[124:127], v[144:159]
  ds_read_b128 a[128:131], v16 offset:0
  ds_read_b64_tr_b16 v[36:37], v21 offset:0
  ds_read_b64_tr_b16 v[38:39], v21 offset:512
  s_add_u32 m0, s76, 81920
  s_nop 0
  buffer_load_dwordx4 v24, s[28:31], 0 offen offset:0 lds
  v_mfma_f32_32x32x16_bf16 v[160:175], v[52:55], a[120:123], v[160:175]
  ds_read_b128 a[132:135], v16 offset:4096
  ds_read_b64_tr_b16 v[40:41], v22 offset:0
  ds_read_b64_tr_b16 v[42:43], v22 offset:512
  buffer_load_dwordx4 v24, s[28:31], s68 offen offset:1024 lds
  v_mfma_f32_32x32x16_bf16 v[176:191], v[52:55], a[124:127], v[176:191]
  ds_read_b64_tr_b16 v[44:45], v23 offset:0
  ds_read_b64_tr_b16 v[46:47], v23 offset:512
  s_cmp_lt_u32 s52, 2
  s_mov_b32 s69, 0
  s_cselect_b32 s69, 0, s69
  v_add_u32 v102, s69, v100
  v_add_u32 v103, s69, v101
  v_mfma_f32_32x32x16_bf16 v[192:207], v[56:59], a[120:123], v[192:207]
  ds_read_b64_tr_b16 v[80:81], v102
  ds_read_b64_tr_b16 v[82:83], v103
  s_add_u32 m0, s76, 90112
  s_nop 0
  buffer_load_dwordx4 v25, s[32:35], 0 offen offset:0 lds
  v_mfma_f32_32x32x16_bf16 v[208:223], v[56:59], a[124:127], v[208:223]
  v_mfma_f32_32x32x16_bf16 v[224:239], v[60:63], a[120:123], v[224:239]
  buffer_load_dwordx4 v25, s[32:35], s68 offen offset:1024 lds
  v_mfma_f32_32x32x16_bf16 v[240:255], v[60:63], a[124:127], v[240:255]
  s_waitcnt lgkmcnt(0)
  v_mfma_f32_32x32x16_bf16 v[64:79], v[84:87], v[80:83], 0
  ds_read_b64_tr_b16 v[48:49], v20 offset:2048
  ds_read_b64_tr_b16 v[50:51], v20 offset:2560
  ds_read_b128 a[136:139], v17 offset:0
  s_add_u32 m0, s75, 49152
  s_nop 0
  buffer_load_dwordx4 v7, s[24:27], s60 offen offset:0 lds
  v_mfma_f32_32x32x16_bf16 v[128:143], v[32:35], a[128:131], v[128:143]
  ds_read_b64_tr_b16 v[52:53], v21 offset:2048
  ds_read_b64_tr_b16 v[54:55], v21 offset:2560
  ds_read_b128 a[140:143], v17 offset:4096
  v_mfma_f32_32x32x16_bf16 v[144:159], v[32:35], a[132:135], v[144:159]
  ds_read_b64_tr_b16 v[56:57], v22 offset:2048
  ds_read_b64_tr_b16 v[58:59], v22 offset:2560
  ds_read_b64_tr_b16 v[60:61], v23 offset:2048
  buffer_load_dwordx4 v8, s[24:27], s61 offen offset:1024 lds
  v_mfma_f32_32x32x16_bf16 v[160:175], v[36:39], a[128:131], v[160:175]
  ds_read_b64_tr_b16 v[62:63], v23 offset:2560
  s_cmp_lt_u32 s52, 2
  s_mov_b32 s69, 512
  s_cselect_b32 s69, 2048, s69
  v_add_u32 v102, s69, v100
  v_add_u32 v103, s69, v101
  ds_read_b64_tr_b16 v[80:81], v102
  v_mfma_f32_32x32x16_bf16 v[176:191], v[36:39], a[132:135], v[176:191]
  ds_read_b64_tr_b16 v[82:83], v103
  buffer_load_dwordx4 v7, s[24:27], s62 offen offset:2048 lds
  v_mfma_f32_32x32x16_bf16 v[192:207], v[40:43], a[128:131], v[192:207]
  v_mfma_f32_32x32x16_bf16 v[208:223], v[40:43], a[132:135], v[208:223]
  buffer_load_dwordx4 v8, s[24:27], s63 offen offset:3072 lds
  v_mfma_f32_32x32x16_bf16 v[224:239], v[44:47], a[128:131], v[224:239]
  v_mfma_f32_32x32x16_bf16 v[240:255], v[44:47], a[132:135], v[240:255]
  s_add_u32 m0, s75, 53248
  s_nop 0
  buffer_load_dwordx4 v7, s[24:27], s64 offen offset:0 lds
  s_waitcnt lgkmcnt(0)
  v_mfma_f32_32x32x16_bf16 v[64:79], v[84:87], v[80:83], v[64:79]
  ds_read_b64_tr_b16 v[32:33], v20 offset:4096
  ds_read_b64_tr_b16 v[34:35], v20 offset:4608
  ds_read_b128 a[144:147], v18 offset:0
  v_mfma_f32_32x32x16_bf16 v[128:143], v[48:51], a[136:139], v[128:143]
  ds_read_b64_tr_b16 v[36:37], v21 offset:4096
  ds_read_b64_tr_b16 v[38:39], v21 offset:4608
  ds_read_b128 a[148:151], v18 offset:4096
  buffer_load_dwordx4 v8, s[24:27], s65 offen offset:1024 lds
  v_mfma_f32_32x32x16_bf16 v[144:159], v[48:51], a[140:143], v[144:159]
  ds_read_b64_tr_b16 v[40:41], v22 offset:4096
  ds_read_b64_tr_b16 v[42:43], v22 offset:4608
  ds_read_b64_tr_b16 v[44:45], v23 offset:4096
  v_mfma_f32_32x32x16_bf16 v[160:175], v[52:55], a[136:139], v[160:175]
  ds_read_b64_tr_b16 v[46:47], v23 offset:4608
  s_cmp_lt_u32 s52, 2
  s_mov_b32 s69, 2048
  s_cselect_b32 s69, 4096, s69
  v_add_u32 v102, s69, v100
  v_add_u32 v103, s69, v101
  ds_read_b64_tr_b16 v[80:81], v102
  v_mfma_f32_32x32x16_bf16 v[176:191], v[52:55], a[140:143], v[176:191]
  ds_read_b64_tr_b16 v[82:83], v103
  buffer_load_dwordx4 v7, s[24:27], s66 offen offset:2048 lds
  v_mfma_f32_32x32x16_bf16 v[192:207], v[56:59], a[136:139], v[192:207]
  buffer_load_dwordx4 v8, s[24:27], s67 offen offset:3072 lds
  s_add_u32 s57, s57, 1
  s_and_b32 s57, s57, 7
  v_mfma_f32_32x32x16_bf16 v[208:223], v[56:59], a[140:143], v[208:223]
  s_lshl_b32 s58, s57, 7
  v_add_u32 v7, s58, v5
  v_add_u32 v8, s58, v6
  s_mul_i32 s58, s57, 229376
  v_add_u32 v24, s58, v26
  v_add_u32 v25, s58, v27
  v_mfma_f32_32x32x16_bf16 v[224:239], v[60:63], a[136:139], v[224:239]
  v_mfma_f32_32x32x16_bf16 v[240:255], v[60:63], a[140:143], v[240:255]
  s_waitcnt lgkmcnt(0)
  v_mfma_f32_32x32x16_bf16 v[64:79], v[84:87], v[80:83], v[64:79]
  ds_read_b64_tr_b16 v[48:49], v20 offset:6144
  ds_read_b64_tr_b16 v[50:51], v20 offset:6656
  ds_read_b128 a[152:155], v19 offset:0
  v_mfma_f32_32x32x16_bf16 v[128:143], v[32:35], a[144:147], v[128:143]
  ds_read_b64_tr_b16 v[52:53], v21 offset:6144
  ds_read_b64_tr_b16 v[54:55], v21 offset:6656
  ds_read_b128 a[156:159], v19 offset:4096
  v_mfma_f32_32x32x16_bf16 v[144:159], v[32:35], a[148:151], v[144:159]
  ds_read_b64_tr_b16 v[56:57], v22 offset:6144
  ds_read_b64_tr_b16 v[58:59], v22 offset:6656
  ds_read_b64_tr_b16 v[60:61], v23 offset:6144
  v_mfma_f32_32x32x16_bf16 v[160:175], v[36:39], a[144:147], v[160:175]
  ds_read_b64_tr_b16 v[62:63], v23 offset:6656
  s_cmp_lt_u32 s52, 2
  s_mov_b32 s69, 2560
  s_cselect_b32 s69, 6144, s69
  v_add_u32 v102, s69, v100
  v_add_u32 v103, s69, v101
  ds_read_b64_tr_b16 v[80:81], v102
  v_mfma_f32_32x32x16_bf16 v[176:191], v[36:39], a[148:151], v[176:191]
  ds_read_b64_tr_b16 v[82:83], v103
  v_add_u32 v16, 4294868992, v16
  v_add_u32 v17, 4294868992, v17
  v_mfma_f32_32x32x16_bf16 v[192:207], v[40:43], a[144:147], v[192:207]
  v_add_u32 v18, 4294868992, v18
  v_add_u32 v19, 4294868992, v19
  v_add_u32 v20, 4294868992, v20
  v_mfma_f32_32x32x16_bf16 v[208:223], v[40:43], a[148:151], v[208:223]
  v_add_u32 v21, 4294868992, v21
  v_add_u32 v22, 4294868992, v22
  v_add_u32 v23, 4294868992, v23
  v_mfma_f32_32x32x16_bf16 v[224:239], v[44:47], a[144:147], v[224:239]
  v_mfma_f32_32x32x16_bf16 v[240:255], v[44:47], a[148:151], v[240:255]
  s_waitcnt lgkmcnt(0)
  v_mfma_f32_32x32x16_bf16 v[64:79], v[84:87], v[80:83], v[64:79]
  s_waitcnt vmcnt(12) lgkmcnt(0)
  s_barrier
  ds_read_b64_tr_b16 v[32:33], v20 offset:0
  ds_read_b64_tr_b16 v[34:35], v20 offset:512
  v_mfma_f32_32x32x16_bf16 v[128:143], v[48:51], a[152:155], v[128:143]
  ds_read_b128 a[160:163], v16 offset:0
  ds_read_b64_tr_b16 v[36:37], v21 offset:0
  ds_read_b64_tr_b16 v[38:39], v21 offset:512
  s_add_u32 m0, s76, 131072
  s_nop 0
  buffer_load_dwordx4 v24, s[28:31], 0 offen offset:0 lds
  v_mfma_f32_32x32x16_bf16 v[144:159], v[48:51], a[156:159], v[144:159]
  ds_read_b128 a[164:167], v16 offset:4096
  ds_read_b64_tr_b16 v[40:41], v22 offset:0
  ds_read_b64_tr_b16 v[42:43], v22 offset:512
  buffer_load_dwordx4 v24, s[28:31], s68 offen offset:1024 lds
  v_mfma_f32_32x32x16_bf16 v[160:175], v[52:55], a[152:155], v[160:175]
  ds_read_b64_tr_b16 v[44:45], v23 offset:0
  ds_read_b64_tr_b16 v[46:47], v23 offset:512
  v_mfma_f32_32x32x16_bf16 v[176:191], v[52:55], a[156:159], v[176:191]
  s_add_u32 m0, s76, 139264
  s_nop 0
  buffer_load_dwordx4 v25, s[32:35], 0 offen offset:0 lds
  v_mfma_f32_32x32x16_bf16 v[192:207], v[56:59], a[152:155], v[192:207]
  v_mfma_f32_32x32x16_bf16 v[208:223], v[56:59], a[156:159], v[208:223]
  buffer_load_dwordx4 v25, s[32:35], s68 offen offset:1024 lds
  v_mfma_f32_32x32x16_bf16 v[224:239], v[60:63], a[152:155], v[224:239]
  v_mfma_f32_32x32x16_bf16 v[240:255], v[60:63], a[156:159], v[240:255]
  s_add_u32 m0, s75, 98304
  s_nop 0
  buffer_load_dwordx4 v7, s[24:27], s60 offen offset:0 lds
  s_waitcnt lgkmcnt(7)
  v_mfma_f32_32x32x16_bf16 v[128:143], v[32:35], a[160:163], v[128:143]
  ds_read_b64_tr_b16 v[48:49], v20 offset:2048
  ds_read_b64_tr_b16 v[50:51], v20 offset:2560
  ds_read_b128 a[168:171], v17 offset:0
  v_and_b32 v65, 0xffff0000, v64
  v_sub_f32 v64, v64, v65
  v_cvt_pk_bf16_f32 v65, v65, v64
  s_waitcnt lgkmcnt(7)
  v_mfma_f32_32x32x16_bf16 v[144:159], v[32:35], a[164:167], v[144:159]
  ds_read_b64_tr_b16 v[52:53], v21 offset:2048
  ds_read_b64_tr_b16 v[54:55], v21 offset:2560
  ds_read_b128 a[172:175], v17 offset:4096
  buffer_store_dword v65, v89, s[36:39], 0 offen sc1
  v_mfma_f32_32x32x16_bf16 v[160:175], v[36:39], a[160:163], v[160:175]
  ds_read_b64_tr_b16 v[56:57], v22 offset:2048
  ds_read_b64_tr_b16 v[58:59], v22 offset:2560
  ds_read_b64_tr_b16 v[60:61], v23 offset:2048
  v_mfma_f32_32x32x16_bf16 v[176:191], v[36:39], a[164:167], v[176:191]
  ds_read_b64_tr_b16 v[62:63], v23 offset:2560
  buffer_load_dwordx4 v8, s[24:27], s61 offen offset:1024 lds
  s_waitcnt lgkmcnt(12)
  v_mfma_f32_32x32x16_bf16 v[192:207], v[40:43], a[160:163], v[192:207]
  v_mfma_f32_32x32x16_bf16 v[208:223], v[40:43], a[164:167], v[208:223]
  buffer_load_dwordx4 v7, s[24:27], s62 offen offset:2048 lds
  s_waitcnt lgkmcnt(10)
  v_mfma_f32_32x32x16_bf16 v[224:239], v[44:47], a[160:163], v[224:239]
  v_mfma_f32_32x32x16_bf16 v[240:255], v[44:47], a[164:167], v[240:255]
  buffer_load_dwordx4 v8, s[24:27], s63 offen offset:3072 lds
  s_waitcnt lgkmcnt(7)
  v_mfma_f32_32x32x16_bf16 v[128:143], v[48:51], a[168:171], v[128:143]
  ds_read_b64_tr_b16 v[32:33], v20 offset:4096
  ds_read_b64_tr_b16 v[34:35], v20 offset:4608
  ds_read_b128 a[176:179], v18 offset:0
  s_waitcnt lgkmcnt(7)
  v_mfma_f32_32x32x16_bf16 v[144:159], v[48:51], a[172:175], v[144:159]
  ds_read_b64_tr_b16 v[36:37], v21 offset:4096
  ds_read_b64_tr_b16 v[38:39], v21 offset:4608
  ds_read_b128 a[180:183], v18 offset:4096
  s_add_u32 m0, s75, 102400
  s_nop 0
  buffer_load_dwordx4 v7, s[24:27], s64 offen offset:0 lds
  v_mfma_f32_32x32x16_bf16 v[160:175], v[52:55], a[168:171], v[160:175]
  ds_read_b64_tr_b16 v[40:41], v22 offset:4096
  ds_read_b64_tr_b16 v[42:43], v22 offset:4608
  ds_read_b64_tr_b16 v[44:45], v23 offset:4096
  v_mfma_f32_32x32x16_bf16 v[176:191], v[52:55], a[172:175], v[176:191]
  ds_read_b64_tr_b16 v[46:47], v23 offset:4608
  buffer_load_dwordx4 v8, s[24:27], s65 offen offset:1024 lds
  s_waitcnt lgkmcnt(12)
  v_mfma_f32_32x32x16_bf16 v[192:207], v[56:59], a[168:171], v[192:207]
  v_mfma_f32_32x32x16_bf16 v[208:223], v[56:59], a[172:175], v[208:223]
  buffer_load_dwordx4 v7, s[24:27], s66 offen offset:2048 lds
  s_waitcnt lgkmcnt(10)
  v_mfma_f32_32x32x16_bf16 v[224:239], v[60:63], a[168:171], v[224:239]
  v_mfma_f32_32x32x16_bf16 v[240:255], v[60:63], a[172:175], v[240:255]
  buffer_load_dwordx4 v8, s[24:27], s67 offen offset:3072 lds
  s_add_u32 s57, s57, 1
  s_and_b32 s57, s57, 7
  s_waitcnt lgkmcnt(7)
  v_mfma_f32_32x32x16_bf16 v[128:143], v[32:35], a[176:179], v[128:143]
  ds_read_b64_tr_b16 v[48:49], v20 offset:6144
  ds_read_b64_tr_b16 v[50:51], v20 offset:6656
  ds_read_b128 a[184:187], v19 offset:0
  s_lshl_b32 s58, s57, 7
  v_add_u32 v7, s58, v5
  v_add_u32 v8, s58, v6
  s_waitcnt lgkmcnt(7)
  v_mfma_f32_32x32x16_bf16 v[144:159], v[32:35], a[180:183], v[144:159]
  ds_read_b64_tr_b16 v[52:53], v21 offset:6144
  ds_read_b64_tr_b16 v[54:55], v21 offset:6656
  ds_read_b128 a[188:191], v19 offset:4096
  s_mul_i32 s58, s57, 229376
  v_add_u32 v24, s58, v26
  v_add_u32 v25, s58, v27
  v_mfma_f32_32x32x16_bf16 v[160:175], v[36:39], a[176:179], v[160:175]
  ds_read_b64_tr_b16 v[56:57], v22 offset:6144
  ds_read_b64_tr_b16 v[58:59], v22 offset:6656
  ds_read_b64_tr_b16 v[60:61], v23 offset:6144
  v_mfma_f32_32x32x16_bf16 v[176:191], v[36:39], a[180:183], v[176:191]
  ds_read_b64_tr_b16 v[62:63], v23 offset:6656
  v_add_u32 v16, 49152, v16
  v_add_u32 v17, 49152, v17
  s_waitcnt lgkmcnt(12)
  v_mfma_f32_32x32x16_bf16 v[192:207], v[40:43], a[176:179], v[192:207]
  v_add_u32 v18, 49152, v18
  v_add_u32 v19, 49152, v19
  v_add_u32 v20, 49152, v20
  v_mfma_f32_32x32x16_bf16 v[208:223], v[40:43], a[180:183], v[208:223]
  v_add_u32 v21, 49152, v21
  v_add_u32 v22, 49152, v22
  v_add_u32 v23, 49152, v23
  s_waitcnt lgkmcnt(10)
  v_mfma_f32_32x32x16_bf16 v[224:239], v[44:47], a[176:179], v[224:239]
  v_mfma_f32_32x32x16_bf16 v[240:255], v[44:47], a[180:183], v[240:255]
  s_waitcnt lgkmcnt(7)
  v_mfma_f32_32x32x16_bf16 v[128:143], v[48:51], a[184:187], v[128:143]
  s_waitcnt vmcnt(13) lgkmcnt(0)
  s_barrier
  ds_read_b64_tr_b16 v[32:33], v20 offset:0
  ds_read_b64_tr_b16 v[34:35], v20 offset:512
  buffer_load_dword v91, v90, s[36:39], 0 offen sc1
  v_mfma_f32_32x32x16_bf16 v[144:159], v[48:51], a[188:191], v[144:159]
  ds_read_b128 a[192:195], v16 offset:0
  ds_read_b64_tr_b16 v[36:37], v21 offset:0
  ds_read_b64_tr_b16 v[38:39], v21 offset:512
  v_mfma_f32_32x32x16_bf16 v[160:175], v[52:55], a[184:187], v[160:175]
  ds_read_b128 a[196:199], v16 offset:4096
  ds_read_b64_tr_b16 v[40:41], v22 offset:0
  ds_read_b64_tr_b16 v[42:43], v22 offset:512
  v_mfma_f32_32x32x16_bf16 v[176:191], v[52:55], a[188:191], v[176:191]
  ds_read_b64_tr_b16 v[44:45], v23 offset:0
  ds_read_b64_tr_b16 v[46:47], v23 offset:512
  v_mfma_f32_32x32x16_bf16 v[192:207], v[56:59], a[184:187], v[192:207]
  v_mfma_f32_32x32x16_bf16 v[208:223], v[56:59], a[188:191], v[208:223]
  v_mfma_f32_32x32x16_bf16 v[224:239], v[60:63], a[184:187], v[224:239]
  v_mfma_f32_32x32x16_bf16 v[240:255], v[60:63], a[188:191], v[240:255]
  s_waitcnt lgkmcnt(7)
  v_mfma_f32_32x32x16_bf16 v[128:143], v[32:35], a[192:195], v[128:143]
  ds_read_b64_tr_b16 v[48:49], v20 offset:2048
  ds_read_b64_tr_b16 v[50:51], v20 offset:2560
  ds_read_b128 a[200:203], v17 offset:0
  s_waitcnt lgkmcnt(7)
  v_mfma_f32_32x32x16_bf16 v[144:159], v[32:35], a[196:199], v[144:159]
  ds_read_b64_tr_b16 v[52:53], v21 offset:2048
  ds_read_b64_tr_b16 v[54:55], v21 offset:2560
  ds_read_b128 a[204:207], v17 offset:4096
  v_mfma_f32_32x32x16_bf16 v[160:175], v[36:39], a[192:195], v[160:175]
  ds_read_b64_tr_b16 v[56:57], v22 offset:2048
  ds_read_b64_tr_b16 v[58:59], v22 offset:2560
  ds_read_b64_tr_b16 v[60:61], v23 offset:2048
  v_mfma_f32_32x32x16_bf16 v[176:191], v[36:39], a[196:199], v[176:191]
  ds_read_b64_tr_b16 v[62:63], v23 offset:2560
  s_waitcnt lgkmcnt(12)
  v_mfma_f32_32x32x16_bf16 v[192:207], v[40:43], a[192:195], v[192:207]
  v_mfma_f32_32x32x16_bf16 v[208:223], v[40:43], a[196:199], v[208:223]
  s_waitcnt lgkmcnt(10)
  v_mfma_f32_32x32x16_bf16 v[224:239], v[44:47], a[192:195], v[224:239]
  v_mfma_f32_32x32x16_bf16 v[240:255], v[44:47], a[196:199], v[240:255]
  s_waitcnt lgkmcnt(7)
  v_mfma_f32_32x32x16_bf16 v[128:143], v[48:51], a[200:203], v[128:143]
  ds_read_b64_tr_b16 v[32:33], v20 offset:4096
  ds_read_b64_tr_b16 v[34:35], v20 offset:4608
  ds_read_b128 a[208:211], v18 offset:0
  s_waitcnt lgkmcnt(7)
  v_mfma_f32_32x32x16_bf16 v[144:159], v[48:51], a[204:207], v[144:159]
  ds_read_b64_tr_b16 v[36:37], v21 offset:4096
  ds_read_b64_tr_b16 v[38:39], v21 offset:4608
  ds_read_b128 a[212:215], v18 offset:4096
  v_mfma_f32_32x32x16_bf16 v[160:175], v[52:55], a[200:203], v[160:175]
  ds_read_b64_tr_b16 v[40:41], v22 offset:4096
  ds_read_b64_tr_b16 v[42:43], v22 offset:4608
  ds_read_b64_tr_b16 v[44:45], v23 offset:4096
  v_mfma_f32_32x32x16_bf16 v[176:191], v[52:55], a[204:207], v[176:191]
  ds_read_b64_tr_b16 v[46:47], v23 offset:4608
  s_waitcnt lgkmcnt(12)
  v_mfma_f32_32x32x16_bf16 v[192:207], v[56:59], a[200:203], v[192:207]
  v_mfma_f32_32x32x16_bf16 v[208:223], v[56:59], a[204:207], v[208:223]
  s_waitcnt lgkmcnt(10)
  v_mfma_f32_32x32x16_bf16 v[224:239], v[60:63], a[200:203], v[224:239]
  v_mfma_f32_32x32x16_bf16 v[240:255], v[60:63], a[204:207], v[240:255]
  s_waitcnt lgkmcnt(7)
  v_mfma_f32_32x32x16_bf16 v[128:143], v[32:35], a[208:211], v[128:143]
  ds_read_b64_tr_b16 v[48:49], v20 offset:6144
  ds_read_b64_tr_b16 v[50:51], v20 offset:6656
  ds_read_b128 a[216:219], v19 offset:0
  s_waitcnt vmcnt(0)
  v_cmp_ne_u32 vcc, s56, v91
  s_nop 0
  s_cbranch_vccnz L_slow2
L_back2:
  s_waitcnt lgkmcnt(7)
  v_mfma_f32_32x32x16_bf16 v[144:159], v[32:35], a[212:215], v[144:159]
  ds_read_b64_tr_b16 v[52:53], v21 offset:6144
  ds_read_b64_tr_b16 v[54:55], v21 offset:6656
  ds_read_b128 a[220:223], v19 offset:4096
  buffer_load_dwordx2 v[92:93], v96, s[36:39], 0 offen sc1
  v_mfma_f32_32x32x16_bf16 v[160:175], v[36:39], a[208:211], v[160:175]
  ds_read_b64_tr_b16 v[56:57], v22 offset:6144
  ds_read_b64_tr_b16 v[58:59], v22 offset:6656
  ds_read_b64_tr_b16 v[60:61], v23 offset:6144
  buffer_load_dwordx2 v[94:95], v97, s[36:39], 0 offen sc1
  s_add_u32 s69, s78, s52
  s_lshl_b32 s69, s69, 10
  v_mfma_f32_32x32x16_bf16 v[176:191], v[36:39], a[212:215], v[176:191]
  ds_read_b64_tr_b16 v[62:63], v23 offset:6656
  v_add_u32 v16, 49152, v16
  v_add_u32 v17, 49152, v17
  s_waitcnt lgkmcnt(12)
  v_mfma_f32_32x32x16_bf16 v[192:207], v[40:43], a[208:211], v[192:207]
  v_add_u32 v18, 49152, v18
  v_add_u32 v19, 49152, v19
  v_add_u32 v20, 49152, v20
  v_mfma_f32_32x32x16_bf16 v[208:223], v[40:43], a[212:215], v[208:223]
  v_add_u32 v21, 49152, v21
  v_add_u32 v22, 49152, v22
  v_add_u32 v23, 49152, v23
  s_waitcnt lgkmcnt(10)
  v_mfma_f32_32x32x16_bf16 v[224:239], v[44:47], a[208:211], v[224:239]
  s_lshl_b32 s70, s52, 10
  s_add_u32 m0, s70, 159744
  s_nop 0
  buffer_load_dwordx4 v121, s[36:39], s69 offen sc1 lds
  v_mfma_f32_32x32x16_bf16 v[240:255], v[44:47], a[212:215], v[240:255]
  s_add_u32 s59, s77, 1
  s_and_b32 s59, s59, 7
  s_mul_i32 s59, s59, 229376
  s_waitcnt lgkmcnt(7)
  v_mfma_f32_32x32x16_bf16 v[128:143], v[48:51], a[216:219], v[128:143]
  s_waitcnt lgkmcnt(0)
  s_barrier
  ds_read_b64_tr_b16 v[32:33], v20 offset:0
  ds_read_b64_tr_b16 v[34:35], v20 offset:512
  v_mfma_f32_32x32x16_bf16 v[144:159], v[48:51], a[220:223], v[144:159]
  ds_read_b128 a[224:227], v16 offset:0
  ds_read_b64_tr_b16 v[36:37], v21 offset:0
  ds_read_b64_tr_b16 v[38:39], v21 offset:512
  s_mov_b32 s71, 6144
  buffer_store_dword v13, v14, s[36:39], s71 offen sc1
  v_mfma_f32_32x32x16_bf16 v[160:175], v[52:55], a[216:219], v[160:175]
  ds_read_b128 a[228:231], v16 offset:4096
  ds_read_b64_tr_b16 v[40:41], v22 offset:0
  ds_read_b64_tr_b16 v[42:43], v22 offset:512
  v_mfma_f32_32x32x16_bf16 v[176:191], v[52:55], a[220:223], v[176:191]
  ds_read_b64_tr_b16 v[44:45], v23 offset:0
  ds_read_b64_tr_b16 v[46:47], v23 offset:512
  s_add_u32 m0, s76, 8192
  s_nop 0
  buffer_load_dwordx4 v28, s[28:31], s59 offen lds
  v_mfma_f32_32x32x16_bf16 v[192:207], v[56:59], a[216:219], v[192:207]
  s_add_u32 m0, s76, 9216
  s_nop 0
  buffer_load_dwordx4 v29, s[32:35], s59 offen lds
  v_mfma_f32_32x32x16_bf16 v[208:223], v[56:59], a[220:223], v[208:223]
  v_mfma_f32_32x32x16_bf16 v[224:239], v[60:63], a[216:219], v[224:239]
  s_add_u32 m0, s82, 36864
  s_nop 0
  buffer_load_dwordx4 v11, s[96:99], s59 offen lds
  v_mfma_f32_32x32x16_bf16 v[240:255], v[60:63], a[220:223], v[240:255]
  s_add_u32 s59, s77, 2
  s_and_b32 s59, s59, 7
  s_mul_i32 s59, s59, 229376
  s_waitcnt lgkmcnt(7)
  v_mfma_f32_32x32x16_bf16 v[128:143], v[32:35], a[224:227], v[128:143]
  ds_read_b64_tr_b16 v[48:49], v20 offset:2048
  ds_read_b64_tr_b16 v[50:51], v20 offset:2560
  ds_read_b128 a[232:235], v17 offset:0
  s_waitcnt lgkmcnt(7)
  v_mfma_f32_32x32x16_bf16 v[144:159], v[32:35], a[228:231], v[144:159]
  ds_read_b64_tr_b16 v[52:53], v21 offset:2048
  ds_read_b64_tr_b16 v[54:55], v21 offset:2560
  ds_read_b128 a[236:239], v17 offset:4096
  v_mfma_f32_32x32x16_bf16 v[160:175], v[36:39], a[224:227], v[160:175]
  ds_read_b64_tr_b16 v[56:57], v22 offset:2048
  ds_read_b64_tr_b16 v[58:59], v22 offset:2560
  ds_read_b64_tr_b16 v[60:61], v23 offset:2048
  v_mfma_f32_32x32x16_bf16 v[176:191], v[36:39], a[228:231], v[176:191]
  ds_read_b64_tr_b16 v[62:63], v23 offset:2560
  s_add_u32 m0, s76, 16384
  s_nop 0
  buffer_load_dwordx4 v28, s[28:31], s59 offen lds
  s_waitcnt lgkmcnt(12)
  v_mfma_f32_32x32x16_bf16 v[192:207], v[40:43], a[224:227], v[192:207]
  s_add_u32 m0, s76, 17408
  s_nop 0
  buffer_load_dwordx4 v29, s[32:35], s59 offen lds
  v_mfma_f32_32x32x16_bf16 v[208:223], v[40:43], a[228:231], v[208:223]
  s_waitcnt lgkmcnt(10)
  v_mfma_f32_32x32x16_bf16 v[224:239], v[44:47], a[224:227], v[224:239]
  s_add_u32 m0, s82, 40960
  s_nop 0
  buffer_load_dwordx4 v11, s[96:99], s59 offen lds
  v_mfma_f32_32x32x16_bf16 v[240:255], v[44:47], a[228:231], v[240:255]
  s_add_u32 s59, s77, 3
  s_and_b32 s59, s59, 7
  s_mul_i32 s59, s59, 229376
  s_waitcnt lgkmcnt(7)
  v_mfma_f32_32x32x16_bf16 v[128:143], v[48:51], a[232:235], v[128:143]
  ds_read_b64_tr_b16 v[32:33], v20 offset:4096
  ds_read_b64_tr_b16 v[34:35], v20 offset:4608
  ds_read_b128 a[240:243], v18 offset:0
  s_waitcnt lgkmcnt(7)
  v_mfma_f32_32x32x16_bf16 v[144:159], v[48:51], a[236:239], v[144:159]
  ds_read_b64_tr_b16 v[36:37], v21 offset:4096
  ds_read_b64_tr_b16 v[38:39], v21 offset:4608
  ds_read_b128 a[244:247], v18 offset:4096
  v_mfma_f32_32x32x16_bf16 v[160:175], v[52:55], a[232:235], v[160:175]
  ds_read_b64_tr_b16 v[40:41], v22 offset:4096
  ds_read_b64_tr_b16 v[42:43], v22 offset:4608
  ds_read_b64_tr_b16 v[44:45], v23 offset:4096
  v_mfma_f32_32x32x16_bf16 v[176:191], v[52:55], a[236:239], v[176:191]
  ds_read_b64_tr_b16 v[46:47], v23 offset:4608
  s_add_u32 m0, s76, 24576
  s_nop 0
  buffer_load_dwordx4 v28, s[28:31], s59 offen lds
  s_waitcnt lgkmcnt(12)
  v_mfma_f32_32x32x16_bf16 v[192:207], v[56:59], a[232:235], v[192:207]
  s_add_u32 m0, s76, 25600
  s_nop 0
  buffer_load_dwordx4 v29, s[32:35], s59 offen lds
  v_mfma_f32_32x32x16_bf16 v[208:223], v[56:59], a[236:239], v[208:223]
  s_waitcnt lgkmcnt(10)
  v_mfma_f32_32x32x16_bf16 v[224:239], v[60:63], a[232:235], v[224:239]
  s_add_u32 m0, s82, 45056
  s_nop 0
  buffer_load_dwordx4 v11, s[96:99], s59 offen lds
  v_mfma_f32_32x32x16_bf16 v[240:255], v[60:63], a[236:239], v[240:255]
  s_add_u32 s59, s77, 4
  s_and_b32 s59, s59, 7
  s_mul_i32 s59, s59, 229376
  s_waitcnt lgkmcnt(7)
  v_mfma_f32_32x32x16_bf16 v[128:143], v[32:35], a[240:243], v[128:143]
  ds_read_b64_tr_b16 v[48:49], v20 offset:6144
  ds_read_b64_tr_b16 v[50:51], v20 offset:6656
  ds_read_b128 a[248:251], v19 offset:0
  s_waitcnt lgkmcnt(7)
  v_mfma_f32_32x32x16_bf16 v[144:159], v[32:35], a[244:247], v[144:159]
  ds_read_b64_tr_b16 v[52:53], v21 offset:6144
  ds_read_b64_tr_b16 v[54:55], v21 offset:6656
  ds_read_b128 a[252:255], v19 offset:4096
  v_mfma_f32_32x32x16_bf16 v[160:175], v[36:39], a[240:243], v[160:175]
  ds_read_b64_tr_b16 v[56:57], v22 offset:6144
  ds_read_b64_tr_b16 v[58:59], v22 offset:6656
  ds_read_b64_tr_b16 v[60:61], v23 offset:6144
  v_mfma_f32_32x32x16_bf16 v[176:191], v[36:39], a[244:247], v[176:191]
  ds_read_b64_tr_b16 v[62:63], v23 offset:6656
  s_add_u32 m0, s76, 65536
  s_nop 0
  buffer_load_dwordx4 v28, s[28:31], s59 offen lds
  s_waitcnt lgkmcnt(12)
  v_mfma_f32_32x32x16_bf16 v[192:207], v[40:43], a[240:243], v[192:207]
  s_add_u32 m0, s76, 66560
  s_nop 0
  buffer_load_dwordx4 v29, s[32:35], s59 offen lds
  v_mfma_f32_32x32x16_bf16 v[208:223], v[40:43], a[244:247], v[208:223]
  s_waitcnt lgkmcnt(10)
  v_mfma_f32_32x32x16_bf16 v[224:239], v[44:47], a[240:243], v[224:239]
  s_add_u32 m0, s82, 49152
  s_nop 0
  buffer_load_dwordx4 v11, s[96:99], s59 offen lds
  v_mfma_f32_32x32x16_bf16 v[240:255], v[44:47], a[244:247], v[240:255]
  s_add_u32 s59, s77, 5
  s_and_b32 s59, s59, 7
  s_mul_i32 s59, s59, 229376
  s_waitcnt lgkmcnt(7)
  v_mfma_f32_32x32x16_bf16 v[128:143], v[48:51], a[248:251], v[128:143]
  s_waitcnt vmcnt(13) lgkmcnt(0)
  s_barrier
  ds_read_b32 v32, v120 offset:0
  ds_read_b32 v33, v120 offset:128
  v_mov_b32 v108, v92
  v_mfma_f32_32x32x16_bf16 v[144:159], v[48:51], a[252:255], v[144:159]
  ds_read_b32 v34, v120 offset:256
  ds_read_b32 v35, v120 offset:384
  ds_read_b32 v36, v120 offset:1024
  v_mov_b32 v109, v92
  v_mov_b32 v110, v92
  v_mov_b32 v111, v92
  v_mfma_f32_32x32x16_bf16 v[160:175], v[52:55], a[248:251], v[160:175]
  ds_read_b32 v37, v120 offset:1152
  ds_read_b32 v38, v120 offset:1280
  ds_read_b32 v39, v120 offset:1408
  v_mov_b32 v112, v94
  v_mov_b32 v113, v94
  v_mov_b32 v114, v94
  v_mfma_f32_32x32x16_bf16 v[176:191], v[52:55], a[252:255], v[176:191]
  ds_read_b32 v40, v120 offset:2048
  ds_read_b32 v41, v120 offset:2176
  ds_read_b32 v42, v120 offset:2304
  v_mov_b32 v115, v94
  v_mfma_f32_32x32x16_bf16 v[192:207], v[56:59], a[248:251], v[192:207]
  ds_read_b32 v43, v120 offset:2432
  ds_read_b32 v44, v120 offset:3072
  ds_read_b32 v45, v120 offset:3200
  v_mfma_f32_32x32x16_bf16 v[208:223], v[56:59], a[252:255], v[208:223]
  ds_read_b32 v46, v120 offset:3328
  s_waitcnt lgkmcnt(14)
  ds_read_b32 v47, v120 offset:3456
  s_add_u32 m0, s76, 73728
  s_nop 0
  buffer_load_dwordx4 v28, s[28:31], s59 offen lds
  v_mfma_f32_32x32x16_bf16 v[224:239], v[60:63], a[248:251], v[224:239]
  s_add_u32 m0, s76, 74752
  s_nop 0
  buffer_load_dwordx4 v29, s[32:35], s59 offen lds
  v_mfma_f32_32x32x16_bf16 v[240:255], v[60:63], a[252:255], v[240:255]
  s_waitcnt lgkmcnt(12)
  v_mfma_f32_32x32x16_bf16 v[128:143], v[32:35], v[108:111], v[128:143]
  v_rcp_f32 v5, v93
  v_mov_b32 v7, v93
  v_rcp_f32 v6, v95
  v_mov_b32 v8, v95
  v_mul_f32 v5, 0xbfb8aa3b, v5
  v_mfma_f32_32x32x16_bf16 v[144:159], v[32:35], v[112:115], v[144:159]
  v_mul_f32 v6, 0xbfb8aa3b, v6
  v_mov_b32 v16, v108
  v_mov_b32 v17, v109
  v_mov_b32 v18, v110
  v_mov_b32 v19, v111
  s_waitcnt lgkmcnt(8)
  v_mfma_f32_32x32x16_bf16 v[160:175], v[36:39], v[108:111], v[160:175]
  v_mov_b32 v20, v112
  v_mov_b32 v21, v113
  v_mov_b32 v22, v114
  v_mov_b32 v23, v115
  v_mov_b32 v24, v104
  v_mfma_f32_32x32x16_bf16 v[176:191], v[36:39], v[112:115], v[176:191]
  v_mov_b32 v25, v105
  v_mov_b32 v26, v106
  v_mov_b32 v27, v107
  v_mov_b32 v10, v120
  v_mov_b32 v12, v121
  s_waitcnt lgkmcnt(4)
  v_mfma_f32_32x32x16_bf16 v[192:207], v[40:43], v[108:111], v[192:207]
  ds_read_b64_tr_b16 v[48:49], v24 offset:0
  ds_read_b64_tr_b16 v[50:51], v24 offset:256
  ds_read_b64_tr_b16 v[52:53], v25 offset:0
  ds_read_b64_tr_b16 v[54:55], v25 offset:256
  v_mov_b32 v56, v122
  v_mfma_f32_32x32x16_bf16 v[208:223], v[40:43], v[112:115], v[208:223]
  v_mov_b32 v57, v123
  v_mov_b32 v58, v124
  v_mov_b32 v59, v125
  v_mov_b32 v60, v126
  v_mov_b32 v61, v127
  s_waitcnt lgkmcnt(4)
  v_mfma_f32_32x32x16_bf16 v[224:239], v[44:47], v[108:111], v[224:239]
  s_add_u32 m0, s82, 53248
  s_nop 0
  buffer_load_dwordx4 v11, s[96:99], s59 offen lds
  v_mfma_f32_32x32x16_bf16 v[240:255], v[44:47], v[112:115], v[240:255]
  s_add_u32 s59, s77, 6
  s_and_b32 s59, s59, 7
  s_mul_i32 s59, s59, 229376
  s_waitcnt lgkmcnt(2)
  v_mfma_f32_32x32x16_bf16 v[64:79], v[48:51], a[0:3], 0
  ds_read_b64_tr_b16 v[32:33], v24 offset:2048
  ds_read_b64_tr_b16 v[34:35], v24 offset:2304
  s_add_u32 m0, s76, 81920
  s_nop 0
  buffer_load_dwordx4 v28, s[28:31], s59 offen lds
  v_mfma_f32_32x32x16_bf16 v[80:95], v[48:51], a[4:7], 0
  ds_read_b64_tr_b16 v[36:37], v25 offset:2048
  ds_read_b64_tr_b16 v[38:39], v25 offset:2304
  s_lshr_b32 s58, s60, 15
  s_mul_i32 s58, s58, 114688
  s_add_u32 s58, s58, 8388608
  v_lshl_add_u32 v44, v2, 4, s58
  s_waitcnt lgkmcnt(4)
  v_mfma_f32_32x32x16_bf16 v[96:111], v[52:55], a[0:3], 0
  s_add_u32 m0, s76, 82944
  s_nop 0
  buffer_load_dwordx4 v29, s[32:35], s59 offen lds
  v_mfma_f32_32x32x16_bf16 v[112:127], v[52:55], a[4:7], 0
  s_lshr_b32 s58, s64, 15
  s_mul_i32 s58, s58, 114688
  s_add_u32 s58, s58, 8388608
  v_lshl_add_u32 v45, v2, 4, s58
  s_lshl_b32 s78, s78, 10
  v_mul_f32 v128, v5, v128
  s_waitcnt lgkmcnt(2)
  v_mfma_f32_32x32x16_bf16 v[64:79], v[32:35], a[8:11], v[64:79]
  ds_read_b64_tr_b16 v[48:49], v24 offset:4096
  ds_read_b64_tr_b16 v[50:51], v24 offset:4352
  v_mul_f32 v129, v5, v129
  v_mul_f32 v130, v5, v130
  v_mul_f32 v131, v5, v131
  v_mul_f32 v132, v5, v132
  v_mfma_f32_32x32x16_bf16 v[80:95], v[32:35], a[12:15], v[80:95]
  ds_read_b64_tr_b16 v[52:53], v25 offset:4096
  ds_read_b64_tr_b16 v[54:55], v25 offset:4352
  s_add_u32 m0, s82, 57344
  s_nop 0
  buffer_load_dwordx4 v11, s[96:99], s59 offen lds
  s_waitcnt lgkmcnt(4)
  v_mfma_f32_32x32x16_bf16 v[96:111], v[36:39], a[8:11], v[96:111]
  s_add_u32 s59, s77, 7
  s_and_b32 s59, s59, 7
  s_mul_i32 s59, s59, 229376
  v_mul_f32 v133, v5, v133
  v_mul_f32 v134, v5, v134
  v_mul_f32 v135, v5, v135
  v_mfma_f32_32x32x16_bf16 v[112:127], v[36:39], a[12:15], v[112:127]
  v_exp_f32 v128, v128
  v_exp_f32 v129, v129
  v_exp_f32 v130, v130
  s_waitcnt lgkmcnt(2)
  v_mfma_f32_32x32x16_bf16 v[64:79], v[48:51], a[16:19], v[64:79]
  ds_read_b64_tr_b16 v[32:33], v24 offset:6144
  ds_read_b64_tr_b16 v[34:35], v24 offset:6400
  s_add_u32 m0, s76, 90112
  s_nop 0
  buffer_load_dwordx4 v28, s[28:31], s59 offen lds
  v_mfma_f32_32x32x16_bf16 v[80:95], v[48:51], a[20:23], v[80:95]
  ds_read_b64_tr_b16 v[36:37], v25 offset:6144
  ds_read_b64_tr_b16 v[38:39], v25 offset:6400
  v_exp_f32 v131, v131
  v_exp_f32 v132, v132
  s_waitcnt lgkmcnt(4)
  v_mfma_f32_32x32x16_bf16 v[96:111], v[52:55], a[16:19], v[96:111]
  v_exp_f32 v133, v133
  v_exp_f32 v134, v134
  v_exp_f32 v135, v135
  v_mfma_f32_32x32x16_bf16 v[112:127], v[52:55], a[20:23], v[112:127]
  s_add_u32 m0, s76, 91136
  s_nop 0
  buffer_load_dwordx4 v29, s[32:35], s59 offen lds
  v_fma_f32 v128, v128, v7, v7
  v_fma_f32 v129, v129, v7, v7
  s_waitcnt lgkmcnt(2)
  v_mfma_f32_32x32x16_bf16 v[64:79], v[32:35], a[24:27], v[64:79]
  s_waitcnt vmcnt(11) lgkmcnt(0)
  s_barrier
  v_add_u32 v24, 4294819840, v24
  v_fma_f32 v130, v130, v7, v7
  v_fma_f32 v131, v131, v7, v7
  v_mfma_f32_32x32x16_bf16 v[80:95], v[32:35], a[28:31], v[80:95]
  v_add_u32 v25, 4294819840, v25
  ds_read_b64_tr_b16 v[48:49], v24 offset:8192
  v_fma_f32 v132, v132, v7, v7
  v_fma_f32 v133, v133, v7, v7
  v_fma_f32 v134, v134, v7, v7
  v_fma_f32 v135, v135, v7, v7
  v_mfma_f32_32x32x16_bf16 v[96:111], v[36:39], a[24:27], v[96:111]
  ds_read_b64_tr_b16 v[50:51], v24 offset:8448
  ds_read_b64_tr_b16 v[52:53], v25 offset:8192
  s_add_u32 m0, s82, 61440
  s_nop 0
  buffer_load_dwordx4 v11, s[96:99], s59 offen lds
  v_mfma_f32_32x32x16_bf16 v[112:127], v[36:39], a[28:31], v[112:127]
  ds_read_b64_tr_b16 v[54:55], v25 offset:8448
  v_readlane_b32 s84, v9, 0
  s_add_u32 m0, s81, 102400
  v_readlane_b32 s85, v9, 1
  v_rcp_f32 v128, v128
  s_waitcnt lgkmcnt(2)
  v_mfma_f32_32x32x16_bf16 v[64:79], v[48:51], a[32:35], v[64:79]
  ds_read_b64_tr_b16 v[32:33], v24 offset:10240
  ds_read_b64_tr_b16 v[34:35], v24 offset:10496
  v_rcp_f32 v129, v129
  v_rcp_f32 v130, v130
  v_mfma_f32_32x32x16_bf16 v[80:95], v[48:51], a[36:39], v[80:95]
  ds_read_b64_tr_b16 v[36:37], v25 offset:10240
  ds_read_b64_tr_b16 v[38:39], v25 offset:10496
  buffer_load_dwordx4 v56, s[40:43], s84 offen lds
  v_rcp_f32 v131, v131
  s_waitcnt lgkmcnt(4)
  v_mfma_f32_32x32x16_bf16 v[96:111], v[52:55], a[32:35], v[96:111]
  v_rcp_f32 v132, v132
  v_rcp_f32 v133, v133
  v_rcp_f32 v134, v134
  v_mfma_f32_32x32x16_bf16 v[112:127], v[52:55], a[36:39], v[112:127]
  v_rcp_f32 v135, v135
  v_mul_f32 v136, v136, v128
  v_mul_f32 v137, v137, v129
  v_mul_f32 v138, v138, v130
  v_mul_f32 v139, v139, v131
  s_waitcnt lgkmcnt(2)
  v_mfma_f32_32x32x16_bf16 v[64:79], v[32:35], a[40:43], v[64:79]
  ds_read_b64_tr_b16 v[48:49], v24 offset:12288
  ds_read_b64_tr_b16 v[50:51], v24 offset:12544
  buffer_load_dwordx4 v57, s[40:43], s84 offen offset:1024 lds
  s_add_u32 m0, s81, 110592
  v_readlane_b32 s86, v9, 2
  v_mfma_f32_32x32x16_bf16 v[80:95], v[32:35], a[44:47], v[80:95]
  ds_read_b64_tr_b16 v[52:53], v25 offset:12288
  ds_read_b64_tr_b16 v[54:55], v25 offset:12544
  v_mul_f32 v140, v140, v132
  v_mul_f32 v141, v141, v133
  v_mul_f32 v142, v142, v134
  v_mul_f32 v143, v143, v135
  s_waitcnt lgkmcnt(4)
  v_mfma_f32_32x32x16_bf16 v[96:111], v[36:39], a[40:43], v[96:111]
  v_cvt_pk_bf16_f32 v128, v136, v137
  v_cvt_pk_bf16_f32 v129, v138, v139
  v_cvt_pk_bf16_f32 v130, v140, v141
  v_cvt_pk_bf16_f32 v131, v142, v143
  buffer_store_dwordx4 v[128:131], v44, s[36:39], s78 offen offset:0 sc1
  v_mfma_f32_32x32x16_bf16 v[112:127], v[36:39], a[44:47], v[112:127]
  v_mul_f32 v144, v6, v144
  v_mul_f32 v145, v6, v145
  v_mul_f32 v146, v6, v146
  v_mul_f32 v147, v6, v147
  v_mul_f32 v148, v6, v148
  v_mul_f32 v149, v6, v149
  s_waitcnt lgkmcnt(2)
  v_mfma_f32_32x32x16_bf16 v[64:79], v[48:51], a[48:51], v[64:79]
  ds_read_b64_tr_b16 v[32:33], v24 offset:14336
  ds_read_b64_tr_b16 v[34:35], v24 offset:14592
  v_mul_f32 v150, v6, v150
  v_mul_f32 v151, v6, v151
  v_exp_f32 v144, v144
  v_mfma_f32_32x32x16_bf16 v[80:95], v[48:51], a[52:55], v[80:95]
  ds_read_b64_tr_b16 v[36:37], v25 offset:14336
  ds_read_b64_tr_b16 v[38:39], v25 offset:14592
  v_exp_f32 v145, v145
  v_exp_f32 v146, v146
  s_waitcnt lgkmcnt(4)
  v_mfma_f32_32x32x16_bf16 v[96:111], v[52:55], a[48:51], v[96:111]
  buffer_load_dwordx4 v56, s[40:43], s85 offen lds
  v_exp_f32 v147, v147
  v_exp_f32 v148, v148
  v_mfma_f32_32x32x16_bf16 v[112:127], v[52:55], a[52:55], v[112:127]
  v_exp_f32 v149, v149
  v_exp_f32 v150, v150
  v_exp_f32 v151, v151
  s_waitcnt lgkmcnt(2)
  v_mfma_f32_32x32x16_bf16 v[64:79], v[32:35], a[56:59], v[64:79]
  ds_read_b64_tr_b16 v[48:49], v24 offset:16384
  ds_read_b64_tr_b16 v[50:51], v24 offset:16640
  v_fma_f32 v144, v144, v8, v8
  v_fma_f32 v145, v145, v8, v8
  v_fma_f32 v146, v146, v8, v8
  v_fma_f32 v147, v147, v8, v8
  v_mfma_f32_32x32x16_bf16 v[80:95], v[32:35], a[60:63], v[80:95]
  ds_read_b64_tr_b16 v[52:53], v25 offset:16384
  ds_read_b64_tr_b16 v[54:55], v25 offset:16640
  buffer_load_dwordx4 v57, s[40:43], s85 offen offset:1024 lds
  s_add_u32 m0, s81, 118784
  v_readlane_b32 s87, v9, 3
  s_waitcnt lgkmcnt(4)
  v_mfma_f32_32x32x16_bf16 v[96:111], v[36:39], a[56:59], v[96:111]
  v_fma_f32 v148, v148, v8, v8
  v_fma_f32 v149, v149, v8, v8
  v_fma_f32 v150, v150, v8, v8
  v_fma_f32 v151, v151, v8, v8
  v_rcp_f32 v144, v144
  v_mfma_f32_32x32x16_bf16 v[112:127], v[36:39], a[60:63], v[112:127]
  v_rcp_f32 v145, v145
  v_rcp_f32 v146, v146
  v_rcp_f32 v147, v147
  s_waitcnt lgkmcnt(2)
  v_mfma_f32_32x32x16_bf16 v[64:79], v[48:51], a[64:67], v[64:79]
  ds_read_b64_tr_b16 v[32:33], v24 offset:18432
  ds_read_b64_tr_b16 v[34:35], v24 offset:18688
  buffer_load_dwordx4 v56, s[40:43], s86 offen lds
  v_rcp_f32 v148, v148
  v_mfma_f32_32x32x16_bf16 v[80:95], v[48:51], a[68:71], v[80:95]
  ds_read_b64_tr_b16 v[36:37], v25 offset:18432
  ds_read_b64_tr_b16 v[38:39], v25 offset:18688
  v_rcp_f32 v149, v149
  v_rcp_f32 v150, v150
  s_waitcnt lgkmcnt(4)
  v_mfma_f32_32x32x16_bf16 v[96:111], v[52:55], a[64:67], v[96:111]
  v_rcp_f32 v151, v151
  v_mul_f32 v152, v152, v144
  v_mul_f32 v153, v153, v145
  v_mul_f32 v154, v154, v146
  v_mul_f32 v155, v155, v147
  v_mfma_f32_32x32x16_bf16 v[112:127], v[52:55], a[68:71], v[112:127]
  buffer_load_dwordx4 v57, s[40:43], s86 offen offset:1024 lds
  s_add_u32 m0, s81, 126976
  v_readlane_b32 s84, v9, 4
  v_mul_f32 v156, v156, v148
  v_mul_f32 v157, v157, v149
  s_waitcnt lgkmcnt(2)
  v_mfma_f32_32x32x16_bf16 v[64:79], v[32:35], a[72:75], v[64:79]
  ds_read_b64_tr_b16 v[48:49], v24 offset:20480
  ds_read_b64_tr_b16 v[50:51], v24 offset:20736
  v_mul_f32 v158, v158, v150
  v_mul_f32 v159, v159, v151
  v_cvt_pk_bf16_f32 v144, v152, v153
  v_cvt_pk_bf16_f32 v145, v154, v155
  v_mfma_f32_32x32x16_bf16 v[80:95], v[32:35], a[76:79], v[80:95]
  ds_read_b64_tr_b16 v[52:53], v25 offset:20480
  ds_read_b64_tr_b16 v[54:55], v25 offset:20736
  v_cvt_pk_bf16_f32 v146, v156, v157
  v_cvt_pk_bf16_f32 v147, v158, v159
  buffer_store_dwordx4 v[144:147], v45, s[36:39], s78 offen offset:0 sc1
  s_waitcnt lgkmcnt(4)
  v_mfma_f32_32x32x16_bf16 v[96:111], v[36:39], a[72:75], v[96:111]
  v_mul_f32 v160, v5, v160
  v_mul_f32 v161, v5, v161
  v_mul_f32 v162, v5, v162
  v_mul_f32 v163, v5, v163
  v_mul_f32 v164, v5, v164
  v_mul_f32 v165, v5, v165
  v_mfma_f32_32x32x16_bf16 v[112:127], v[36:39], a[76:79], v[112:127]
  v_mul_f32 v166, v5, v166
  v_mul_f32 v167, v5, v167
  v_exp_f32 v160, v160
  v_exp_f32 v161, v161
  s_waitcnt lgkmcnt(2)
  v_mfma_f32_32x32x16_bf16 v[64:79], v[48:51], a[80:83], v[64:79]
  ds_read_b64_tr_b16 v[32:33], v24 offset:22528
  ds_read_b64_tr_b16 v[34:35], v24 offset:22784
  v_exp_f32 v162, v162
  v_exp_f32 v163, v163
  v_mfma_f32_32x32x16_bf16 v[80:95], v[48:51], a[84:87], v[80:95]
  ds_read_b64_tr_b16 v[36:37], v25 offset:22528
  ds_read_b64_tr_b16 v[38:39], v25 offset:22784
  buffer_load_dwordx4 v56, s[40:43], s87 offen lds
  v_exp_f32 v164, v164
  s_waitcnt lgkmcnt(4)
  v_mfma_f32_32x32x16_bf16 v[96:111], v[52:55], a[80:83], v[96:111]
  v_exp_f32 v165, v165
  v_exp_f32 v166, v166
  v_exp_f32 v167, v167
  v_mfma_f32_32x32x16_bf16 v[112:127], v[52:55], a[84:87], v[112:127]
  v_fma_f32 v160, v160, v7, v7
  v_fma_f32 v161, v161, v7, v7
  v_fma_f32 v162, v162, v7, v7
  v_fma_f32 v163, v163, v7, v7
  v_fma_f32 v164, v164, v7, v7
  v_fma_f32 v165, v165, v7, v7
  s_waitcnt lgkmcnt(2)
  v_mfma_f32_32x32x16_bf16 v[64:79], v[32:35], a[88:91], v[64:79]
  ds_read_b64_tr_b16 v[48:49], v24 offset:24576
  ds_read_b64_tr_b16 v[50:51], v24 offset:24832
  buffer_load_dwordx4 v57, s[40:43], s87 offen offset:1024 lds
  s_add_u32 m0, s81, 135168
  v_readlane_b32 s85, v9, 5
  v_mfma_f32_32x32x16_bf16 v[80:95], v[32:35], a[92:95], v[80:95]
  ds_read_b64_tr_b16 v[52:53], v25 offset:24576
  ds_read_b64_tr_b16 v[54:55], v25 offset:24832
  v_fma_f32 v166, v166, v7, v7
  v_fma_f32 v167, v167, v7, v7
  v_rcp_f32 v160, v160
  s_waitcnt lgkmcnt(4)
  v_mfma_f32_32x32x16_bf16 v[96:111], v[36:39], a[88:91], v[96:111]
  v_rcp_f32 v161, v161
  v_rcp_f32 v162, v162
  v_rcp_f32 v163, v163
  v_mfma_f32_32x32x16_bf16 v[112:127], v[36:39], a[92:95], v[112:127]
  buffer_load_dwordx4 v56, s[40:43], s84 offen lds
  v_rcp_f32 v164, v164
  v_rcp_f32 v165, v165
  s_waitcnt lgkmcnt(2)
  v_mfma_f32_32x32x16_bf16 v[64:79], v[48:51], a[96:99], v[64:79]
  ds_read_b64_tr_b16 v[32:33], v24 offset:26624
  ds_read_b64_tr_b16 v[34:35], v24 offset:26880
  v_rcp_f32 v166, v166
  v_rcp_f32 v167, v167
  v_mfma_f32_32x32x16_bf16 v[80:95], v[48:51], a[100:103], v[80:95]
  ds_read_b64_tr_b16 v[36:37], v25 offset:26624
  ds_read_b64_tr_b16 v[38:39], v25 offset:26880
  v_mul_f32 v168, v168, v160
  v_mul_f32 v169, v169, v161
  v_mul_f32 v170, v170, v162
  v_mul_f32 v171, v171, v163
  s_waitcnt lgkmcnt(4)
  v_mfma_f32_32x32x16_bf16 v[96:111], v[52:55], a[96:99], v[96:111]
  buffer_load_dwordx4 v57, s[40:43], s84 offen offset:1024 lds
  s_add_u32 m0, s81, 143360
  v_readlane_b32 s86, v9, 7
  v_mul_f32 v172, v172, v164
  v_mul_f32 v173, v173, v165
  v_mfma_f32_32x32x16_bf16 v[112:127], v[52:55], a[100:103], v[112:127]
  v_mul_f32 v174, v174, v166
  v_mul_f32 v175, v175, v167
  v_cvt_pk_bf16_f32 v160, v168, v169
  v_cvt_pk_bf16_f32 v161, v170, v171
  v_cvt_pk_bf16_f32 v162, v172, v173
  v_cvt_pk_bf16_f32 v163, v174, v175
  s_waitcnt lgkmcnt(2)
  v_mfma_f32_32x32x16_bf16 v[64:79], v[32:35], a[104:107], v[64:79]
  ds_read_b64_tr_b16 v[48:49], v24 offset:28672
  ds_read_b64_tr_b16 v[50:51], v24 offset:28928
  buffer_store_dwordx4 v[160:163], v44, s[36:39], s78 offen offset:1024 sc1
  v_mul_f32 v176, v6, v176
  v_mul_f32 v177, v6, v177
  v_mfma_f32_32x32x16_bf16 v[80:95], v[32:35], a[108:111], v[80:95]
  ds_read_b64_tr_b16 v[52:53], v25 offset:28672
  ds_read_b64_tr_b16 v[54:55], v25 offset:28928
  v_mul_f32 v178, v6, v178
  v_mul_f32 v179, v6, v179
  v_mul_f32 v180, v6, v180
  v_mul_f32 v181, v6, v181
  s_waitcnt lgkmcnt(4)
  v_mfma_f32_32x32x16_bf16 v[96:111], v[36:39], a[104:107], v[96:111]
  v_mul_f32 v182, v6, v182
  v_mul_f32 v183, v6, v183
  v_exp_f32 v176, v176
  v_exp_f32 v177, v177
  v_mfma_f32_32x32x16_bf16 v[112:127], v[36:39], a[108:111], v[112:127]
  v_exp_f32 v178, v178
  v_exp_f32 v179, v179
  v_exp_f32 v180, v180
  s_waitcnt lgkmcnt(2)
  v_mfma_f32_32x32x16_bf16 v[64:79], v[48:51], a[112:115], v[64:79]
  ds_read_b64_tr_b16 v[32:33], v24 offset:30720
  ds_read_b64_tr_b16 v[34:35], v24 offset:30976
  buffer_load_dwordx4 v56, s[40:43], s85 offen lds
  v_exp_f32 v181, v181
  v_mfma_f32_32x32x16_bf16 v[80:95], v[48:51], a[116:119], v[80:95]
  ds_read_b64_tr_b16 v[36:37], v25 offset:30720
  ds_read_b64_tr_b16 v[38:39], v25 offset:30976
  v_exp_f32 v182, v182
  v_exp_f32 v183, v183
  s_waitcnt lgkmcnt(4)
  v_mfma_f32_32x32x16_bf16 v[96:111], v[52:55], a[112:115], v[96:111]
  v_fma_f32 v176, v176, v8, v8
  v_fma_f32 v177, v177, v8, v8
  v_fma_f32 v178, v178, v8, v8
  v_fma_f32 v179, v179, v8, v8
  v_fma_f32 v180, v180, v8, v8
  v_fma_f32 v181, v181, v8, v8
  v_mfma_f32_32x32x16_bf16 v[112:127], v[52:55], a[116:119], v[112:127]
  buffer_load_dwordx4 v57, s[40:43], s85 offen offset:1024 lds
  v_and_b32 v63, 7, v2
  s_lshl_b32 s69, s55, 2
  s_add_u32 s69, s69, 6144
  v_lshl_add_u32 v63, v63, 7, s69
  s_waitcnt lgkmcnt(2)
  v_mfma_f32_32x32x16_bf16 v[64:79], v[32:35], a[120:123], v[64:79]
  s_waitcnt vmcnt(15) lgkmcnt(0)
  s_barrier
  v_add_u32 v24, 32768, v24
  v_fma_f32 v182, v182, v8, v8
  v_fma_f32 v183, v183, v8, v8
  v_mfma_f32_32x32x16_bf16 v[80:95], v[32:35], a[124:127], v[80:95]
  v_add_u32 v25, 32768, v25
  ds_read_b64_tr_b16 v[48:49], v24 offset:32768
  v_rcp_f32 v176, v176
  v_rcp_f32 v177, v177
  v_mfma_f32_32x32x16_bf16 v[96:111], v[36:39], a[120:123], v[96:111]
  ds_read_b64_tr_b16 v[50:51], v24 offset:33024
  ds_read_b64_tr_b16 v[52:53], v25 offset:32768
  buffer_load_dword v42, v63, s[36:39], 0 offen sc1
  s_add_u32 m0, s81, 0
  v_readlane_b32 s87, v9, 8
  v_mfma_f32_32x32x16_bf16 v[112:127], v[36:39], a[124:127], v[112:127]
  ds_read_b64_tr_b16 v[54:55], v25 offset:33024
  v_rcp_f32 v178, v178
  v_rcp_f32 v179, v179
  s_waitcnt lgkmcnt(2)
  v_mfma_f32_32x32x16_bf16 v[64:79], v[48:51], a[128:131], v[64:79]
  ds_read_b64_tr_b16 v[32:33], v24 offset:34816
  ds_read_b64_tr_b16 v[34:35], v24 offset:35072
  v_rcp_f32 v180, v180
  v_rcp_f32 v181, v181
  v_mfma_f32_32x32x16_bf16 v[80:95], v[48:51], a[132:135], v[80:95]
  ds_read_b64_tr_b16 v[36:37], v25 offset:34816
  ds_read_b64_tr_b16 v[38:39], v25 offset:35072
  buffer_load_dwordx4 v56, s[40:43], s86 offen lds
  v_rcp_f32 v182, v182
  s_waitcnt lgkmcnt(4)
  v_mfma_f32_32x32x16_bf16 v[96:111], v[52:55], a[128:131], v[96:111]
  v_rcp_f32 v183, v183
  v_mul_f32 v184, v184, v176
  v_mul_f32 v185, v185, v177
  v_mul_f32 v186, v186, v178
  v_mul_f32 v187, v187, v179
  v_mfma_f32_32x32x16_bf16 v[112:127], v[52:55], a[132:135], v[112:127]
  v_mul_f32 v188, v188, v180
  v_mul_f32 v189, v189, v181
  v_mul_f32 v190, v190, v182
  v_mul_f32 v191, v191, v183
  v_cvt_pk_bf16_f32 v176, v184, v185
  v_cvt_pk_bf16_f32 v177, v186, v187
  s_waitcnt lgkmcnt(2)
  v_mfma_f32_32x32x16_bf16 v[64:79], v[32:35], a[136:139], v[64:79]
  ds_read_b64_tr_b16 v[48:49], v24 offset:36864
  ds_read_b64_tr_b16 v[50:51], v24 offset:37120
  buffer_load_dwordx4 v57, s[40:43], s86 offen offset:1024 lds
  s_add_u32 m0, s81, 8192
  v_readlane_b32 s84, v9, 9
  v_mfma_f32_32x32x16_bf16 v[80:95], v[32:35], a[140:143], v[80:95]
  ds_read_b64_tr_b16 v[52:53], v25 offset:36864
  ds_read_b64_tr_b16 v[54:55], v25 offset:37120
  v_cvt_pk_bf16_f32 v178, v188, v189
  v_cvt_pk_bf16_f32 v179, v190, v191
  buffer_store_dwordx4 v[176:179], v45, s[36:39], s78 offen offset:1024 sc1
  s_waitcnt lgkmcnt(4)
  v_mfma_f32_32x32x16_bf16 v[96:111], v[36:39], a[136:139], v[96:111]
  v_mul_f32 v192, v5, v192
  v_mul_f32 v193, v5, v193
  v_mul_f32 v194, v5, v194
  v_mul_f32 v195, v5, v195
  v_mul_f32 v196, v5, v196
  v_mul_f32 v197, v5, v197
  v_mfma_f32_32x32x16_bf16 v[112:127], v[36:39], a[140:143], v[112:127]
  v_mul_f32 v198, v5, v198
  v_mul_f32 v199, v5, v199
  v_exp_f32 v192, v192
  v_exp_f32 v193, v193
  s_waitcnt lgkmcnt(2)
  v_mfma_f32_32x32x16_bf16 v[64:79], v[48:51], a[144:147], v[64:79]
  ds_read_b64_tr_b16 v[32:33], v24 offset:38912
  ds_read_b64_tr_b16 v[34:35], v24 offset:39168
  v_exp_f32 v194, v194
  v_exp_f32 v195, v195
  v_mfma_f32_32x32x16_bf16 v[80:95], v[48:51], a[148:151], v[80:95]
  ds_read_b64_tr_b16 v[36:37], v25 offset:38912
  ds_read_b64_tr_b16 v[38:39], v25 offset:39168
  v_exp_f32 v196, v196
  v_exp_f32 v197, v197
  s_waitcnt lgkmcnt(4)
  v_mfma_f32_32x32x16_bf16 v[96:111], v[52:55], a[144:147], v[96:111]
  buffer_load_dwordx4 v56, s[40:43], s87 offen lds
  v_exp_f32 v198, v198
  v_exp_f32 v199, v199
  v_mfma_f32_32x32x16_bf16 v[112:127], v[52:55], a[148:151], v[112:127]
  v_fma_f32 v192, v192, v7, v7
  v_fma_f32 v193, v193, v7, v7
  v_fma_f32 v194, v194, v7, v7
  v_fma_f32 v195, v195, v7, v7
  v_fma_f32 v196, v196, v7, v7
  v_fma_f32 v197, v197, v7, v7
  s_waitcnt lgkmcnt(2)
  v_mfma_f32_32x32x16_bf16 v[64:79], v[32:35], a[152:155], v[64:79]
  ds_read_b64_tr_b16 v[48:49], v24 offset:40960
  ds_read_b64_tr_b16 v[50:51], v24 offset:41216
  v_fma_f32 v198, v198, v7, v7
  v_fma_f32 v199, v199, v7, v7
  v_rcp_f32 v192, v192
  v_mfma_f32_32x32x16_bf16 v[80:95], v[32:35], a[156:159], v[80:95]
  ds_read_b64_tr_b16 v[52:53], v25 offset:40960
  ds_read_b64_tr_b16 v[54:55], v25 offset:41216
  buffer_load_dwordx4 v57, s[40:43], s87 offen offset:1024 lds
  s_add_u32 m0, s81, 16384
  v_readlane_b32 s85, v9, 10
  s_waitcnt lgkmcnt(4)
  v_mfma_f32_32x32x16_bf16 v[96:111], v[36:39], a[152:155], v[96:111]
  v_rcp_f32 v193, v193
  v_rcp_f32 v194, v194
  v_rcp_f32 v195, v195
  v_mfma_f32_32x32x16_bf16 v[112:127], v[36:39], a[156:159], v[112:127]
  v_rcp_f32 v196, v196
  v_rcp_f32 v197, v197
  v_rcp_f32 v198, v198
  s_waitcnt lgkmcnt(2)
  v_mfma_f32_32x32x16_bf16 v[64:79], v[48:51], a[160:163], v[64:79]
  s_waitcnt vmcnt(2)
  s_barrier
  ds_read_b64_tr_b16 v[32:33], v24 offset:43008
  s_mov_b32 s71, 8192
  buffer_store_dword v13, v14, s[36:39], s71 offen sc1
  v_mfma_f32_32x32x16_bf16 v[80:95], v[48:51], a[164:167], v[80:95]
  ds_read_b64_tr_b16 v[34:35], v24 offset:43264
  ds_read_b64_tr_b16 v[36:37], v25 offset:43008
  v_rcp_f32 v199, v199
  v_mul_f32 v200, v200, v192
  v_mul_f32 v201, v201, v193
  s_waitcnt lgkmcnt(3)
  v_mfma_f32_32x32x16_bf16 v[96:111], v[52:55], a[160:163], v[96:111]
  ds_read_b64_tr_b16 v[38:39], v25 offset:43264
  v_mul_f32 v202, v202, v194
  v_mul_f32 v203, v203, v195
  v_mul_f32 v204, v204, v196
  v_mul_f32 v205, v205, v197
  v_mul_f32 v206, v206, v198
  v_mfma_f32_32x32x16_bf16 v[112:127], v[52:55], a[164:167], v[112:127]
  buffer_load_dwordx4 v56, s[40:43], s84 offen lds
  v_mul_f32 v207, v207, v199
  v_cvt_pk_bf16_f32 v192, v200, v201
  v_cvt_pk_bf16_f32 v193, v202, v203
  v_cvt_pk_bf16_f32 v194, v204, v205
  s_waitcnt lgkmcnt(2)
  v_mfma_f32_32x32x16_bf16 v[64:79], v[32:35], a[168:171], v[64:79]
  ds_read_b64_tr_b16 v[48:49], v24 offset:45056
  ds_read_b64_tr_b16 v[50:51], v24 offset:45312
  v_cvt_pk_bf16_f32 v195, v206, v207
  buffer_store_dwordx4 v[192:195], v44, s[36:39], s78 offen offset:2048 sc1
  v_mul_f32 v208, v6, v208
  v_mfma_f32_32x32x16_bf16 v[80:95], v[32:35], a[172:175], v[80:95]
  ds_read_b64_tr_b16 v[52:53], v25 offset:45056
  ds_read_b64_tr_b16 v[54:55], v25 offset:45312
  v_mul_f32 v209, v6, v209
  v_mul_f32 v210, v6, v210
  v_mul_f32 v211, v6, v211
  v_mul_f32 v212, v6, v212
  s_waitcnt lgkmcnt(4)
  v_mfma_f32_32x32x16_bf16 v[96:111], v[36:39], a[168:171], v[96:111]
  v_mul_f32 v213, v6, v213
  v_mul_f32 v214, v6, v214
  v_mul_f32 v215, v6, v215
  v_exp_f32 v208, v208
  v_mfma_f32_32x32x16_bf16 v[112:127], v[36:39], a[172:175], v[112:127]
  v_exp_f32 v209, v209
  v_exp_f32 v210, v210
  v_exp_f32 v211, v211
  s_waitcnt lgkmcnt(2)
  v_mfma_f32_32x32x16_bf16 v[64:79], v[48:51], a[176:179], v[64:79]
  ds_read_b64_tr_b16 v[32:33], v24 offset:47104
  ds_read_b64_tr_b16 v[34:35], v24 offset:47360
  v_exp_f32 v212, v212
  v_exp_f32 v213, v213
  v_mfma_f32_32x32x16_bf16 v[80:95], v[48:51], a[180:183], v[80:95]
  ds_read_b64_tr_b16 v[36:37], v25 offset:47104
  ds_read_b64_tr_b16 v[38:39], v25 offset:47360
  buffer_load_dwordx4 v57, s[40:43], s84 offen offset:1024 lds
  s_add_u32 m0, s81, 24576
  v_readlane_b32 s86, v9, 11
  s_waitcnt lgkmcnt(4)
  v_mfma_f32_32x32x16_bf16 v[96:111], v[52:55], a[176:179], v[96:111]
  v_exp_f32 v214, v214
  v_exp_f32 v215, v215
  v_fma_f32 v208, v208, v8, v8
  v_fma_f32 v209, v209, v8, v8
  v_mfma_f32_32x32x16_bf16 v[112:127], v[52:55], a[180:183], v[112:127]
  v_fma_f32 v210, v210, v8, v8
  v_fma_f32 v211, v211, v8, v8
  v_fma_f32 v212, v212, v8, v8
  v_fma_f32 v213, v213, v8, v8
  v_fma_f32 v214, v214, v8, v8
  v_fma_f32 v215, v215, v8, v8
  s_waitcnt lgkmcnt(2)
  v_mfma_f32_32x32x16_bf16 v[64:79], v[32:35], a[184:187], v[64:79]
  ds_read_b64_tr_b16 v[48:49], v24 offset:49152
  ds_read_b64_tr_b16 v[50:51], v24 offset:49408
  buffer_load_dwordx4 v56, s[40:43], s85 offen lds
  v_rcp_f32 v208, v208
  v_mfma_f32_32x32x16_bf16 v[80:95], v[32:35], a[188:191], v[80:95]
  ds_read_b64_tr_b16 v[52:53], v25 offset:49152
  ds_read_b64_tr_b16 v[54:55], v25 offset:49408
  v_rcp_f32 v209, v209
  v_rcp_f32 v210, v210
  s_waitcnt lgkmcnt(4)
  v_mfma_f32_32x32x16_bf16 v[96:111], v[36:39], a[184:187], v[96:111]
  v_rcp_f32 v211, v211
  v_rcp_f32 v212, v212
  v_rcp_f32 v213, v213
  v_mfma_f32_32x32x16_bf16 v[112:127], v[36:39], a[188:191], v[112:127]
  buffer_load_dwordx4 v57, s[40:43], s85 offen offset:1024 lds
  v_cmp_ne_u32 vcc, s56, v42
  s_nop 0
  s_cbranch_vccnz L_slow3
L_back3:
  s_waitcnt lgkmcnt(2)
  v_mfma_f32_32x32x16_bf16 v[64:79], v[48:51], a[192:195], v[64:79]
  ds_read_b64_tr_b16 v[32:33], v24 offset:51200
  ds_read_b64_tr_b16 v[34:35], v24 offset:51456
  s_add_u32 s69, s79, s52
  s_cmp_lt_u32 s52, 2
  s_cselect_b32 s69, s69, s80
  s_lshl_b32 s69, s69, 10
  v_mfma_f32_32x32x16_bf16 v[80:95], v[48:51], a[196:199], v[80:95]
  ds_read_b64_tr_b16 v[36:37], v25 offset:51200
  ds_read_b64_tr_b16 v[38:39], v25 offset:51456
  v_rcp_f32 v214, v214
  v_rcp_f32 v215, v215
  s_waitcnt lgkmcnt(4)
  v_mfma_f32_32x32x16_bf16 v[96:111], v[52:55], a[192:195], v[96:111]
  s_lshl_b32 s70, s52, 10
  s_add_u32 m0, s70, 159744
  s_nop 0
  buffer_load_dwordx4 v12, s[36:39], s69 offen sc1 lds
  v_mul_f32 v216, v216, v208
  v_mfma_f32_32x32x16_bf16 v[112:127], v[52:55], a[196:199], v[112:127]
  v_mul_f32 v217, v217, v209
  v_mul_f32 v218, v218, v210
  v_mul_f32 v219, v219, v211
  v_mul_f32 v220, v220, v212
  v_mul_f32 v221, v221, v213
  v_mul_f32 v222, v222, v214
  s_waitcnt lgkmcnt(2)
  v_mfma_f32_32x32x16_bf16 v[64:79], v[32:35], a[200:203], v[64:79]
  ds_read_b64_tr_b16 v[48:49], v24 offset:53248
  ds_read_b64_tr_b16 v[50:51], v24 offset:53504
  v_mul_f32 v223, v223, v215
  v_cvt_pk_bf16_f32 v208, v216, v217
  v_cvt_pk_bf16_f32 v209, v218, v219
  v_cvt_pk_bf16_f32 v210, v220, v221
  v_mfma_f32_32x32x16_bf16 v[80:95], v[32:35], a[204:207], v[80:95]
  ds_read_b64_tr_b16 v[52:53], v25 offset:53248
  ds_read_b64_tr_b16 v[54:55], v25 offset:53504
  v_cvt_pk_bf16_f32 v211, v222, v223
  buffer_store_dwordx4 v[208:211], v45, s[36:39], s78 offen offset:2048 sc1
  v_mul_f32 v224, v5, v224
  s_waitcnt lgkmcnt(4)
  v_mfma_f32_32x32x16_bf16 v[96:111], v[36:39], a[200:203], v[96:111]
  v_mul_f32 v225, v5, v225
  v_mul_f32 v226, v5, v226
  v_mul_f32 v227, v5, v227
  v_mul_f32 v228, v5, v228
  v_mul_f32 v229, v5, v229
  v_mul_f32 v230, v5, v230
  v_mfma_f32_32x32x16_bf16 v[112:127], v[36:39], a[204:207], v[112:127]
  v_mul_f32 v231, v5, v231
  v_exp_f32 v224, v224
  v_exp_f32 v225, v225
  s_waitcnt lgkmcnt(2)
  v_mfma_f32_32x32x16_bf16 v[64:79], v[48:51], a[208:211], v[64:79]
  ds_read_b64_tr_b16 v[32:33], v24 offset:55296
  ds_read_b64_tr_b16 v[34:35], v24 offset:55552
  v_exp_f32 v226, v226
  v_exp_f32 v227, v227
  v_mfma_f32_32x32x16_bf16 v[80:95], v[48:51], a[212:215], v[80:95]
  ds_read_b64_tr_b16 v[36:37], v25 offset:55296
  ds_read_b64_tr_b16 v[38:39], v25 offset:55552
  v_exp_f32 v228, v228
  v_exp_f32 v229, v229
  s_waitcnt lgkmcnt(4)
  v_mfma_f32_32x32x16_bf16 v[96:111], v[52:55], a[208:211], v[96:111]
  v_exp_f32 v230, v230
  v_exp_f32 v231, v231
  v_fma_f32 v224, v224, v7, v7
  v_fma_f32 v225, v225, v7, v7
  v_mfma_f32_32x32x16_bf16 v[112:127], v[52:55], a[212:215], v[112:127]
  v_fma_f32 v226, v226, v7, v7
  v_fma_f32 v227, v227, v7, v7
  v_fma_f32 v228, v228, v7, v7
  v_fma_f32 v229, v229, v7, v7
  v_fma_f32 v230, v230, v7, v7
  v_fma_f32 v231, v231, v7, v7
  s_waitcnt lgkmcnt(2)
  v_mfma_f32_32x32x16_bf16 v[64:79], v[32:35], a[216:219], v[64:79]
  ds_read_b64_tr_b16 v[48:49], v24 offset:57344
  ds_read_b64_tr_b16 v[50:51], v24 offset:57600
  v_rcp_f32 v224, v224
  v_rcp_f32 v225, v225
  v_mfma_f32_32x32x16_bf16 v[80:95], v[32:35], a[220:223], v[80:95]
  ds_read_b64_tr_b16 v[52:53], v25 offset:57344
  ds_read_b64_tr_b16 v[54:55], v25 offset:57600
  v_rcp_f32 v226, v226
  v_rcp_f32 v227, v227
  s_waitcnt lgkmcnt(4)
  v_mfma_f32_32x32x16_bf16 v[96:111], v[36:39], a[216:219], v[96:111]
  v_rcp_f32 v228, v228
  v_rcp_f32 v229, v229
  v_rcp_f32 v230, v230
  v_mfma_f32_32x32x16_bf16 v[112:127], v[36:39], a[220:223], v[112:127]
  v_rcp_f32 v231, v231
  v_mul_f32 v232, v232, v224
  v_mul_f32 v233, v233, v225
  v_mul_f32 v234, v234, v226
  v_mul_f32 v235, v235, v227
  s_waitcnt lgkmcnt(2)
  v_mfma_f32_32x32x16_bf16 v[64:79], v[48:51], a[224:227], v[64:79]
  ds_read_b64_tr_b16 v[32:33], v24 offset:59392
  ds_read_b64_tr_b16 v[34:35], v24 offset:59648
  v_mul_f32 v236, v236, v228
  v_mul_f32 v237, v237, v229
  v_mul_f32 v238, v238, v230
  v_mul_f32 v239, v239, v231
  v_mfma_f32_32x32x16_bf16 v[80:95], v[48:51], a[228:231], v[80:95]
  ds_read_b64_tr_b16 v[36:37], v25 offset:59392
  ds_read_b64_tr_b16 v[38:39], v25 offset:59648
  v_cvt_pk_bf16_f32 v224, v232, v233
  v_cvt_pk_bf16_f32 v225, v234, v235
  v_cvt_pk_bf16_f32 v226, v236, v237
  v_cvt_pk_bf16_f32 v227, v238, v239
  s_waitcnt lgkmcnt(4)
  v_mfma_f32_32x32x16_bf16 v[96:111], v[52:55], a[224:227], v[96:111]
  buffer_store_dwordx4 v[224:227], v44, s[36:39], s78 offen offset:3072 sc1
  v_mul_f32 v240, v6, v240
  v_mul_f32 v241, v6, v241
  v_mul_f32 v242, v6, v242
  v_mul_f32 v243, v6, v243
  v_mfma_f32_32x32x16_bf16 v[112:127], v[52:55], a[228:231], v[112:127]
  v_mul_f32 v244, v6, v244
  v_mul_f32 v245, v6, v245
  v_mul_f32 v246, v6, v246
  v_mul_f32 v247, v6, v247
  v_exp_f32 v240, v240
  s_waitcnt lgkmcnt(2)
  v_mfma_f32_32x32x16_bf16 v[64:79], v[32:35], a[232:235], v[64:79]
  ds_read_b64_tr_b16 v[48:49], v24 offset:61440
  ds_read_b64_tr_b16 v[50:51], v24 offset:61696
  v_exp_f32 v241, v241
  v_exp_f32 v242, v242
  v_mfma_f32_32x32x16_bf16 v[80:95], v[32:35], a[236:239], v[80:95]
  ds_read_b64_tr_b16 v[52:53], v25 offset:61440
  ds_read_b64_tr_b16 v[54:55], v25 offset:61696
  v_exp_f32 v243, v243
  v_exp_f32 v244, v244
  s_waitcnt lgkmcnt(4)
  v_mfma_f32_32x32x16_bf16 v[96:111], v[36:39], a[232:235], v[96:111]
  v_exp_f32 v245, v245
  v_exp_f32 v246, v246
  v_exp_f32 v247, v247
  v_mfma_f32_32x32x16_bf16 v[112:127], v[36:39], a[236:239], v[112:127]
  v_fma_f32 v240, v240, v8, v8
  v_fma_f32 v241, v241, v8, v8
  v_fma_f32 v242, v242, v8, v8
  v_fma_f32 v243, v243, v8, v8
  v_fma_f32 v244, v244, v8, v8
  v_fma_f32 v245, v245, v8, v8
  s_waitcnt lgkmcnt(2)
  v_mfma_f32_32x32x16_bf16 v[64:79], v[48:51], a[240:243], v[64:79]
  ds_read_b64_tr_b16 v[32:33], v24 offset:63488
  ds_read_b64_tr_b16 v[34:35], v24 offset:63744
  v_fma_f32 v246, v246, v8, v8
  v_fma_f32 v247, v247, v8, v8
  v_rcp_f32 v240, v240
  v_mfma_f32_32x32x16_bf16 v[80:95], v[48:51], a[244:247], v[80:95]
  ds_read_b64_tr_b16 v[36:37], v25 offset:63488
  ds_read_b64_tr_b16 v[38:39], v25 offset:63744
  v_rcp_f32 v241, v241
  v_rcp_f32 v242, v242
  s_waitcnt lgkmcnt(4)
  v_mfma_f32_32x32x16_bf16 v[96:111], v[52:55], a[240:243], v[96:111]
  v_rcp_f32 v243, v243
  v_rcp_f32 v244, v244
  v_rcp_f32 v245, v245
  v_mfma_f32_32x32x16_bf16 v[112:127], v[52:55], a[244:247], v[112:127]
  v_rcp_f32 v246, v246
  v_rcp_f32 v247, v247
  v_mul_f32 v248, v248, v240
  v_mul_f32 v249, v249, v241
  s_waitcnt lgkmcnt(2)
  v_mfma_f32_32x32x16_bf16 v[64:79], v[32:35], a[248:251], v[64:79]
  s_waitcnt vmcnt(2) lgkmcnt(0)
  s_barrier
  ds_read_b32 v48, v10 offset:0
  ds_read_b32 v49, v10 offset:128
  ds_read_b32 v50, v10 offset:256
  v_mfma_f32_32x32x16_bf16 v[80:95], v[32:35], a[252:255], v[80:95]
  ds_read_b32 v51, v10 offset:384
  ds_read_b32 v52, v10 offset:1024
  ds_read_b32 v53, v10 offset:1152
  ds_read_b32 v54, v10 offset:1280
  s_add_u32 m0, s81, 65536
  v_readlane_b32 s87, v9, 12
  v_mfma_f32_32x32x16_bf16 v[96:111], v[36:39], a[248:251], v[96:111]
  ds_read_b32 v55, v10 offset:1408
  buffer_load_dwordx4 v56, s[40:43], s86 offen lds
  v_mul_f32 v250, v250, v242
  v_mul_f32 v251, v251, v243
  v_mul_f32 v252, v252, v244
  v_mfma_f32_32x32x16_bf16 v[112:127], v[36:39], a[252:255], v[112:127]
  v_mul_f32 v253, v253, v245
  v_mul_f32 v254, v254, v246
  v_mul_f32 v255, v255, v247
  v_cvt_pk_bf16_f32 v240, v248, v249
  v_cvt_pk_bf16_f32 v241, v250, v251
  v_cvt_pk_bf16_f32 v242, v252, v253
  v_cvt_pk_bf16_f32 v243, v254, v255
  buffer_store_dwordx4 v[240:243], v45, s[36:39], s78 offen offset:3072 sc1
  s_waitcnt lgkmcnt(4)
  v_mfma_f32_32x32x16_bf16 v[64:79], v[48:51], v[16:19], v[64:79]
  ds_read_b64_tr_b16 v[32:33], v26 offset:0
  ds_read_b64_tr_b16 v[34:35], v27 offset:0
  s_lshl_b32 s79, s79, 10
  buffer_load_dwordx4 v57, s[40:43], s86 offen offset:1024 lds
  v_mfma_f32_32x32x16_bf16 v[80:95], v[48:51], v[20:23], v[80:95]
  s_lshl_b32 s80, s80, 10
  s_add_u32 m0, s81, 73728
  v_readlane_b32 s84, v9, 13
  s_waitcnt lgkmcnt(2)
  v_mfma_f32_32x32x16_bf16 v[96:111], v[52:55], v[16:19], v[96:111]
  buffer_load_dwordx4 v56, s[40:43], s87 offen lds
  v_mfma_f32_32x32x16_bf16 v[112:127], v[52:55], v[20:23], v[112:127]
  s_waitcnt lgkmcnt(0)
  v_mfma_f32_32x32x16_bf16 v[128:143], v[32:35], a[0:3], 0
  ds_read_b64_tr_b16 v[48:49], v26 offset:512
  ds_read_b64_tr_b16 v[50:51], v27 offset:512
  buffer_load_dwordx4 v57, s[40:43], s87 offen offset:1024 lds
  s_add_u32 m0, s81, 81920
  v_readlane_b32 s85, v9, 14
  v_mfma_f32_32x32x16_bf16 v[144:159], v[32:35], a[4:7], 0
  s_nop 0
  s_waitcnt lgkmcnt(0)
  v_mfma_f32_32x32x16_bf16 v[128:143], v[48:51], a[8:11], v[128:143]
  ds_read_b64_tr_b16 v[32:33], v26 offset:2048
  ds_read_b64_tr_b16 v[34:35], v27 offset:2048
  buffer_load_dwordx4 v56, s[40:43], s84 offen lds
  v_mul_f32 v64, v5, v64
  v_mul_f32 v65, v5, v65
  v_mfma_f32_32x32x16_bf16 v[144:159], v[48:51], a[12:15], v[144:159]
  v_mul_f32 v66, v5, v66
  v_mul_f32 v67, v5, v67
  v_mul_f32 v68, v5, v68
  v_mul_f32 v69, v5, v69
  v_mul_f32 v70, v5, v70
  v_mul_f32 v71, v5, v71
  s_waitcnt lgkmcnt(0)
  v_mfma_f32_32x32x16_bf16 v[128:143], v[32:35], a[16:19], v[128:143]
  ds_read_b64_tr_b16 v[48:49], v26 offset:2560
  ds_read_b64_tr_b16 v[50:51], v27 offset:2560
  buffer_load_dwordx4 v57, s[40:43], s84 offen offset:1024 lds
  s_add_u32 m0, s81, 90112
  v_readlane_b32 s86, v9, 6
  v_mfma_f32_32x32x16_bf16 v[144:159], v[32:35], a[20:23], v[144:159]
  v_exp_f32 v64, v64
  v_exp_f32 v65, v65
  v_exp_f32 v66, v66
  s_waitcnt lgkmcnt(0)
  v_mfma_f32_32x32x16_bf16 v[128:143], v[48:51], a[24:27], v[128:143]
  v_add_u32 v26, 4294844416, v26
  v_add_u32 v27, 4294844416, v27
  buffer_load_dwordx4 v56, s[40:43], s85 offen lds
  v_exp_f32 v67, v67
  v_mfma_f32_32x32x16_bf16 v[144:159], v[48:51], a[28:31], v[144:159]
  ds_read_b64_tr_b16 v[32:33], v26 offset:4096
  ds_read_b64_tr_b16 v[34:35], v27 offset:4096
  v_exp_f32 v68, v68
  v_exp_f32 v69, v69
  s_waitcnt lgkmcnt(0)
  v_mfma_f32_32x32x16_bf16 v[128:143], v[32:35], a[32:35], v[128:143]
  ds_read_b64_tr_b16 v[48:49], v26 offset:4608
  ds_read_b64_tr_b16 v[50:51], v27 offset:4608
  buffer_load_dwordx4 v57, s[40:43], s85 offen offset:1024 lds
  v_exp_f32 v70, v70
  v_mfma_f32_32x32x16_bf16 v[144:159], v[32:35], a[36:39], v[144:159]
  v_exp_f32 v71, v71
  v_fma_f32 v64, v64, v7, v7
  v_fma_f32 v65, v65, v7, v7
  v_fma_f32 v66, v66, v7, v7
  v_fma_f32 v67, v67, v7, v7
  s_waitcnt lgkmcnt(0)
  v_mfma_f32_32x32x16_bf16 v[128:143], v[48:51], a[40:43], v[128:143]
  ds_read_b64_tr_b16 v[32:33], v26 offset:6144
  ds_read_b64_tr_b16 v[34:35], v27 offset:6144
  v_fma_f32 v68, v68, v7, v7
  v_fma_f32 v69, v69, v7, v7
  v_fma_f32 v70, v70, v7, v7
  v_fma_f32 v71, v71, v7, v7
  v_mfma_f32_32x32x16_bf16 v[144:159], v[48:51], a[44:47], v[144:159]
  v_rcp_f32 v64, v64
  v_rcp_f32 v65, v65
  v_rcp_f32 v66, v66
  s_waitcnt lgkmcnt(0)
  v_mfma_f32_32x32x16_bf16 v[128:143], v[32:35], a[48:51], v[128:143]
  s_waitcnt vmcnt(7) lgkmcnt(0)
  s_barrier
  ds_read_b64_tr_b16 v[48:49], v26 offset:6656
  s_mov_b32 s71, 9216
  buffer_store_dword v13, v14, s[36:39], s71 offen sc1
  v_mfma_f32_32x32x16_bf16 v[144:159], v[32:35], a[52:55], v[144:159]
  ds_read_b64_tr_b16 v[50:51], v27 offset:6656
  s_add_u32 m0, s81, 151552
  v_readlane_b32 s87, v9, 15
  buffer_load_dwordx4 v56, s[40:43], s86 offen lds
  s_waitcnt lgkmcnt(0)
  v_mfma_f32_32x32x16_bf16 v[128:143], v[48:51], a[56:59], v[128:143]
  ds_read_b64_tr_b16 v[32:33], v26 offset:8192
  ds_read_b64_tr_b16 v[34:35], v27 offset:8192
  v_rcp_f32 v67, v67
  v_rcp_f32 v68, v68
  v_mfma_f32_32x32x16_bf16 v[144:159], v[48:51], a[60:63], v[144:159]
  buffer_load_dwordx4 v57, s[40:43], s86 offen offset:1024 lds
  s_cmp_lt_u32 s52, 2
  s_mov_b32 s82, 8192
  s_cselect_b32 s82, 8192, s82
  s_waitcnt lgkmcnt(0)
  v_mfma_f32_32x32x16_bf16 v[128:143], v[32:35], a[64:67], v[128:143]
  ds_read_b64_tr_b16 v[48:49], v26 offset:8704
  ds_read_b64_tr_b16 v[50:51], v27 offset:8704
  v_rcp_f32 v69, v69
  v_rcp_f32 v70, v70
  v_mfma_f32_32x32x16_bf16 v[144:159], v[32:35], a[68:71], v[144:159]
  buffer_load_dword v62, v61, s[36:39], s82 offen sc1
  v_rcp_f32 v71, v71
  v_mul_f32 v72, v72, v64
  v_mul_f32 v73, v73, v65
  v_mul_f32 v74, v74, v66
  s_waitcnt lgkmcnt(0)
  v_mfma_f32_32x32x16_bf16 v[128:143], v[48:51], a[72:75], v[128:143]
  ds_read_b64_tr_b16 v[32:33], v26 offset:10240
  ds_read_b64_tr_b16 v[34:35], v27 offset:10240
  v_mul_f32 v75, v75, v67
  v_mul_f32 v76, v76, v68
  v_mul_f32 v77, v77, v69
  v_mul_f32 v78, v78, v70
  v_mfma_f32_32x32x16_bf16 v[144:159], v[48:51], a[76:79], v[144:159]
  v_mul_f32 v79, v79, v71
  v_cvt_pk_bf16_f32 v64, v72, v73
  v_cvt_pk_bf16_f32 v65, v74, v75
  v_cvt_pk_bf16_f32 v66, v76, v77
  v_cvt_pk_bf16_f32 v67, v78, v79
  s_waitcnt lgkmcnt(0)
  v_mfma_f32_32x32x16_bf16 v[128:143], v[32:35], a[80:83], v[128:143]
  ds_read_b64_tr_b16 v[48:49], v26 offset:10752
  ds_read_b64_tr_b16 v[50:51], v27 offset:10752
  buffer_store_dwordx4 v[64:67], v44, s[36:39], s79 offen offset:0 sc1
  v_mul_f32 v80, v6, v80
  v_mul_f32 v81, v6, v81
  v_mfma_f32_32x32x16_bf16 v[144:159], v[32:35], a[84:87], v[144:159]
  v_mul_f32 v82, v6, v82
  v_mul_f32 v83, v6, v83
  v_mul_f32 v84, v6, v84
  v_mul_f32 v85, v6, v85
  v_mul_f32 v86, v6, v86
  v_mul_f32 v87, v6, v87
  s_waitcnt lgkmcnt(0)
  v_mfma_f32_32x32x16_bf16 v[128:143], v[48:51], a[88:91], v[128:143]
  ds_read_b64_tr_b16 v[32:33], v26 offset:12288
  ds_read_b64_tr_b16 v[34:35], v27 offset:12288
  v_exp_f32 v80, v80
  v_exp_f32 v81, v81
  v_mfma_f32_32x32x16_bf16 v[144:159], v[48:51], a[92:95], v[144:159]
  v_exp_f32 v82, v82
  v_exp_f32 v83, v83
  v_exp_f32 v84, v84
  s_waitcnt lgkmcnt(0)
  v_mfma_f32_32x32x16_bf16 v[128:143], v[32:35], a[96:99], v[128:143]
  ds_read_b64_tr_b16 v[48:49], v26 offset:12800
  ds_read_b64_tr_b16 v[50:51], v27 offset:12800
  v_exp_f32 v85, v85
  v_exp_f32 v86, v86
  v_mfma_f32_32x32x16_bf16 v[144:159], v[32:35], a[100:103], v[144:159]
  v_exp_f32 v87, v87
  v_fma_f32 v80, v80, v8, v8
  v_fma_f32 v81, v81, v8, v8
  v_fma_f32 v82, v82, v8, v8
  v_fma_f32 v83, v83, v8, v8
  s_waitcnt lgkmcnt(0)
  v_mfma_f32_32x32x16_bf16 v[128:143], v[48:51], a[104:107], v[128:143]
  ds_read_b64_tr_b16 v[32:33], v26 offset:14336
  ds_read_b64_tr_b16 v[34:35], v27 offset:14336
  v_fma_f32 v84, v84, v8, v8
  v_fma_f32 v85, v85, v8, v8
  v_fma_f32 v86, v86, v8, v8
  v_fma_f32 v87, v87, v8, v8
  v_mfma_f32_32x32x16_bf16 v[144:159], v[48:51], a[108:111], v[144:159]
  v_rcp_f32 v80, v80
  v_rcp_f32 v81, v81
  v_rcp_f32 v82, v82
  s_waitcnt lgkmcnt(0)
  v_mfma_f32_32x32x16_bf16 v[128:143], v[32:35], a[112:115], v[128:143]
  ds_read_b64_tr_b16 v[48:49], v26 offset:14848
  ds_read_b64_tr_b16 v[50:51], v27 offset:14848
  s_waitcnt vmcnt(1)
  v_cmp_ne_u32 vcc, s56, v62
  s_nop 0
  s_cbranch_vccnz L_slow4
L_back4:
  v_readlane_b32 s88, v3, 0
  v_mfma_f32_32x32x16_bf16 v[144:159], v[32:35], a[116:119], v[144:159]
  v_readlane_b32 s89, v3, 1
  v_readlane_b32 s90, v3, 2
  s_nop 1
  buffer_load_dwordx4 v[160:163], v60, s[36:39], s88 offen sc1
  v_readlane_b32 s91, v3, 3
  s_waitcnt lgkmcnt(0)
  v_mfma_f32_32x32x16_bf16 v[128:143], v[48:51], a[120:123], v[128:143]
  ds_read_b64_tr_b16 v[32:33], v26 offset:16384
  ds_read_b64_tr_b16 v[34:35], v27 offset:16384
  buffer_load_dwordx4 v[164:167], v60, s[36:39], s89 offen sc1
  v_readlane_b32 s88, v3, 4
  v_mfma_f32_32x32x16_bf16 v[144:159], v[48:51], a[124:127], v[144:159]
  v_rcp_f32 v83, v83
  v_rcp_f32 v84, v84
  v_rcp_f32 v85, v85
  s_waitcnt lgkmcnt(0)
  v_mfma_f32_32x32x16_bf16 v[128:143], v[32:35], a[128:131], v[128:143]
  ds_read_b64_tr_b16 v[48:49], v26 offset:16896
  ds_read_b64_tr_b16 v[50:51], v27 offset:16896
  buffer_load_dwordx4 v[168:171], v60, s[36:39], s90 offen sc1
  v_readlane_b32 s89, v3, 5
  v_mfma_f32_32x32x16_bf16 v[144:159], v[32:35], a[132:135], v[144:159]
  v_rcp_f32 v86, v86
  v_rcp_f32 v87, v87
  v_mul_f32 v88, v88, v80
  v_mul_f32 v89, v89, v81
  s_waitcnt lgkmcnt(0)
  v_mfma_f32_32x32x16_bf16 v[128:143], v[48:51], a[136:139], v[128:143]
  ds_read_b64_tr_b16 v[32:33], v26 offset:18432
  ds_read_b64_tr_b16 v[34:35], v27 offset:18432
  buffer_load_dwordx4 v[172:175], v60, s[36:39], s91 offen sc1
  v_readlane_b32 s90, v3, 6
  v_mul_f32 v90, v90, v82
  v_mfma_f32_32x32x16_bf16 v[144:159], v[48:51], a[140:143], v[144:159]
  v_mul_f32 v91, v91, v83
  v_mul_f32 v92, v92, v84
  v_mul_f32 v93, v93, v85
  v_mul_f32 v94, v94, v86
  v_mul_f32 v95, v95, v87
  v_cvt_pk_bf16_f32 v80, v88, v89
  s_waitcnt lgkmcnt(0)
  v_mfma_f32_32x32x16_bf16 v[128:143], v[32:35], a[144:147], v[128:143]
  ds_read_b64_tr_b16 v[48:49], v26 offset:18944
  ds_read_b64_tr_b16 v[50:51], v27 offset:18944
  buffer_load_dwordx4 v[176:179], v60, s[36:39], s88 offen sc1
  v_readlane_b32 s91, v3, 7
  v_cvt_pk_bf16_f32 v81, v90, v91
  v_mfma_f32_32x32x16_bf16 v[144:159], v[32:35], a[148:151], v[144:159]
  v_cvt_pk_bf16_f32 v82, v92, v93
  v_cvt_pk_bf16_f32 v83, v94, v95
  buffer_store_dwordx4 v[80:83], v45, s[36:39], s79 offen offset:0 sc1
  v_mul_f32 v96, v5, v96
  v_mul_f32 v97, v5, v97
  s_waitcnt lgkmcnt(0)
  v_mfma_f32_32x32x16_bf16 v[128:143], v[48:51], a[152:155], v[128:143]
  ds_read_b64_tr_b16 v[32:33], v26 offset:20480
  ds_read_b64_tr_b16 v[34:35], v27 offset:20480
  v_mul_f32 v98, v5, v98
  v_mul_f32 v99, v5, v99
  v_mul_f32 v100, v5, v100
  v_mul_f32 v101, v5, v101
  v_mfma_f32_32x32x16_bf16 v[144:159], v[48:51], a[156:159], v[144:159]
  v_mul_f32 v102, v5, v102
  v_mul_f32 v103, v5, v103
  v_exp_f32 v96, v96
  v_exp_f32 v97, v97
  s_waitcnt lgkmcnt(0)
  v_mfma_f32_32x32x16_bf16 v[128:143], v[32:35], a[160:163], v[128:143]
  ds_read_b64_tr_b16 v[48:49], v26 offset:20992
  ds_read_b64_tr_b16 v[50:51], v27 offset:20992
  buffer_load_dwordx4 v[180:183], v60, s[36:39], s89 offen sc1
  v_readlane_b32 s88, v3, 8
  v_mfma_f32_32x32x16_bf16 v[144:159], v[32:35], a[164:167], v[144:159]
  v_exp_f32 v98, v98
  v_exp_f32 v99, v99
  v_exp_f32 v100, v100
  s_waitcnt lgkmcnt(0)
  v_mfma_f32_32x32x16_bf16 v[128:143], v[48:51], a[168:171], v[128:143]
  ds_read_b64_tr_b16 v[32:33], v26 offset:22528
  ds_read_b64_tr_b16 v[34:35], v27 offset:22528
  buffer_load_dwordx4 v[184:187], v60, s[36:39], s90 offen sc1
  v_readlane_b32 s89, v3, 9
  v_mfma_f32_32x32x16_bf16 v[144:159], v[48:51], a[172:175], v[144:159]
  v_exp_f32 v101, v101
  v_exp_f32 v102, v102
  v_exp_f32 v103, v103
  s_waitcnt lgkmcnt(0)
  v_mfma_f32_32x32x16_bf16 v[128:143], v[32:35], a[176:179], v[128:143]
  ds_read_b64_tr_b16 v[48:49], v26 offset:23040
  ds_read_b64_tr_b16 v[50:51], v27 offset:23040
  buffer_load_dwordx4 v[188:191], v60, s[36:39], s91 offen sc1
  v_readlane_b32 s90, v3, 10
  v_fma_f32 v96, v96, v7, v7
  v_mfma_f32_32x32x16_bf16 v[144:159], v[32:35], a[180:183], v[144:159]
  v_fma_f32 v97, v97, v7, v7
  v_fma_f32 v98, v98, v7, v7
  v_fma_f32 v99, v99, v7, v7
  v_fma_f32 v100, v100, v7, v7
  v_fma_f32 v101, v101, v7, v7
  v_fma_f32 v102, v102, v7, v7
  s_waitcnt lgkmcnt(0)
  v_mfma_f32_32x32x16_bf16 v[128:143], v[48:51], a[184:187], v[128:143]
  ds_read_b64_tr_b16 v[32:33], v26 offset:24576
  ds_read_b64_tr_b16 v[34:35], v27 offset:24576
  buffer_load_dwordx4 v[192:195], v60, s[36:39], s88 offen sc1
  v_readlane_b32 s91, v3, 11
  v_fma_f32 v103, v103, v7, v7
  v_mfma_f32_32x32x16_bf16 v[144:159], v[48:51], a[188:191], v[144:159]
  v_rcp_f32 v96, v96
  v_rcp_f32 v97, v97
  v_rcp_f32 v98, v98
  s_waitcnt lgkmcnt(0)
  v_mfma_f32_32x32x16_bf16 v[128:143], v[32:35], a[192:195], v[128:143]
  ds_read_b64_tr_b16 v[48:49], v26 offset:25088
  ds_read_b64_tr_b16 v[50:51], v27 offset:25088
  buffer_load_dwordx4 v[196:199], v60, s[36:39], s89 offen sc1
  v_readlane_b32 s88, v3, 12
  v_mfma_f32_32x32x16_bf16 v[144:159], v[32:35], a[196:199], v[144:159]
  v_rcp_f32 v99, v99
  v_rcp_f32 v100, v100
  v_rcp_f32 v101, v101
  s_waitcnt lgkmcnt(0)
  v_mfma_f32_32x32x16_bf16 v[128:143], v[48:51], a[200:203], v[128:143]
  ds_read_b64_tr_b16 v[32:33], v26 offset:26624
  ds_read_b64_tr_b16 v[34:35], v27 offset:26624
  buffer_load_dwordx4 v[200:203], v60, s[36:39], s90 offen sc1
  v_readlane_b32 s89, v3, 13
  v_mfma_f32_32x32x16_bf16 v[144:159], v[48:51], a[204:207], v[144:159]
  v_rcp_f32 v102, v102
  v_rcp_f32 v103, v103
  v_mul_f32 v104, v104, v96
  v_mul_f32 v105, v105, v97
  s_waitcnt lgkmcnt(0)
  v_mfma_f32_32x32x16_bf16 v[128:143], v[32:35], a[208:211], v[128:143]
  ds_read_b64_tr_b16 v[48:49], v26 offset:27136
  ds_read_b64_tr_b16 v[50:51], v27 offset:27136
  buffer_load_dwordx4 v[204:207], v60, s[36:39], s91 offen sc1
  v_readlane_b32 s90, v3, 14
  v_mul_f32 v106, v106, v98
  v_mfma_f32_32x32x16_bf16 v[144:159], v[32:35], a[212:215], v[144:159]
  v_mul_f32 v107, v107, v99
  v_mul_f32 v108, v108, v100
  v_mul_f32 v109, v109, v101
  v_mul_f32 v110, v110, v102
  v_mul_f32 v111, v111, v103
  v_cvt_pk_bf16_f32 v96, v104, v105
  s_waitcnt lgkmcnt(0)
  v_mfma_f32_32x32x16_bf16 v[128:143], v[48:51], a[216:219], v[128:143]
  ds_read_b64_tr_b16 v[32:33], v26 offset:28672
  ds_read_b64_tr_b16 v[34:35], v27 offset:28672
  buffer_load_dwordx4 v[208:211], v60, s[36:39], s88 offen sc1
  v_readlane_b32 s91, v3, 15
  v_cvt_pk_bf16_f32 v97, v106, v107
  v_mfma_f32_32x32x16_bf16 v[144:159], v[48:51], a[220:223], v[144:159]
  v_cvt_pk_bf16_f32 v98, v108, v109
  v_cvt_pk_bf16_f32 v99, v110, v111
  buffer_store_dwordx4 v[96:99], v44, s[36:39], s79 offen offset:1024 sc1
  v_mul_f32 v112, v6, v112
  v_mul_f32 v113, v6, v113
  s_waitcnt lgkmcnt(0)
  v_mfma_f32_32x32x16_bf16 v[128:143], v[32:35], a[224:227], v[128:143]
  ds_read_b64_tr_b16 v[48:49], v26 offset:29184
  ds_read_b64_tr_b16 v[50:51], v27 offset:29184
  v_mul_f32 v114, v6, v114
  v_mul_f32 v115, v6, v115
  v_mul_f32 v116, v6, v116
  v_mul_f32 v117, v6, v117
  v_mfma_f32_32x32x16_bf16 v[144:159], v[32:35], a[228:231], v[144:159]
  v_mul_f32 v118, v6, v118
  v_mul_f32 v119, v6, v119
  v_exp_f32 v112, v112
  v_exp_f32 v113, v113
  s_waitcnt lgkmcnt(0)
  v_mfma_f32_32x32x16_bf16 v[128:143], v[48:51], a[232:235], v[128:143]
  ds_read_b64_tr_b16 v[32:33], v26 offset:30720
  ds_read_b64_tr_b16 v[34:35], v27 offset:30720
  buffer_load_dwordx4 v[212:215], v60, s[36:39], s89 offen sc1
  v_readlane_b32 s88, v3, 16
  v_mfma_f32_32x32x16_bf16 v[144:159], v[48:51], a[236:239], v[144:159]
  v_exp_f32 v114, v114
  v_exp_f32 v115, v115
  v_exp_f32 v116, v116
  s_waitcnt lgkmcnt(0)
  v_mfma_f32_32x32x16_bf16 v[128:143], v[32:35], a[240:243], v[128:143]
  ds_read_b64_tr_b16 v[48:49], v26 offset:31232
  ds_read_b64_tr_b16 v[50:51], v27 offset:31232
  buffer_load_dwordx4 v[216:219], v60, s[36:39], s90 offen sc1
  v_readlane_b32 s89, v3, 17
  v_mfma_f32_32x32x16_bf16 v[144:159], v[32:35], a[244:247], v[144:159]
  v_exp_f32 v117, v117
  v_exp_f32 v118, v118
  v_exp_f32 v119, v119
  s_waitcnt lgkmcnt(0)
  v_mfma_f32_32x32x16_bf16 v[128:143], v[48:51], a[248:251], v[128:143]
  ds_read_b32 v36, v10 offset:2048
  ds_read_b32 v37, v10 offset:2176
  ds_read_b32 v38, v10 offset:2304
  ds_read_b32 v39, v10 offset:2432
  buffer_load_dwordx4 v[220:223], v60, s[36:39], s91 offen sc1
  v_mfma_f32_32x32x16_bf16 v[144:159], v[48:51], a[252:255], v[144:159]
  v_fma_f32 v112, v112, v8, v8
  v_fma_f32 v113, v113, v8, v8
  v_fma_f32 v114, v114, v8, v8
  v_fma_f32 v115, v115, v8, v8
  v_fma_f32 v116, v116, v8, v8
  v_fma_f32 v117, v117, v8, v8
  s_waitcnt lgkmcnt(0)
  v_mfma_f32_32x32x16_bf16 v[128:143], v[36:39], v[16:19], v[128:143]
  v_fma_f32 v118, v118, v8, v8
  v_fma_f32 v119, v119, v8, v8
  v_rcp_f32 v112, v112
  v_rcp_f32 v113, v113
  v_mfma_f32_32x32x16_bf16 v[144:159], v[36:39], v[20:23], v[144:159]
  v_rcp_f32 v114, v114
  v_rcp_f32 v115, v115
  v_rcp_f32 v116, v116
  v_rcp_f32 v117, v117
  v_rcp_f32 v118, v118
  v_rcp_f32 v119, v119
  v_mul_f32 v120, v120, v112
  v_mul_f32 v121, v121, v113
  v_mul_f32 v122, v122, v114
  v_mul_f32 v123, v123, v115
  v_mul_f32 v124, v124, v116
  v_mul_f32 v125, v125, v117
  v_mul_f32 v126, v126, v118
  v_mul_f32 v127, v127, v119
  v_cvt_pk_bf16_f32 v112, v120, v121
  v_cvt_pk_bf16_f32 v113, v122, v123
  v_cvt_pk_bf16_f32 v114, v124, v125
  v_cvt_pk_bf16_f32 v115, v126, v127
  buffer_store_dwordx4 v[112:115], v45, s[36:39], s79 offen offset:1024 sc1
  v_mul_f32 v128, v5, v128
  v_mul_f32 v129, v5, v129
  v_mul_f32 v130, v5, v130
  v_mul_f32 v131, v5, v131
  v_mul_f32 v132, v5, v132
  v_mul_f32 v133, v5, v133
  v_mul_f32 v134, v5, v134
  v_mul_f32 v135, v5, v135
  v_exp_f32 v128, v128
  v_exp_f32 v129, v129
  v_exp_f32 v130, v130
  v_exp_f32 v131, v131
  v_exp_f32 v132, v132
  v_exp_f32 v133, v133
  v_exp_f32 v134, v134
  v_exp_f32 v135, v135
  v_fma_f32 v128, v128, v7, v7
  v_fma_f32 v129, v129, v7, v7
  v_fma_f32 v130, v130, v7, v7
  v_fma_f32 v131, v131, v7, v7
  v_fma_f32 v132, v132, v7, v7
  v_fma_f32 v133, v133, v7, v7
  v_fma_f32 v134, v134, v7, v7
  v_fma_f32 v135, v135, v7, v7
  v_rcp_f32 v128, v128
  v_rcp_f32 v129, v129
  v_rcp_f32 v130, v130
  v_rcp_f32 v131, v131
  v_rcp_f32 v132, v132
  v_rcp_f32 v133, v133
  v_rcp_f32 v134, v134
  v_rcp_f32 v135, v135
  v_mul_f32 v136, v136, v128
  v_mul_f32 v137, v137, v129
  v_mul_f32 v138, v138, v130
  v_mul_f32 v139, v139, v131
  v_mul_f32 v140, v140, v132
  v_mul_f32 v141, v141, v133
  v_mul_f32 v142, v142, v134
  v_mul_f32 v143, v143, v135
  v_cvt_pk_bf16_f32 v128, v136, v137
  v_cvt_pk_bf16_f32 v129, v138, v139
  v_cvt_pk_bf16_f32 v130, v140, v141
  v_cvt_pk_bf16_f32 v131, v142, v143
  buffer_store_dwordx4 v[128:131], v44, s[36:39], s80 offen offset:0 sc1
  s_cmp_lt_u32 s52, 2
  s_mov_b32 s82, 9216
  s_cselect_b32 s82, 9216, s82
  buffer_load_dword v62, v61, s[36:39], s82 offen sc1
  v_mul_f32 v144, v6, v144
  v_mul_f32 v145, v6, v145
  v_mul_f32 v146, v6, v146
  v_mul_f32 v147, v6, v147
  v_mul_f32 v148, v6, v148
  v_mul_f32 v149, v6, v149
  v_mul_f32 v150, v6, v150
  v_mul_f32 v151, v6, v151
  v_exp_f32 v144, v144
  v_exp_f32 v145, v145
  v_exp_f32 v146, v146
  v_exp_f32 v147, v147
  v_exp_f32 v148, v148
  v_exp_f32 v149, v149
  v_exp_f32 v150, v150
  v_exp_f32 v151, v151
  v_fma_f32 v144, v144, v8, v8
  v_fma_f32 v145, v145, v8, v8
  v_fma_f32 v146, v146, v8, v8
  v_fma_f32 v147, v147, v8, v8
  v_fma_f32 v148, v148, v8, v8
  v_fma_f32 v149, v149, v8, v8
  v_fma_f32 v150, v150, v8, v8
  v_fma_f32 v151, v151, v8, v8
  v_rcp_f32 v144, v144
  v_rcp_f32 v145, v145
  v_rcp_f32 v146, v146
  v_rcp_f32 v147, v147
  v_rcp_f32 v148, v148
  v_rcp_f32 v149, v149
  v_rcp_f32 v150, v150
  v_rcp_f32 v151, v151
  v_mul_f32 v152, v152, v144
  v_mul_f32 v153, v153, v145
  v_mul_f32 v154, v154, v146
  v_mul_f32 v155, v155, v147
  v_mul_f32 v156, v156, v148
  v_mul_f32 v157, v157, v149
  v_mul_f32 v158, v158, v150
  v_mul_f32 v159, v159, v151
  v_cvt_pk_bf16_f32 v144, v152, v153
  v_cvt_pk_bf16_f32 v145, v154, v155
  v_cvt_pk_bf16_f32 v146, v156, v157
  v_cvt_pk_bf16_f32 v147, v158, v159
  buffer_store_dwordx4 v[144:147], v45, s[36:39], s80 offen offset:0 sc1
  v_add_u32 v148, 65536, v58
  v_add_u32 v149, 65536, v59
  v_add_u32 v150, 131072, v58
  v_add_u32 v151, 131072, v59
  s_lshl_b32 s58, s72, 1
  s_and_b32 s69, s52, 1
  s_add_u32 s58, s58, s69
  s_lshl_b32 s58, s58, 15
  s_lshl_b32 s69, s73, 7
  s_add_u32 s58, s58, s69
  s_lshr_b32 s69, s52, 1
  s_lshl_b32 s69, s69, 6
  s_add_u32 s58, s58, s69
  v_mov_b32 v145, s58
  v_and_b32 v144, 31, v2
  v_lshl_add_u32 v144, v144, 10, v145
  v_lshrrev_b32 v146, 5, v2
  v_lshl_add_u32 v145, v146, 3, v144
  v_lshl_add_u32 v144, v146, 4, v144
  s_lshl_b32 s58, s52, 12
  v_lshl_add_u32 v146, v2, 4, s58
  v_xor_b32 v147, 0x2000, v146
  s_waitcnt vmcnt(3) lgkmcnt(0)
  s_barrier
  ds_read_b64_tr_b16 v[32:33], v148 offset:36864
  ds_read_b64_tr_b16 v[34:35], v148 offset:37888
  ds_read_b64_tr_b16 v[36:37], v149 offset:36864
  ds_read_b64_tr_b16 v[38:39], v149 offset:37888
  s_waitcnt lgkmcnt(2)
  v_mfma_f32_32x32x16_bf16 v[64:79], v[32:35], v[160:163], 0
  ds_read_b64_tr_b16 v[40:41], v148 offset:38912
  ds_read_b64_tr_b16 v[42:43], v148 offset:39936
  s_mov_b32 s71, 10240
  buffer_store_dword v13, v14, s[36:39], s71 offen sc1
  buffer_load_dwordx2 v[128:129], v145, s[24:27], 0 offen offset:0
  s_add_u32 m0, s81, 32768
  v_readlane_b32 s84, v9, 16
  s_waitcnt lgkmcnt(2)
  v_mfma_f32_32x32x16_bf16 v[80:95], v[36:39], v[160:163], 0
  ds_read_b64_tr_b16 v[44:45], v149 offset:38912
  ds_read_b64_tr_b16 v[46:47], v149 offset:39936
  buffer_load_dwordx2 v[130:131], v145, s[24:27], 0 offen offset:16
  s_waitcnt lgkmcnt(2)
  v_mfma_f32_32x32x16_bf16 v[64:79], v[40:43], v[164:167], v[64:79]
  ds_read_b64_tr_b16 v[32:33], v148 offset:45056
  ds_read_b64_tr_b16 v[34:35], v148 offset:46080
  buffer_load_dwordx2 v[132:133], v145, s[24:27], 0 offen offset:32
  s_waitcnt vmcnt(5)
  v_cmp_ne_u32 vcc, s56, v62
  s_nop 0
  s_cbranch_vccnz L_slow5
L_back5:
  v_readlane_b32 s90, v3, 18
  s_waitcnt lgkmcnt(2)
  v_mfma_f32_32x32x16_bf16 v[80:95], v[44:47], v[164:167], v[80:95]
  ds_read_b64_tr_b16 v[36:37], v149 offset:45056
  ds_read_b64_tr_b16 v[38:39], v149 offset:46080
  buffer_load_dwordx2 v[134:135], v145, s[24:27], 0 offen offset:48
  s_waitcnt lgkmcnt(2)
  v_mfma_f32_32x32x16_bf16 v[64:79], v[32:35], v[168:171], v[64:79]
  ds_read_b64_tr_b16 v[40:41], v148 offset:47104
  ds_read_b64_tr_b16 v[42:43], v148 offset:48128
  buffer_load_dwordx4 v[224:227], v60, s[36:39], s88 offen sc1
  v_readlane_b32 s91, v3, 19
  s_waitcnt lgkmcnt(2)
  v_mfma_f32_32x32x16_bf16 v[80:95], v[36:39], v[168:171], v[80:95]
  ds_read_b64_tr_b16 v[44:45], v149 offset:47104
  ds_read_b64_tr_b16 v[46:47], v149 offset:48128
  buffer_load_dwordx4 v[228:231], v60, s[36:39], s89 offen sc1
  v_readlane_b32 s88, v3, 20
  s_waitcnt lgkmcnt(2)
  v_mfma_f32_32x32x16_bf16 v[64:79], v[40:43], v[172:175], v[64:79]
  ds_read_b64_tr_b16 v[32:33], v148 offset:53248
  ds_read_b64_tr_b16 v[34:35], v148 offset:54272
  buffer_load_dwordx4 v56, s[40:43], s87 offen lds
  s_waitcnt lgkmcnt(2)
  v_mfma_f32_32x32x16_bf16 v[80:95], v[44:47], v[172:175], v[80:95]
  ds_read_b64_tr_b16 v[36:37], v149 offset:53248
  ds_read_b64_tr_b16 v[38:39], v149 offset:54272
  buffer_load_dwordx4 v57, s[40:43], s87 offen offset:1024 lds
  s_add_u32 m0, s81, 40960
  v_readlane_b32 s85, v9, 17
  s_waitcnt lgkmcnt(2)
  v_mfma_f32_32x32x16_bf16 v[64:79], v[32:35], v[176:179], v[64:79]
  ds_read_b64_tr_b16 v[40:41], v148 offset:55296
  ds_read_b64_tr_b16 v[42:43], v148 offset:56320
  buffer_load_dwordx4 v[232:235], v60, s[36:39], s90 offen sc1
  v_readlane_b32 s89, v3, 21
  s_waitcnt lgkmcnt(2)
  v_mfma_f32_32x32x16_bf16 v[80:95], v[36:39], v[176:179], v[80:95]
  ds_read_b64_tr_b16 v[44:45], v149 offset:55296
  ds_read_b64_tr_b16 v[46:47], v149 offset:56320
  buffer_load_dwordx4 v[236:239], v60, s[36:39], s91 offen sc1
  v_readlane_b32 s90, v3, 22
  s_waitcnt lgkmcnt(2)
  v_mfma_f32_32x32x16_bf16 v[64:79], v[40:43], v[180:183], v[64:79]
  ds_read_b64_tr_b16 v[32:33], v148 offset:61440
  ds_read_b64_tr_b16 v[34:35], v148 offset:62464
  buffer_load_dwordx4 v56, s[40:43], s84 offen lds
  s_waitcnt lgkmcnt(2)
  v_mfma_f32_32x32x16_bf16 v[80:95], v[44:47], v[180:183], v[80:95]
  ds_read_b64_tr_b16 v[36:37], v149 offset:61440
  ds_read_b64_tr_b16 v[38:39], v149 offset:62464
  buffer_load_dwordx4 v57, s[40:43], s84 offen offset:1024 lds
  s_add_u32 m0, s81, 49152
  v_readlane_b32 s86, v9, 18
  s_waitcnt lgkmcnt(2)
  v_mfma_f32_32x32x16_bf16 v[64:79], v[32:35], v[184:187], v[64:79]
  ds_read_b64_tr_b16 v[40:41], v148 offset:63488
  ds_read_b64_tr_b16 v[42:43], v148 offset:64512
  buffer_load_dwordx4 v[240:243], v60, s[36:39], s88 offen sc1
  v_readlane_b32 s91, v3, 23
  s_waitcnt lgkmcnt(2)
  v_mfma_f32_32x32x16_bf16 v[80:95], v[36:39], v[184:187], v[80:95]
  ds_read_b64_tr_b16 v[44:45], v149 offset:63488
  ds_read_b64_tr_b16 v[46:47], v149 offset:64512
  buffer_load_dwordx4 v[244:247], v60, s[36:39], s89 offen sc1
  v_readlane_b32 s88, v3, 24
  s_waitcnt lgkmcnt(2)
  v_mfma_f32_32x32x16_bf16 v[64:79], v[40:43], v[188:191], v[64:79]
  s_waitcnt lgkmcnt(0)
  s_barrier
  ds_read_b64_tr_b16 v[32:33], v150 offset:4096
  buffer_load_dwordx4 v56, s[40:43], s85 offen lds
  v_mfma_f32_32x32x16_bf16 v[80:95], v[44:47], v[188:191], v[80:95]
  ds_read_b64_tr_b16 v[34:35], v150 offset:5120
  ds_read_b64_tr_b16 v[36:37], v151 offset:4096
  ds_read_b64_tr_b16 v[38:39], v151 offset:5120
  buffer_load_dwordx4 v57, s[40:43], s85 offen offset:1024 lds
  s_add_u32 m0, s81, 57344
  v_readlane_b32 s87, v9, 19
  s_waitcnt lgkmcnt(2)
  v_mfma_f32_32x32x16_bf16 v[64:79], v[32:35], v[192:195], v[64:79]
  ds_read_b64_tr_b16 v[40:41], v150 offset:6144
  ds_read_b64_tr_b16 v[42:43], v150 offset:7168
  buffer_load_dwordx4 v[248:251], v60, s[36:39], s90 offen sc1
  v_readlane_b32 s89, v3, 25
  s_waitcnt lgkmcnt(2)
  v_mfma_f32_32x32x16_bf16 v[80:95], v[36:39], v[192:195], v[80:95]
  ds_read_b64_tr_b16 v[44:45], v151 offset:6144
  ds_read_b64_tr_b16 v[46:47], v151 offset:7168
  buffer_load_dwordx4 v[252:255], v60, s[36:39], s91 offen sc1
  v_readlane_b32 s90, v3, 26
  s_waitcnt lgkmcnt(2)
  v_mfma_f32_32x32x16_bf16 v[64:79], v[40:43], v[196:199], v[64:79]
  ds_read_b64_tr_b16 v[32:33], v150 offset:12288
  ds_read_b64_tr_b16 v[34:35], v150 offset:13312
  buffer_load_dwordx4 v56, s[40:43], s86 offen lds
  s_waitcnt lgkmcnt(2)
  v_mfma_f32_32x32x16_bf16 v[80:95], v[44:47], v[196:199], v[80:95]
  ds_read_b64_tr_b16 v[36:37], v151 offset:12288
  ds_read_b64_tr_b16 v[38:39], v151 offset:13312
  buffer_load_dwordx4 v57, s[40:43], s86 offen offset:1024 lds
  s_add_u32 m0, s81, 102400
  v_readlane_b32 s84, v9, 20
  s_waitcnt lgkmcnt(2)
  v_mfma_f32_32x32x16_bf16 v[64:79], v[32:35], v[200:203], v[64:79]
  ds_read_b64_tr_b16 v[40:41], v150 offset:14336
  ds_read_b64_tr_b16 v[42:43], v150 offset:15360
  buffer_load_dwordx4 v[160:163], v60, s[36:39], s88 offen sc1
  v_readlane_b32 s91, v3, 27
  s_waitcnt lgkmcnt(2)
  v_mfma_f32_32x32x16_bf16 v[80:95], v[36:39], v[200:203], v[80:95]
  ds_read_b64_tr_b16 v[44:45], v151 offset:14336
  ds_read_b64_tr_b16 v[46:47], v151 offset:15360
  buffer_load_dwordx4 v[164:167], v60, s[36:39], s89 offen sc1
  v_readlane_b32 s88, v3, 28
  s_waitcnt lgkmcnt(2)
  v_mfma_f32_32x32x16_bf16 v[64:79], v[40:43], v[204:207], v[64:79]
  ds_read_b64_tr_b16 v[32:33], v150 offset:20480
  ds_read_b64_tr_b16 v[34:35], v150 offset:21504
  buffer_load_dwordx4 v56, s[40:43], s87 offen lds
  s_waitcnt lgkmcnt(2)
  v_mfma_f32_32x32x16_bf16 v[80:95], v[44:47], v[204:207], v[80:95]
  ds_read_b64_tr_b16 v[36:37], v151 offset:20480
  ds_read_b64_tr_b16 v[38:39], v151 offset:21504
  buffer_load_dwordx4 v57, s[40:43], s87 offen offset:1024 lds
  s_add_u32 m0, s81, 110592
  v_readlane_b32 s85, v9, 21
  s_waitcnt lgkmcnt(2)
  v_mfma_f32_32x32x16_bf16 v[64:79], v[32:35], v[208:211], v[64:79]
  ds_read_b64_tr_b16 v[40:41], v150 offset:22528
  ds_read_b64_tr_b16 v[42:43], v150 offset:23552
  buffer_load_dwordx4 v[168:171], v60, s[36:39], s90 offen sc1
  v_readlane_b32 s89, v3, 29
  s_waitcnt lgkmcnt(2)
  v_mfma_f32_32x32x16_bf16 v[80:95], v[36:39], v[208:211], v[80:95]
  ds_read_b64_tr_b16 v[44:45], v151 offset:22528
  ds_read_b64_tr_b16 v[46:47], v151 offset:23552
  buffer_load_dwordx4 v[172:175], v60, s[36:39], s91 offen sc1
  v_readlane_b32 s90, v3, 30
  s_waitcnt lgkmcnt(2)
  v_mfma_f32_32x32x16_bf16 v[64:79], v[40:43], v[212:215], v[64:79]
  ds_read_b64_tr_b16 v[32:33], v58 offset:0
  ds_read_b64_tr_b16 v[34:35], v58 offset:1024
  buffer_load_dwordx4 v56, s[44:47], s84 offen lds
  s_waitcnt lgkmcnt(2)
  v_mfma_f32_32x32x16_bf16 v[80:95], v[44:47], v[212:215], v[80:95]
  ds_read_b64_tr_b16 v[36:37], v59 offset:0
  ds_read_b64_tr_b16 v[38:39], v59 offset:1024
  buffer_load_dwordx4 v57, s[44:47], s84 offen offset:1024 lds
  s_add_u32 m0, s81, 118784
  v_readlane_b32 s86, v9, 22
  s_waitcnt lgkmcnt(2)
  v_mfma_f32_32x32x16_bf16 v[64:79], v[32:35], v[216:219], v[64:79]
  ds_read_b64_tr_b16 v[40:41], v58 offset:2048
  ds_read_b64_tr_b16 v[42:43], v58 offset:3072
  buffer_load_dwordx4 v[176:179], v60, s[36:39], s88 offen sc1
  v_readlane_b32 s91, v3, 31
  s_waitcnt lgkmcnt(2)
  v_mfma_f32_32x32x16_bf16 v[80:95], v[36:39], v[216:219], v[80:95]
  ds_read_b64_tr_b16 v[44:45], v59 offset:2048
  ds_read_b64_tr_b16 v[46:47], v59 offset:3072
  buffer_load_dwordx4 v[180:183], v60, s[36:39], s89 offen sc1
  v_readlane_b32 s88, v3, 32
  s_waitcnt lgkmcnt(2)
  v_mfma_f32_32x32x16_bf16 v[64:79], v[40:43], v[220:223], v[64:79]
  s_waitcnt vmcnt(31) lgkmcnt(0)
  s_barrier
  ds_read_b64_tr_b16 v[32:33], v58 offset:8192
  s_mov_b32 s71, 11264
  buffer_store_dword v13, v14, s[36:39], s71 offen sc1
  v_mfma_f32_32x32x16_bf16 v[80:95], v[44:47], v[220:223], v[80:95]
  ds_read_b64_tr_b16 v[34:35], v58 offset:9216
  ds_read_b64_tr_b16 v[36:37], v59 offset:8192
  ds_read_b64_tr_b16 v[38:39], v59 offset:9216
  buffer_load_dwordx4 v56, s[44:47], s85 offen lds
  s_waitcnt vmcnt(27) lgkmcnt(2)
  v_mfma_f32_32x32x16_bf16 v[64:79], v[32:35], v[224:227], v[64:79]
  ds_read_b64_tr_b16 v[40:41], v58 offset:10240
  ds_read_b64_tr_b16 v[42:43], v58 offset:11264
  buffer_load_dwordx4 v[184:187], v60, s[36:39], s90 offen sc1
  s_cmp_lt_u32 s52, 2
  s_mov_b32 s82, 10240
  s_cselect_b32 s82, 10240, s82
  s_waitcnt lgkmcnt(2)
  v_mfma_f32_32x32x16_bf16 v[80:95], v[36:39], v[224:227], v[80:95]
  ds_read_b64_tr_b16 v[44:45], v59 offset:10240
  ds_read_b64_tr_b16 v[46:47], v59 offset:11264
  buffer_load_dword v62, v61, s[36:39], s82 offen sc1
  v_readlane_b32 s89, v3, 33
  s_waitcnt vmcnt(28) lgkmcnt(2)
  v_mfma_f32_32x32x16_bf16 v[64:79], v[40:43], v[228:231], v[64:79]
  ds_read_b64_tr_b16 v[32:33], v58 offset:16384
  ds_read_b64_tr_b16 v[34:35], v58 offset:17408
  buffer_load_dwordx4 v[188:191], v60, s[36:39], s91 offen sc1
  s_waitcnt vmcnt(1)
  v_cmp_ne_u32 vcc, s56, v62
  s_nop 0
  s_cbranch_vccnz L_slow6
L_back6:
  s_waitcnt lgkmcnt(2)
  v_mfma_f32_32x32x16_bf16 v[80:95], v[44:47], v[228:231], v[80:95]
  ds_read_b64_tr_b16 v[36:37], v59 offset:16384
  ds_read_b64_tr_b16 v[38:39], v59 offset:17408
  s_cmp_lt_u32 s52, 2
  s_mov_b32 s82, 10240
  s_cselect_b32 s82, 12352, s82
  buffer_load_dword v62, v61, s[36:39], s82 offen sc1
  v_readlane_b32 s90, v3, 34
  s_waitcnt lgkmcnt(2)
  v_mfma_f32_32x32x16_bf16 v[64:79], v[32:35], v[232:235], v[64:79]
  ds_read_b64_tr_b16 v[40:41], v58 offset:18432
  ds_read_b64_tr_b16 v[42:43], v58 offset:19456
  buffer_load_dwordx4 v[192:195], v60, s[36:39], s88 offen sc1
  v_readlane_b32 s91, v3, 35
  s_waitcnt lgkmcnt(2)
  v_mfma_f32_32x32x16_bf16 v[80:95], v[36:39], v[232:235], v[80:95]
  ds_read_b64_tr_b16 v[44:45], v59 offset:18432
  ds_read_b64_tr_b16 v[46:47], v59 offset:19456
  buffer_load_dwordx4 v[196:199], v60, s[36:39], s89 offen sc1
  v_readlane_b32 s88, v3, 36
  s_waitcnt lgkmcnt(2)
  v_mfma_f32_32x32x16_bf16 v[64:79], v[40:43], v[236:239], v[64:79]
  ds_read_b64_tr_b16 v[32:33], v58 offset:24576
  ds_read_b64_tr_b16 v[34:35], v58 offset:25600
  buffer_load_dwordx4 v57, s[44:47], s85 offen offset:1024 lds
  s_add_u32 m0, s81, 126976
  v_readlane_b32 s87, v9, 23
  s_waitcnt lgkmcnt(2)
  v_mfma_f32_32x32x16_bf16 v[80:95], v[44:47], v[236:239], v[80:95]
  ds_read_b64_tr_b16 v[36:37], v59 offset:24576
  ds_read_b64_tr_b16 v[38:39], v59 offset:25600
  buffer_load_dwordx4 v56, s[44:47], s86 offen lds
  s_waitcnt lgkmcnt(2)
  v_mfma_f32_32x32x16_bf16 v[64:79], v[32:35], v[240:243], v[64:79]
  ds_read_b64_tr_b16 v[40:41], v58 offset:26624
  ds_read_b64_tr_b16 v[42:43], v58 offset:27648
  buffer_load_dwordx4 v[200:203], v60, s[36:39], s90 offen sc1
  v_readlane_b32 s89, v3, 37
  v_lshlrev_b32 v48, 16, v128
  v_lshlrev_b32 v50, 16, v129
  s_waitcnt lgkmcnt(2)
  v_mfma_f32_32x32x16_bf16 v[80:95], v[36:39], v[240:243], v[80:95]
  ds_read_b64_tr_b16 v[44:45], v59 offset:26624
  ds_read_b64_tr_b16 v[46:47], v59 offset:27648
  buffer_load_dwordx4 v[204:207], v60, s[36:39], s91 offen sc1
  v_readlane_b32 s90, v3, 38
  v_lshlrev_b32 v52, 16, v130
  v_lshlrev_b32 v54, 16, v131
  s_waitcnt lgkmcnt(2)
  v_mfma_f32_32x32x16_bf16 v[64:79], v[40:43], v[244:247], v[64:79]
  ds_read_b64_tr_b16 v[32:33], v148 offset:0
  ds_read_b64_tr_b16 v[34:35], v148 offset:1024
  v_lshlrev_b32 v136, 16, v132
  v_lshlrev_b32 v138, 16, v133
  v_lshlrev_b32 v140, 16, v134
  v_lshlrev_b32 v142, 16, v135
  v_and_b32 v49, 0xffff0000, v128
  s_waitcnt lgkmcnt(2)
  v_mfma_f32_32x32x16_bf16 v[80:95], v[44:47], v[244:247], v[80:95]
  ds_read_b64_tr_b16 v[36:37], v149 offset:0
  ds_read_b64_tr_b16 v[38:39], v149 offset:1024
  v_and_b32 v51, 0xffff0000, v129
  v_and_b32 v53, 0xffff0000, v130
  v_and_b32 v55, 0xffff0000, v131
  v_and_b32 v137, 0xffff0000, v132
  v_and_b32 v139, 0xffff0000, v133
  s_waitcnt lgkmcnt(2)
  v_mfma_f32_32x32x16_bf16 v[64:79], v[32:35], v[248:251], v[64:79]
  ds_read_b64_tr_b16 v[40:41], v148 offset:2048
  ds_read_b64_tr_b16 v[42:43], v148 offset:3072
  buffer_load_dwordx4 v[208:211], v60, s[36:39], s88 offen sc1
  v_readlane_b32 s91, v3, 39
  buffer_load_dwordx4 v[212:215], v60, s[36:39], s89 offen sc1
  s_waitcnt lgkmcnt(2)
  v_mfma_f32_32x32x16_bf16 v[80:95], v[36:39], v[248:251], v[80:95]
  ds_read_b64_tr_b16 v[44:45], v149 offset:2048
  ds_read_b64_tr_b16 v[46:47], v149 offset:3072
  v_readlane_b32 s88, v3, 40
  buffer_load_dwordx4 v[216:219], v60, s[36:39], s90 offen sc1
  v_readlane_b32 s89, v3, 41
  v_and_b32 v141, 0xffff0000, v134
  s_waitcnt lgkmcnt(2)
  v_mfma_f32_32x32x16_bf16 v[64:79], v[40:43], v[252:255], v[64:79]
  s_waitcnt lgkmcnt(0)
  s_barrier
  ds_read_b64_tr_b16 v[32:33], v148 offset:8192
  v_and_b32 v143, 0xffff0000, v135
  buffer_load_dwordx4 v57, s[44:47], s86 offen offset:1024 lds
  v_mfma_f32_32x32x16_bf16 v[80:95], v[44:47], v[252:255], v[80:95]
  ds_read_b64_tr_b16 v[34:35], v148 offset:9216
  ds_read_b64_tr_b16 v[36:37], v149 offset:8192
  ds_read_b64_tr_b16 v[38:39], v149 offset:9216
  s_add_u32 m0, s81, 135168
  v_readlane_b32 s84, v9, 24
  buffer_load_dwordx4 v56, s[44:47], s87 offen lds
  s_waitcnt lgkmcnt(2)
  v_mfma_f32_32x32x16_bf16 v[64:79], v[32:35], v[160:163], v[64:79]
  ds_read_b64_tr_b16 v[40:41], v148 offset:10240
  ds_read_b64_tr_b16 v[42:43], v148 offset:11264
  buffer_load_dwordx4 v57, s[44:47], s87 offen offset:1024 lds
  s_add_u32 m0, s81, 143360
  v_readlane_b32 s85, v9, 25
  s_waitcnt lgkmcnt(2)
  v_mfma_f32_32x32x16_bf16 v[80:95], v[36:39], v[160:163], v[80:95]
  ds_read_b64_tr_b16 v[44:45], v149 offset:10240
  ds_read_b64_tr_b16 v[46:47], v149 offset:11264
  buffer_load_dwordx4 v56, s[44:47], s84 offen lds
  s_waitcnt lgkmcnt(2)
  v_mfma_f32_32x32x16_bf16 v[64:79], v[40:43], v[164:167], v[64:79]
  ds_read_b64_tr_b16 v[32:33], v148 offset:16384
  ds_read_b64_tr_b16 v[34:35], v148 offset:17408
  buffer_load_dwordx4 v[220:223], v60, s[36:39], s91 offen sc1
  s_waitcnt vmcnt(14)
  v_cmp_ne_u32 vcc, s56, v62
  s_nop 0
  s_cbranch_vccnz L_slow7
L_back7:
  s_waitcnt lgkmcnt(2)
  v_mfma_f32_32x32x16_bf16 v[80:95], v[44:47], v[164:167], v[80:95]
  ds_read_b64_tr_b16 v[36:37], v149 offset:16384
  ds_read_b64_tr_b16 v[38:39], v149 offset:17408
  v_readlane_b32 s90, v3, 42
  buffer_load_dwordx4 v[224:227], v60, s[36:39], s88 offen sc1
  v_readlane_b32 s91, v3, 43
  s_waitcnt lgkmcnt(2)
  v_mfma_f32_32x32x16_bf16 v[64:79], v[32:35], v[168:171], v[64:79]
  ds_read_b64_tr_b16 v[40:41], v148 offset:18432
  ds_read_b64_tr_b16 v[42:43], v148 offset:19456
  buffer_load_dwordx4 v57, s[44:47], s84 offen offset:1024 lds
  s_add_u32 m0, s81, 151552
  v_readlane_b32 s86, v9, 26
  s_waitcnt lgkmcnt(2)
  v_mfma_f32_32x32x16_bf16 v[80:95], v[36:39], v[168:171], v[80:95]
  ds_read_b64_tr_b16 v[44:45], v149 offset:18432
  ds_read_b64_tr_b16 v[46:47], v149 offset:19456
  buffer_load_dwordx4 v56, s[44:47], s85 offen lds
  s_waitcnt lgkmcnt(2)
  v_mfma_f32_32x32x16_bf16 v[64:79], v[40:43], v[172:175], v[64:79]
  ds_read_b64_tr_b16 v[32:33], v148 offset:24576
  ds_read_b64_tr_b16 v[34:35], v148 offset:25600
  buffer_load_dwordx4 v[228:231], v60, s[36:39], s89 offen sc1
  v_readlane_b32 s88, v3, 44
  s_waitcnt lgkmcnt(2)
  v_mfma_f32_32x32x16_bf16 v[80:95], v[44:47], v[172:175], v[80:95]
  ds_read_b64_tr_b16 v[36:37], v149 offset:24576
  ds_read_b64_tr_b16 v[38:39], v149 offset:25600
  buffer_load_dwordx4 v[232:235], v60, s[36:39], s90 offen sc1
  v_readlane_b32 s89, v3, 45
  s_waitcnt lgkmcnt(2)
  v_mfma_f32_32x32x16_bf16 v[64:79], v[32:35], v[176:179], v[64:79]
  ds_read_b64_tr_b16 v[40:41], v148 offset:26624
  ds_read_b64_tr_b16 v[42:43], v148 offset:27648
  buffer_load_dwordx4 v57, s[44:47], s85 offen offset:1024 lds
  s_add_u32 m0, s81, 0
  v_readlane_b32 s87, v9, 27
  s_waitcnt lgkmcnt(2)
  v_mfma_f32_32x32x16_bf16 v[80:95], v[36:39], v[176:179], v[80:95]
  ds_read_b64_tr_b16 v[44:45], v149 offset:26624
  ds_read_b64_tr_b16 v[46:47], v149 offset:27648
  buffer_load_dwordx4 v56, s[44:47], s86 offen lds
  s_waitcnt lgkmcnt(2)
  v_mfma_f32_32x32x16_bf16 v[64:79], v[40:43], v[180:183], v[64:79]
  ds_read_b64_tr_b16 v[32:33], v58 offset:32768
  ds_read_b64_tr_b16 v[34:35], v58 offset:33792
  buffer_load_dwordx4 v[236:239], v60, s[36:39], s91 offen sc1
  v_readlane_b32 s90, v3, 46
  s_waitcnt lgkmcnt(2)
  v_mfma_f32_32x32x16_bf16 v[80:95], v[44:47], v[180:183], v[80:95]
  ds_read_b64_tr_b16 v[36:37], v59 offset:32768
  ds_read_b64_tr_b16 v[38:39], v59 offset:33792
  buffer_load_dwordx4 v[240:243], v60, s[36:39], s88 offen sc1
  v_readlane_b32 s91, v3, 47
  s_waitcnt lgkmcnt(2)
  v_mfma_f32_32x32x16_bf16 v[64:79], v[32:35], v[184:187], v[64:79]
  ds_read_b64_tr_b16 v[40:41], v58 offset:34816
  ds_read_b64_tr_b16 v[42:43], v58 offset:35840
  buffer_load_dwordx4 v57, s[44:47], s86 offen offset:1024 lds
  s_add_u32 m0, s81, 8192
  v_readlane_b32 s84, v9, 28
  s_waitcnt lgkmcnt(2)
  v_mfma_f32_32x32x16_bf16 v[80:95], v[36:39], v[184:187], v[80:95]
  ds_read_b64_tr_b16 v[44:45], v59 offset:34816
  ds_read_b64_tr_b16 v[46:47], v59 offset:35840
  buffer_load_dwordx4 v56, s[44:47], s87 offen lds
  s_waitcnt lgkmcnt(2)
  v_mfma_f32_32x32x16_bf16 v[64:79], v[40:43], v[188:191], v[64:79]
  s_waitcnt lgkmcnt(0)
  s_barrier
  ds_read_b64_tr_b16 v[32:33], v58 offset:40960
  buffer_load_dwordx4 v[244:247], v60, s[36:39], s89 offen sc1
  v_readlane_b32 s88, v3, 48
  v_mfma_f32_32x32x16_bf16 v[80:95], v[44:47], v[188:191], v[80:95]
  ds_read_b64_tr_b16 v[34:35], v58 offset:41984
  ds_read_b64_tr_b16 v[36:37], v59 offset:40960
  ds_read_b64_tr_b16 v[38:39], v59 offset:41984
  buffer_load_dwordx4 v[248:251], v60, s[36:39], s90 offen sc1
  v_readlane_b32 s89, v3, 49
  s_waitcnt vmcnt(26) lgkmcnt(2)
  v_mfma_f32_32x32x16_bf16 v[64:79], v[32:35], v[192:195], v[64:79]
  ds_read_b64_tr_b16 v[40:41], v58 offset:43008
  ds_read_b64_tr_b16 v[42:43], v58 offset:44032
  buffer_load_dwordx4 v57, s[44:47], s87 offen offset:1024 lds
  s_add_u32 m0, s81, 16384
  v_readlane_b32 s85, v9, 29
  s_waitcnt lgkmcnt(2)
  v_mfma_f32_32x32x16_bf16 v[80:95], v[36:39], v[192:195], v[80:95]
  ds_read_b64_tr_b16 v[44:45], v59 offset:43008
  ds_read_b64_tr_b16 v[46:47], v59 offset:44032
  buffer_load_dwordx4 v56, s[44:47], s84 offen lds
  s_waitcnt vmcnt(27) lgkmcnt(2)
  v_mfma_f32_32x32x16_bf16 v[64:79], v[40:43], v[196:199], v[64:79]
  ds_read_b64_tr_b16 v[32:33], v58 offset:49152
  ds_read_b64_tr_b16 v[34:35], v58 offset:50176
  buffer_load_dwordx4 v[252:255], v60, s[36:39], s91 offen sc1
  v_readlane_b32 s90, v3, 50
  s_waitcnt lgkmcnt(2)
  v_mfma_f32_32x32x16_bf16 v[80:95], v[44:47], v[196:199], v[80:95]
  ds_read_b64_tr_b16 v[36:37], v59 offset:49152
  ds_read_b64_tr_b16 v[38:39], v59 offset:50176
  buffer_load_dwordx4 v[160:163], v60, s[36:39], s88 offen sc1
  v_readlane_b32 s91, v3, 51
  s_waitcnt vmcnt(26) lgkmcnt(2)
  v_mfma_f32_32x32x16_bf16 v[64:79], v[32:35], v[200:203], v[64:79]
  ds_read_b64_tr_b16 v[40:41], v58 offset:51200
  ds_read_b64_tr_b16 v[42:43], v58 offset:52224
  buffer_load_dwordx4 v57, s[44:47], s84 offen offset:1024 lds
  s_add_u32 m0, s81, 24576
  v_readlane_b32 s86, v9, 30
  s_waitcnt lgkmcnt(2)
  v_mfma_f32_32x32x16_bf16 v[80:95], v[36:39], v[200:203], v[80:95]
  ds_read_b64_tr_b16 v[44:45], v59 offset:51200
  ds_read_b64_tr_b16 v[46:47], v59 offset:52224
  buffer_load_dwordx4 v56, s[44:47], s85 offen lds
  s_waitcnt vmcnt(27) lgkmcnt(2)
  v_mfma_f32_32x32x16_bf16 v[64:79], v[40:43], v[204:207], v[64:79]
  ds_read_b64_tr_b16 v[32:33], v58 offset:57344
  ds_read_b64_tr_b16 v[34:35], v58 offset:58368
  buffer_load_dwordx4 v[164:167], v60, s[36:39], s89 offen sc1
  v_readlane_b32 s88, v3, 52
  s_waitcnt lgkmcnt(2)
  v_mfma_f32_32x32x16_bf16 v[80:95], v[44:47], v[204:207], v[80:95]
  ds_read_b64_tr_b16 v[36:37], v59 offset:57344
  ds_read_b64_tr_b16 v[38:39], v59 offset:58368
  buffer_load_dwordx4 v[168:171], v60, s[36:39], s90 offen sc1
  v_readlane_b32 s89, v3, 53
  s_waitcnt vmcnt(28) lgkmcnt(2)
  v_mfma_f32_32x32x16_bf16 v[64:79], v[32:35], v[208:211], v[64:79]
  ds_read_b64_tr_b16 v[40:41], v58 offset:59392
  ds_read_b64_tr_b16 v[42:43], v58 offset:60416
  buffer_load_dwordx4 v57, s[44:47], s85 offen offset:1024 lds
  s_add_u32 m0, s81, 65536
  v_readlane_b32 s87, v9, 31
  s_waitcnt lgkmcnt(2)
  v_mfma_f32_32x32x16_bf16 v[80:95], v[36:39], v[208:211], v[80:95]
  ds_read_b64_tr_b16 v[44:45], v59 offset:59392
  ds_read_b64_tr_b16 v[46:47], v59 offset:60416
  buffer_load_dwordx4 v56, s[44:47], s86 offen lds
  s_waitcnt vmcnt(29) lgkmcnt(2)
  v_mfma_f32_32x32x16_bf16 v[64:79], v[40:43], v[212:215], v[64:79]
  ds_read_b64_tr_b16 v[32:33], v148 offset:36864
  ds_read_b64_tr_b16 v[34:35], v148 offset:37888
  buffer_load_dwordx4 v[172:175], v60, s[36:39], s91 offen sc1
  v_readlane_b32 s90, v3, 54
  s_waitcnt lgkmcnt(2)
  v_mfma_f32_32x32x16_bf16 v[80:95], v[44:47], v[212:215], v[80:95]
  ds_read_b64_tr_b16 v[36:37], v149 offset:36864
  ds_read_b64_tr_b16 v[38:39], v149 offset:37888
  buffer_load_dwordx4 v[176:179], v60, s[36:39], s88 offen sc1
  v_readlane_b32 s91, v3, 55
  s_waitcnt vmcnt(30) lgkmcnt(2)
  v_mfma_f32_32x32x16_bf16 v[64:79], v[32:35], v[216:219], v[64:79]
  ds_read_b64_tr_b16 v[40:41], v148 offset:38912
  ds_read_b64_tr_b16 v[42:43], v148 offset:39936
  buffer_load_dwordx4 v57, s[44:47], s86 offen offset:1024 lds
  s_add_u32 m0, s81, 73728
  v_readlane_b32 s84, v9, 32
  s_waitcnt lgkmcnt(2)
  v_mfma_f32_32x32x16_bf16 v[80:95], v[36:39], v[216:219], v[80:95]
  ds_read_b64_tr_b16 v[44:45], v149 offset:38912
  ds_read_b64_tr_b16 v[46:47], v149 offset:39936
  buffer_load_dwordx4 v56, s[44:47], s87 offen lds
  s_waitcnt vmcnt(27) lgkmcnt(2)
  v_mfma_f32_32x32x16_bf16 v[64:79], v[40:43], v[220:223], v[64:79]
  s_waitcnt lgkmcnt(0)
  s_barrier
  ds_read_b64_tr_b16 v[32:33], v148 offset:45056
  buffer_load_dwordx4 v[180:183], v60, s[36:39], s89 offen sc1
  v_readlane_b32 s88, v3, 56
  v_mfma_f32_32x32x16_bf16 v[80:95], v[44:47], v[220:223], v[80:95]
  ds_read_b64_tr_b16 v[34:35], v148 offset:46080
  ds_read_b64_tr_b16 v[36:37], v149 offset:45056
  ds_read_b64_tr_b16 v[38:39], v149 offset:46080
  buffer_load_dwordx4 v[184:187], v60, s[36:39], s90 offen sc1
  s_waitcnt vmcnt(28) lgkmcnt(2)
  v_mfma_f32_32x32x16_bf16 v[96:111], v[32:35], v[224:227], 0
  ds_read_b64_tr_b16 v[40:41], v148 offset:47104
  ds_read_b64_tr_b16 v[42:43], v148 offset:48128
  buffer_load_dwordx4 v57, s[44:47], s87 offen offset:1024 lds
  s_add_u32 m0, s81, 81920
  v_readlane_b32 s85, v9, 33
  s_waitcnt lgkmcnt(2)
  v_mfma_f32_32x32x16_bf16 v[112:127], v[36:39], v[224:227], 0
  ds_read_b64_tr_b16 v[44:45], v149 offset:47104
  ds_read_b64_tr_b16 v[46:47], v149 offset:48128
  buffer_load_dwordx4 v56, s[44:47], s84 offen lds
  s_cmp_lt_u32 s52, 2
  s_mov_b32 s82, 11264
  s_cselect_b32 s82, 13376, s82
  s_waitcnt vmcnt(27) lgkmcnt(2)
  v_mfma_f32_32x32x16_bf16 v[96:111], v[40:43], v[228:231], v[96:111]
  ds_read_b64_tr_b16 v[32:33], v148 offset:53248
  ds_read_b64_tr_b16 v[34:35], v148 offset:54272
  buffer_load_dword v62, v61, s[36:39], s82 offen sc1
  v_readlane_b32 s89, v3, 57
  s_waitcnt lgkmcnt(2)
  v_mfma_f32_32x32x16_bf16 v[112:127], v[44:47], v[228:231], v[112:127]
  ds_read_b64_tr_b16 v[36:37], v149 offset:53248
  ds_read_b64_tr_b16 v[38:39], v149 offset:54272
  buffer_load_dwordx4 v[188:191], v60, s[36:39], s91 offen sc1
  s_waitcnt vmcnt(1)
  v_cmp_ne_u32 vcc, s56, v62
  s_nop 0
  s_cbranch_vccnz L_slow8
L_back8:
  s_waitcnt lgkmcnt(2)
  v_mfma_f32_32x32x16_bf16 v[96:111], v[32:35], v[232:235], v[96:111]
  ds_read_b64_tr_b16 v[40:41], v148 offset:55296
  ds_read_b64_tr_b16 v[42:43], v148 offset:56320
  v_readlane_b32 s90, v3, 58
  buffer_load_dwordx4 v[192:195], v60, s[36:39], s88 offen sc1
  v_readlane_b32 s91, v3, 59
  s_waitcnt lgkmcnt(2)
  v_mfma_f32_32x32x16_bf16 v[112:127], v[36:39], v[232:235], v[112:127]
  ds_read_b64_tr_b16 v[44:45], v149 offset:55296
  ds_read_b64_tr_b16 v[46:47], v149 offset:56320
  buffer_load_dwordx4 v[196:199], v60, s[36:39], s89 offen sc1
  v_readlane_b32 s88, v3, 60
  ds_write_b128 v146, v[80:83] offset:49152
  s_waitcnt lgkmcnt(3)
  v_mfma_f32_32x32x16_bf16 v[96:111], v[40:43], v[236:239], v[96:111]
  ds_read_b64_tr_b16 v[32:33], v148 offset:61440
  ds_read_b64_tr_b16 v[34:35], v148 offset:62464
  ds_write_b128 v146, v[84:87] offset:50176
  ds_write_b128 v146, v[88:91] offset:51200
  s_waitcnt lgkmcnt(5)
  v_mfma_f32_32x32x16_bf16 v[112:127], v[44:47], v[236:239], v[112:127]
  ds_read_b64_tr_b16 v[36:37], v149 offset:61440
  ds_read_b64_tr_b16 v[38:39], v149 offset:62464
  ds_write_b128 v146, v[92:95] offset:52224
  buffer_load_dwordx4 v57, s[44:47], s84 offen offset:1024 lds
  s_waitcnt lgkmcnt(5)
  v_mfma_f32_32x32x16_bf16 v[96:111], v[32:35], v[240:243], v[96:111]
  ds_read_b64_tr_b16 v[40:41], v148 offset:63488
  ds_read_b64_tr_b16 v[42:43], v148 offset:64512
  buffer_load_dwordx4 v[200:203], v60, s[36:39], s90 offen sc1
  v_readlane_b32 s89, v3, 61
  buffer_load_dwordx4 v[204:207], v60, s[36:39], s91 offen sc1
  s_waitcnt lgkmcnt(3)
  v_mfma_f32_32x32x16_bf16 v[112:127], v[36:39], v[240:243], v[112:127]
  ds_read_b64_tr_b16 v[44:45], v149 offset:63488
  ds_read_b64_tr_b16 v[46:47], v149 offset:64512
  v_readlane_b32 s90, v3, 62
  buffer_load_dwordx4 v[208:211], v60, s[36:39], s88 offen sc1
  v_readlane_b32 s91, v3, 63
  s_waitcnt lgkmcnt(2)
  v_mfma_f32_32x32x16_bf16 v[96:111], v[40:43], v[244:247], v[96:111]
  ds_read_b64_tr_b16 v[32:33], v150 offset:4096
  ds_read_b64_tr_b16 v[34:35], v150 offset:5120
  s_add_u32 m0, s81, 90112
  v_readlane_b32 s86, v9, 34
  buffer_load_dwordx4 v56, s[44:47], s85 offen lds
  s_waitcnt lgkmcnt(2)
  v_mfma_f32_32x32x16_bf16 v[112:127], v[44:47], v[244:247], v[112:127]
  ds_read_b64_tr_b16 v[36:37], v151 offset:4096
  ds_read_b64_tr_b16 v[38:39], v151 offset:5120
  buffer_load_dwordx4 v57, s[44:47], s85 offen offset:1024 lds
  s_add_u32 m0, s81, 32768
  v_readlane_b32 s87, v9, 35
  s_waitcnt lgkmcnt(2)
  v_mfma_f32_32x32x16_bf16 v[96:111], v[32:35], v[248:251], v[96:111]
  ds_read_b64_tr_b16 v[40:41], v150 offset:6144
  ds_read_b64_tr_b16 v[42:43], v150 offset:7168
  buffer_load_dwordx4 v56, s[44:47], s86 offen lds
  s_waitcnt lgkmcnt(2)
  v_mfma_f32_32x32x16_bf16 v[112:127], v[36:39], v[248:251], v[112:127]
  ds_read_b64_tr_b16 v[44:45], v151 offset:6144
  ds_read_b64_tr_b16 v[46:47], v151 offset:7168
  buffer_load_dwordx4 v57, s[44:47], s86 offen offset:1024 lds
  s_add_u32 m0, s81, 40960
  s_waitcnt lgkmcnt(2)
  v_mfma_f32_32x32x16_bf16 v[96:111], v[40:43], v[252:255], v[96:111]
  s_waitcnt lgkmcnt(0)
  s_barrier
  ds_read_b64_tr_b16 v[32:33], v150 offset:12288
  buffer_load_dwordx4 v[212:215], v60, s[36:39], s89 offen sc1
  v_readlane_b32 s88, v4, 0
  v_mfma_f32_32x32x16_bf16 v[112:127], v[44:47], v[252:255], v[112:127]
  ds_read_b64_tr_b16 v[34:35], v150 offset:13312
  ds_read_b64_tr_b16 v[36:37], v151 offset:12288
  ds_read_b64_tr_b16 v[38:39], v151 offset:13312
  buffer_load_dwordx4 v[216:219], v60, s[36:39], s90 offen sc1
  v_readlane_b32 s89, v4, 1
  s_waitcnt lgkmcnt(2)
  v_mfma_f32_32x32x16_bf16 v[96:111], v[32:35], v[160:163], v[96:111]
  ds_read_b64_tr_b16 v[40:41], v150 offset:14336
  ds_read_b64_tr_b16 v[42:43], v150 offset:15360
  buffer_load_dwordx4 v56, s[44:47], s87 offen lds
  s_waitcnt lgkmcnt(2)
  v_mfma_f32_32x32x16_bf16 v[112:127], v[36:39], v[160:163], v[112:127]
  ds_read_b64_tr_b16 v[44:45], v151 offset:14336
  ds_read_b64_tr_b16 v[46:47], v151 offset:15360
  buffer_load_dwordx4 v57, s[44:47], s87 offen offset:1024 lds
  s_waitcnt lgkmcnt(2)
  v_mfma_f32_32x32x16_bf16 v[96:111], v[40:43], v[164:167], v[96:111]
  ds_read_b64_tr_b16 v[32:33], v150 offset:20480
  ds_read_b64_tr_b16 v[34:35], v150 offset:21504
  buffer_load_dwordx4 v[220:223], v60, s[36:39], s91 offen sc1
  v_readlane_b32 s90, v4, 2
  s_waitcnt lgkmcnt(2)
  v_mfma_f32_32x32x16_bf16 v[112:127], v[44:47], v[164:167], v[112:127]
  ds_read_b64_tr_b16 v[36:37], v151 offset:20480
  ds_read_b64_tr_b16 v[38:39], v151 offset:21504
  buffer_load_dwordx4 v[224:227], v60, s[36:39], s88 offen sc1
  v_readlane_b32 s91, v4, 3
  s_waitcnt lgkmcnt(2)
  v_mfma_f32_32x32x16_bf16 v[96:111], v[32:35], v[168:171], v[96:111]
  ds_read_b64_tr_b16 v[40:41], v150 offset:22528
  ds_read_b64_tr_b16 v[42:43], v150 offset:23552
  buffer_load_dwordx4 v[228:231], v60, s[36:39], s89 offen sc1
  v_readlane_b32 s88, v4, 4
  s_waitcnt lgkmcnt(2)
  v_mfma_f32_32x32x16_bf16 v[112:127], v[36:39], v[168:171], v[112:127]
  ds_read_b64_tr_b16 v[44:45], v151 offset:22528
  ds_read_b64_tr_b16 v[46:47], v151 offset:23552
  buffer_load_dwordx4 v[232:235], v60, s[36:39], s90 offen sc1
  v_readlane_b32 s89, v4, 5
  s_waitcnt lgkmcnt(2)
  v_mfma_f32_32x32x16_bf16 v[96:111], v[40:43], v[172:175], v[96:111]
  ds_read_b64_tr_b16 v[32:33], v58 offset:0
  ds_read_b64_tr_b16 v[34:35], v58 offset:1024
  buffer_load_dwordx4 v[236:239], v60, s[36:39], s91 offen sc1
  v_readlane_b32 s90, v4, 6
  s_waitcnt lgkmcnt(2)
  v_mfma_f32_32x32x16_bf16 v[112:127], v[44:47], v[172:175], v[112:127]
  ds_read_b64_tr_b16 v[36:37], v59 offset:0
  ds_read_b64_tr_b16 v[38:39], v59 offset:1024
  buffer_load_dwordx4 v[240:243], v60, s[36:39], s88 offen sc1
  v_readlane_b32 s91, v4, 7
  s_waitcnt lgkmcnt(2)
  v_mfma_f32_32x32x16_bf16 v[96:111], v[32:35], v[176:179], v[96:111]
  ds_read_b64_tr_b16 v[40:41], v58 offset:2048
  ds_read_b64_tr_b16 v[42:43], v58 offset:3072
  buffer_load_dwordx4 v[244:247], v60, s[36:39], s89 offen sc1
  s_waitcnt lgkmcnt(2)
  v_mfma_f32_32x32x16_bf16 v[112:127], v[36:39], v[176:179], v[112:127]
  ds_read_b64_tr_b16 v[44:45], v59 offset:2048
  ds_read_b64_tr_b16 v[46:47], v59 offset:3072
  buffer_load_dwordx4 v[248:251], v60, s[36:39], s90 offen sc1
  s_waitcnt lgkmcnt(2)
  v_mfma_f32_32x32x16_bf16 v[96:111], v[40:43], v[180:183], v[96:111]
  ds_read_b64_tr_b16 v[32:33], v58 offset:8192
  ds_read_b64_tr_b16 v[34:35], v58 offset:9216
  buffer_load_dwordx4 v[252:255], v60, s[36:39], s91 offen sc1
  s_waitcnt lgkmcnt(2)
  v_mfma_f32_32x32x16_bf16 v[112:127], v[44:47], v[180:183], v[112:127]
  ds_read_b64_tr_b16 v[36:37], v59 offset:8192
  ds_read_b64_tr_b16 v[38:39], v59 offset:9216
  s_waitcnt lgkmcnt(2)
  v_mfma_f32_32x32x16_bf16 v[96:111], v[32:35], v[184:187], v[96:111]
  ds_read_b64_tr_b16 v[40:41], v58 offset:10240
  ds_read_b64_tr_b16 v[42:43], v58 offset:11264
  s_waitcnt lgkmcnt(2)
  v_mfma_f32_32x32x16_bf16 v[112:127], v[36:39], v[184:187], v[112:127]
  ds_read_b64_tr_b16 v[44:45], v59 offset:10240
  ds_read_b64_tr_b16 v[46:47], v59 offset:11264
  s_waitcnt vmcnt(23) lgkmcnt(2)
  v_mfma_f32_32x32x16_bf16 v[96:111], v[40:43], v[188:191], v[96:111]
  s_waitcnt lgkmcnt(0)
  s_barrier
  ds_read_b64_tr_b16 v[32:33], v58 offset:16384
  v_mfma_f32_32x32x16_bf16 v[112:127], v[44:47], v[188:191], v[112:127]
  ds_read_b64_tr_b16 v[34:35], v58 offset:17408
  ds_read_b64_tr_b16 v[36:37], v59 offset:16384
  ds_read_b64_tr_b16 v[38:39], v59 offset:17408
  s_waitcnt vmcnt(22) lgkmcnt(2)
  v_mfma_f32_32x32x16_bf16 v[96:111], v[32:35], v[192:195], v[96:111]
  ds_read_b64_tr_b16 v[40:41], v58 offset:18432
  ds_read_b64_tr_b16 v[42:43], v58 offset:19456
  ds_read_b128 v[80:83], v147 offset:49152
  ds_read_b128 v[84:87], v147 offset:50176
  ds_read_b128 v[88:91], v147 offset:51200
  ds_read_b128 v[92:95], v147 offset:52224
  s_waitcnt lgkmcnt(6)
  v_mfma_f32_32x32x16_bf16 v[112:127], v[36:39], v[192:195], v[112:127]
  ds_read_b64_tr_b16 v[44:45], v59 offset:18432
  ds_read_b64_tr_b16 v[46:47], v59 offset:19456
  s_waitcnt vmcnt(21) lgkmcnt(6)
  v_mfma_f32_32x32x16_bf16 v[96:111], v[40:43], v[196:199], v[96:111]
  ds_read_b64_tr_b16 v[32:33], v58 offset:24576
  ds_read_b64_tr_b16 v[34:35], v58 offset:25600
  s_waitcnt lgkmcnt(2)
  v_mfma_f32_32x32x16_bf16 v[112:127], v[44:47], v[196:199], v[112:127]
  ds_read_b64_tr_b16 v[36:37], v59 offset:24576
  ds_read_b64_tr_b16 v[38:39], v59 offset:25600
  s_waitcnt vmcnt(19) lgkmcnt(2)
  v_mfma_f32_32x32x16_bf16 v[96:111], v[32:35], v[200:203], v[96:111]
  ds_read_b64_tr_b16 v[40:41], v58 offset:26624
  ds_read_b64_tr_b16 v[42:43], v58 offset:27648
  s_waitcnt lgkmcnt(2)
  v_mfma_f32_32x32x16_bf16 v[112:127], v[36:39], v[200:203], v[112:127]
  ds_read_b64_tr_b16 v[44:45], v59 offset:26624
  ds_read_b64_tr_b16 v[46:47], v59 offset:27648
  s_waitcnt vmcnt(18) lgkmcnt(2)
  v_mfma_f32_32x32x16_bf16 v[96:111], v[40:43], v[204:207], v[96:111]
  ds_read_b64_tr_b16 v[32:33], v148 offset:0
  ds_read_b64_tr_b16 v[34:35], v148 offset:1024
  s_waitcnt lgkmcnt(2)
  v_mfma_f32_32x32x16_bf16 v[112:127], v[44:47], v[204:207], v[112:127]
  ds_read_b64_tr_b16 v[36:37], v149 offset:0
  ds_read_b64_tr_b16 v[38:39], v149 offset:1024
  s_waitcnt vmcnt(17) lgkmcnt(2)
  v_mfma_f32_32x32x16_bf16 v[96:111], v[32:35], v[208:211], v[96:111]
  ds_read_b64_tr_b16 v[40:41], v148 offset:2048
  ds_read_b64_tr_b16 v[42:43], v148 offset:3072
  v_add_f32 v64, v64, v80
  v_add_f32 v65, v65, v81
  v_add_f32 v66, v66, v82
  v_add_f32 v67, v67, v83
  v_add_f32 v68, v68, v84
  s_waitcnt lgkmcnt(2)
  v_mfma_f32_32x32x16_bf16 v[112:127], v[36:39], v[208:211], v[112:127]
  ds_read_b64_tr_b16 v[44:45], v149 offset:2048
  ds_read_b64_tr_b16 v[46:47], v149 offset:3072
  v_add_f32 v69, v69, v85
  v_add_f32 v70, v70, v86
  v_add_f32 v71, v71, v87
  v_add_f32 v72, v72, v88
  v_add_f32 v73, v73, v89
  s_waitcnt vmcnt(12) lgkmcnt(2)
  v_mfma_f32_32x32x16_bf16 v[96:111], v[40:43], v[212:215], v[96:111]
  ds_read_b64_tr_b16 v[32:33], v148 offset:8192
  ds_read_b64_tr_b16 v[34:35], v148 offset:9216
  v_add_f32 v74, v74, v90
  v_add_f32 v75, v75, v91
  v_add_f32 v76, v76, v92
  v_add_f32 v77, v77, v93
  v_add_f32 v78, v78, v94
  s_waitcnt lgkmcnt(2)
  v_mfma_f32_32x32x16_bf16 v[112:127], v[44:47], v[212:215], v[112:127]
  ds_read_b64_tr_b16 v[36:37], v149 offset:8192
  ds_read_b64_tr_b16 v[38:39], v149 offset:9216
  v_add_f32 v79, v79, v95
  s_waitcnt vmcnt(11) lgkmcnt(2)
  v_mfma_f32_32x32x16_bf16 v[96:111], v[32:35], v[216:219], v[96:111]
  ds_read_b64_tr_b16 v[40:41], v148 offset:10240
  ds_read_b64_tr_b16 v[42:43], v148 offset:11264
  s_waitcnt lgkmcnt(2)
  v_mfma_f32_32x32x16_bf16 v[112:127], v[36:39], v[216:219], v[112:127]
  ds_read_b64_tr_b16 v[44:45], v149 offset:10240
  ds_read_b64_tr_b16 v[46:47], v149 offset:11264
  s_waitcnt vmcnt(8) lgkmcnt(2)
  v_mfma_f32_32x32x16_bf16 v[96:111], v[40:43], v[220:223], v[96:111]
  s_waitcnt lgkmcnt(0)
  s_barrier
  ds_read_b64_tr_b16 v[32:33], v148 offset:16384
  v_mfma_f32_32x32x16_bf16 v[112:127], v[44:47], v[220:223], v[112:127]
  ds_read_b64_tr_b16 v[34:35], v148 offset:17408
  ds_read_b64_tr_b16 v[36:37], v149 offset:16384
  ds_read_b64_tr_b16 v[38:39], v149 offset:17408
  s_waitcnt vmcnt(7) lgkmcnt(2)
  v_mfma_f32_32x32x16_bf16 v[96:111], v[32:35], v[224:227], v[96:111]
  ds_read_b64_tr_b16 v[40:41], v148 offset:18432
  ds_read_b64_tr_b16 v[42:43], v148 offset:19456
  s_waitcnt lgkmcnt(2)
  v_mfma_f32_32x32x16_bf16 v[112:127], v[36:39], v[224:227], v[112:127]
  ds_read_b64_tr_b16 v[44:45], v149 offset:18432
  ds_read_b64_tr_b16 v[46:47], v149 offset:19456
  s_waitcnt vmcnt(6) lgkmcnt(2)
  v_mfma_f32_32x32x16_bf16 v[96:111], v[40:43], v[228:231], v[96:111]
  ds_read_b64_tr_b16 v[32:33], v148 offset:24576
  ds_read_b64_tr_b16 v[34:35], v148 offset:25600
  s_waitcnt lgkmcnt(2)
  v_mfma_f32_32x32x16_bf16 v[112:127], v[44:47], v[228:231], v[112:127]
  ds_read_b64_tr_b16 v[36:37], v149 offset:24576
  ds_read_b64_tr_b16 v[38:39], v149 offset:25600
  s_waitcnt vmcnt(5) lgkmcnt(2)
  v_mfma_f32_32x32x16_bf16 v[96:111], v[32:35], v[232:235], v[96:111]
  ds_read_b64_tr_b16 v[40:41], v148 offset:26624
  ds_read_b64_tr_b16 v[42:43], v148 offset:27648
  s_waitcnt lgkmcnt(2)
  v_mfma_f32_32x32x16_bf16 v[112:127], v[36:39], v[232:235], v[112:127]
  ds_read_b64_tr_b16 v[44:45], v149 offset:26624
  ds_read_b64_tr_b16 v[46:47], v149 offset:27648
  s_waitcnt vmcnt(4) lgkmcnt(2)
  v_mfma_f32_32x32x16_bf16 v[96:111], v[40:43], v[236:239], v[96:111]
  ds_read_b64_tr_b16 v[32:33], v58 offset:32768
  ds_read_b64_tr_b16 v[34:35], v58 offset:33792
  s_waitcnt lgkmcnt(2)
  v_mfma_f32_32x32x16_bf16 v[112:127], v[44:47], v[236:239], v[112:127]
  ds_read_b64_tr_b16 v[36:37], v59 offset:32768
  ds_read_b64_tr_b16 v[38:39], v59 offset:33792
  s_waitcnt vmcnt(3) lgkmcnt(2)
  v_mfma_f32_32x32x16_bf16 v[96:111], v[32:35], v[240:243], v[96:111]
  ds_read_b64_tr_b16 v[40:41], v58 offset:34816
  ds_read_b64_tr_b16 v[42:43], v58 offset:35840
  s_waitcnt lgkmcnt(2)
  v_mfma_f32_32x32x16_bf16 v[112:127], v[36:39], v[240:243], v[112:127]
  ds_read_b64_tr_b16 v[44:45], v59 offset:34816
  ds_read_b64_tr_b16 v[46:47], v59 offset:35840
  s_waitcnt vmcnt(2) lgkmcnt(2)
  v_mfma_f32_32x32x16_bf16 v[96:111], v[40:43], v[244:247], v[96:111]
  ds_read_b64_tr_b16 v[32:33], v58 offset:40960
  ds_read_b64_tr_b16 v[34:35], v58 offset:41984
  s_waitcnt lgkmcnt(2)
  v_mfma_f32_32x32x16_bf16 v[112:127], v[44:47], v[244:247], v[112:127]
  ds_read_b64_tr_b16 v[36:37], v59 offset:40960
  ds_read_b64_tr_b16 v[38:39], v59 offset:41984
  s_waitcnt vmcnt(1) lgkmcnt(2)
  v_mfma_f32_32x32x16_bf16 v[96:111], v[32:35], v[248:251], v[96:111]
  ds_read_b64_tr_b16 v[40:41], v58 offset:43008
  ds_read_b64_tr_b16 v[42:43], v58 offset:44032
  s_waitcnt lgkmcnt(2)
  v_mfma_f32_32x32x16_bf16 v[112:127], v[36:39], v[248:251], v[112:127]
  ds_read_b64_tr_b16 v[44:45], v59 offset:43008
  ds_read_b64_tr_b16 v[46:47], v59 offset:44032
  s_waitcnt vmcnt(0) lgkmcnt(2)
  v_mfma_f32_32x32x16_bf16 v[96:111], v[40:43], v[252:255], v[96:111]
  s_waitcnt lgkmcnt(0)
  v_mfma_f32_32x32x16_bf16 v[112:127], v[44:47], v[252:255], v[112:127]
  s_nop 11
  ds_write_b128 v146, v[112:115] offset:0
  ds_write_b128 v146, v[116:119] offset:1024
  ds_write_b128 v146, v[120:123] offset:2048
  ds_write_b128 v146, v[124:127] offset:3072
  s_cmp_lt_u32 s52, 2
  s_waitcnt lgkmcnt(0)
  s_barrier
  ds_read_b128 v[112:115], v147 offset:0
  ds_read_b128 v[116:119], v147 offset:1024
  ds_read_b128 v[120:123], v147 offset:2048
  ds_read_b128 v[124:127], v147 offset:3072
  s_cbranch_scc0 L_finB9
  s_waitcnt lgkmcnt(3)
  v_add_f32 v64, v64, v112
  v_add_f32 v65, v65, v113
  v_add_f32 v66, v66, v114
  v_add_f32 v67, v67, v115
  s_waitcnt lgkmcnt(2)
  v_add_f32 v68, v68, v116
  v_add_f32 v69, v69, v117
  v_add_f32 v70, v70, v118
  v_add_f32 v71, v71, v119
  s_waitcnt lgkmcnt(1)
  v_add_f32 v72, v72, v120
  v_add_f32 v73, v73, v121
  v_add_f32 v74, v74, v122
  v_add_f32 v75, v75, v123
  s_waitcnt lgkmcnt(0)
  v_add_f32 v76, v76, v124
  v_add_f32 v77, v77, v125
  v_add_f32 v78, v78, v126
  v_add_f32 v79, v79, v127
  v_mul_f32 v80, 0xbfb8aa3b, v64
  v_mul_f32 v81, 0xbfb8aa3b, v65
  v_mul_f32 v82, 0xbfb8aa3b, v66
  v_mul_f32 v83, 0xbfb8aa3b, v67
  v_mul_f32 v84, 0xbfb8aa3b, v68
  v_mul_f32 v85, 0xbfb8aa3b, v69
  v_mul_f32 v86, 0xbfb8aa3b, v70
  v_mul_f32 v87, 0xbfb8aa3b, v71
  v_mul_f32 v88, 0xbfb8aa3b, v72
  v_mul_f32 v89, 0xbfb8aa3b, v73
  v_mul_f32 v90, 0xbfb8aa3b, v74
  v_mul_f32 v91, 0xbfb8aa3b, v75
  v_mul_f32 v92, 0xbfb8aa3b, v76
  v_mul_f32 v93, 0xbfb8aa3b, v77
  v_mul_f32 v94, 0xbfb8aa3b, v78
  v_mul_f32 v95, 0xbfb8aa3b, v79
  v_exp_f32 v80, v80
  v_exp_f32 v81, v81
  v_exp_f32 v82, v82
  v_exp_f32 v83, v83
  v_exp_f32 v84, v84
  v_exp_f32 v85, v85
  v_exp_f32 v86, v86
  v_exp_f32 v87, v87
  v_exp_f32 v88, v88
  v_exp_f32 v89, v89
  v_exp_f32 v90, v90
  v_exp_f32 v91, v91
  v_exp_f32 v92, v92
  v_exp_f32 v93, v93
  v_exp_f32 v94, v94
  v_exp_f32 v95, v95
  v_mul_f32 v64, v64, v96
  v_mul_f32 v65, v65, v97
  v_mul_f32 v66, v66, v98
  v_mul_f32 v67, v67, v99
  v_mul_f32 v68, v68, v100
  v_mul_f32 v69, v69, v101
  v_mul_f32 v70, v70, v102
  v_mul_f32 v71, v71, v103
  v_mul_f32 v72, v72, v104
  v_mul_f32 v73, v73, v105
  v_mul_f32 v74, v74, v106
  v_mul_f32 v75, v75, v107
  v_mul_f32 v76, v76, v108
  v_mul_f32 v77, v77, v109
  v_mul_f32 v78, v78, v110
  v_mul_f32 v79, v79, v111
  v_add_f32 v80, 1.0, v80
  v_add_f32 v81, 1.0, v81
  v_add_f32 v82, 1.0, v82
  v_add_f32 v83, 1.0, v83
  v_add_f32 v84, 1.0, v84
  v_add_f32 v85, 1.0, v85
  v_add_f32 v86, 1.0, v86
  v_add_f32 v87, 1.0, v87
  v_add_f32 v88, 1.0, v88
  v_add_f32 v89, 1.0, v89
  v_add_f32 v90, 1.0, v90
  v_add_f32 v91, 1.0, v91
  v_add_f32 v92, 1.0, v92
  v_add_f32 v93, 1.0, v93
  v_add_f32 v94, 1.0, v94
  v_add_f32 v95, 1.0, v95
  v_rcp_f32 v80, v80
  v_rcp_f32 v81, v81
  v_rcp_f32 v82, v82
  v_rcp_f32 v83, v83
  v_rcp_f32 v84, v84
  v_rcp_f32 v85, v85
  v_rcp_f32 v86, v86
  v_rcp_f32 v87, v87
  v_fma_f32 v64, v64, v80, v48
  v_fma_f32 v65, v65, v81, v49
  v_fma_f32 v66, v66, v82, v50
  v_fma_f32 v67, v67, v83, v51
  v_fma_f32 v68, v68, v84, v52
  v_fma_f32 v69, v69, v85, v53
  v_fma_f32 v70, v70, v86, v54
  v_fma_f32 v71, v71, v87, v55
  v_cvt_pk_bf16_f32 v112, v64, v65
  v_cvt_pk_bf16_f32 v113, v66, v67
  v_cvt_pk_bf16_f32 v114, v68, v69
  v_cvt_pk_bf16_f32 v115, v70, v71
  s_nop 0
  v_permlane32_swap_b32 v112, v114
  v_permlane32_swap_b32 v113, v115
  buffer_store_dwordx4 v[112:115], v144, s[48:51], 0 offen offset:0
  v_rcp_f32 v88, v88
  v_rcp_f32 v89, v89
  v_rcp_f32 v90, v90
  v_rcp_f32 v91, v91
  v_rcp_f32 v92, v92
  v_rcp_f32 v93, v93
  v_rcp_f32 v94, v94
  v_rcp_f32 v95, v95
  v_fma_f32 v72, v72, v88, v136
  v_fma_f32 v73, v73, v89, v137
  v_fma_f32 v74, v74, v90, v138
  v_fma_f32 v75, v75, v91, v139
  v_fma_f32 v76, v76, v92, v140
  v_fma_f32 v77, v77, v93, v141
  v_fma_f32 v78, v78, v94, v142
  v_fma_f32 v79, v79, v95, v143
  v_cvt_pk_bf16_f32 v116, v72, v73
  v_cvt_pk_bf16_f32 v117, v74, v75
  v_cvt_pk_bf16_f32 v118, v76, v77
  v_cvt_pk_bf16_f32 v119, v78, v79
  s_nop 0
  v_permlane32_swap_b32 v116, v118
  v_permlane32_swap_b32 v117, v119
  buffer_store_dwordx4 v[116:119], v144, s[48:51], 0 offen offset:32
  s_cmp_eq_u32 s2, 0
  s_cbranch_scc0 L_fin10
  v_cmp_eq_u32 vcc, 0, v0
  v_mov_b32 v1, 1073741824
  s_nop 0
  v_cndmask_b32 v1, v1, 0, vcc
  buffer_store_dword v13, v1, s[36:39], 0 offen sc1
L_fin10:
  s_endpgm
L_finB9:
  v_add_f32 v64, v64, v96
  v_add_f32 v65, v65, v97
  v_add_f32 v66, v66, v98
  v_add_f32 v67, v67, v99
  v_add_f32 v68, v68, v100
  v_add_f32 v69, v69, v101
  v_add_f32 v70, v70, v102
  v_add_f32 v71, v71, v103
  v_add_f32 v72, v72, v104
  v_add_f32 v73, v73, v105
  v_add_f32 v74, v74, v106
  v_add_f32 v75, v75, v107
  v_add_f32 v76, v76, v108
  v_add_f32 v77, v77, v109
  v_add_f32 v78, v78, v110
  v_add_f32 v79, v79, v111
  v_mul_f32 v80, 0xbfb8aa3b, v64
  v_mul_f32 v81, 0xbfb8aa3b, v65
  v_mul_f32 v82, 0xbfb8aa3b, v66
  v_mul_f32 v83, 0xbfb8aa3b, v67
  v_mul_f32 v84, 0xbfb8aa3b, v68
  v_mul_f32 v85, 0xbfb8aa3b, v69
  v_mul_f32 v86, 0xbfb8aa3b, v70
  v_mul_f32 v87, 0xbfb8aa3b, v71
  v_mul_f32 v88, 0xbfb8aa3b, v72
  v_mul_f32 v89, 0xbfb8aa3b, v73
  v_mul_f32 v90, 0xbfb8aa3b, v74
  v_mul_f32 v91, 0xbfb8aa3b, v75
  v_mul_f32 v92, 0xbfb8aa3b, v76
  v_mul_f32 v93, 0xbfb8aa3b, v77
  v_mul_f32 v94, 0xbfb8aa3b, v78
  v_mul_f32 v95, 0xbfb8aa3b, v79
  v_exp_f32 v80, v80
  v_exp_f32 v81, v81
  v_exp_f32 v82, v82
  v_exp_f32 v83, v83
  v_exp_f32 v84, v84
  v_exp_f32 v85, v85
  v_exp_f32 v86, v86
  v_exp_f32 v87, v87
  v_exp_f32 v88, v88
  v_exp_f32 v89, v89
  v_exp_f32 v90, v90
  v_exp_f32 v91, v91
  v_exp_f32 v92, v92
  v_exp_f32 v93, v93
  v_exp_f32 v94, v94
  v_exp_f32 v95, v95
  s_waitcnt lgkmcnt(3)
  v_mul_f32 v64, v64, v112
  v_mul_f32 v65, v65, v113
  v_mul_f32 v66, v66, v114
  v_mul_f32 v67, v67, v115
  s_waitcnt lgkmcnt(2)
  v_mul_f32 v68, v68, v116
  v_mul_f32 v69, v69, v117
  v_mul_f32 v70, v70, v118
  v_mul_f32 v71, v71, v119
  s_waitcnt lgkmcnt(1)
  v_mul_f32 v72, v72, v120
  v_mul_f32 v73, v73, v121
  v_mul_f32 v74, v74, v122
  v_mul_f32 v75, v75, v123
  s_waitcnt lgkmcnt(0)
  v_mul_f32 v76, v76, v124
  v_mul_f32 v77, v77, v125
  v_mul_f32 v78, v78, v126
  v_mul_f32 v79, v79, v127
  v_add_f32 v80, 1.0, v80
  v_add_f32 v81, 1.0, v81
  v_add_f32 v82, 1.0, v82
  v_add_f32 v83, 1.0, v83
  v_add_f32 v84, 1.0, v84
  v_add_f32 v85, 1.0, v85
  v_add_f32 v86, 1.0, v86
  v_add_f32 v87, 1.0, v87
  v_add_f32 v88, 1.0, v88
  v_add_f32 v89, 1.0, v89
  v_add_f32 v90, 1.0, v90
  v_add_f32 v91, 1.0, v91
  v_add_f32 v92, 1.0, v92
  v_add_f32 v93, 1.0, v93
  v_add_f32 v94, 1.0, v94
  v_add_f32 v95, 1.0, v95
  v_rcp_f32 v80, v80
  v_rcp_f32 v81, v81
  v_rcp_f32 v82, v82
  v_rcp_f32 v83, v83
  v_rcp_f32 v84, v84
  v_rcp_f32 v85, v85
  v_rcp_f32 v86, v86
  v_rcp_f32 v87, v87
  v_fma_f32 v64, v64, v80, v48
  v_fma_f32 v65, v65, v81, v49
  v_fma_f32 v66, v66, v82, v50
  v_fma_f32 v67, v67, v83, v51
  v_fma_f32 v68, v68, v84, v52
  v_fma_f32 v69, v69, v85, v53
  v_fma_f32 v70, v70, v86, v54
  v_fma_f32 v71, v71, v87, v55
  v_cvt_pk_bf16_f32 v96, v64, v65
  v_cvt_pk_bf16_f32 v97, v66, v67
  v_cvt_pk_bf16_f32 v98, v68, v69
  v_cvt_pk_bf16_f32 v99, v70, v71
  s_nop 0
  v_permlane32_swap_b32 v96, v98
  v_permlane32_swap_b32 v97, v99
  buffer_store_dwordx4 v[96:99], v144, s[48:51], 0 offen offset:0
  v_rcp_f32 v88, v88
  v_rcp_f32 v89, v89
  v_rcp_f32 v90, v90
  v_rcp_f32 v91, v91
  v_rcp_f32 v92, v92
  v_rcp_f32 v93, v93
  v_rcp_f32 v94, v94
  v_rcp_f32 v95, v95
  v_fma_f32 v72, v72, v88, v136
  v_fma_f32 v73, v73, v89, v137
  v_fma_f32 v74, v74, v90, v138
  v_fma_f32 v75, v75, v91, v139
  v_fma_f32 v76, v76, v92, v140
  v_fma_f32 v77, v77, v93, v141
  v_fma_f32 v78, v78, v94, v142
  v_fma_f32 v79, v79, v95, v143
  v_cvt_pk_bf16_f32 v100, v72, v73
  v_cvt_pk_bf16_f32 v101, v74, v75
  v_cvt_pk_bf16_f32 v102, v76, v77
  v_cvt_pk_bf16_f32 v103, v78, v79
  s_nop 0
  v_permlane32_swap_b32 v100, v102
  v_permlane32_swap_b32 v101, v103
  buffer_store_dwordx4 v[100:103], v144, s[48:51], 0 offen offset:32
  s_cmp_eq_u32 s2, 0
  s_cbranch_scc0 L_fin11
  v_cmp_eq_u32 vcc, 0, v0
  v_mov_b32 v1, 1073741824
  s_nop 0
  v_cndmask_b32 v1, v1, 0, vcc
  buffer_store_dword v13, v1, s[36:39], 0 offen sc1
L_fin11:
  s_endpgm
L_qrole:
  s_mov_b32 s28, s6
  s_mov_b32 s29, s7
  s_mov_b32 s30, 1572864
  s_mul_i32 s69, s52, 49152
  s_lshl_b32 s70, s54, 6
  s_add_u32 s69, s69, s70
  v_lshrrev_b32 v9, 2, v2
  v_mul_u32_u24 v9, 3072, v9
  v_and_b32 v26, 3, v2
  v_lshl_add_u32 v26, v26, 4, s69
  v_add_u32 v26, v26, v9
  s_mul_i32 s69, s57, 196608
  v_add_u32 v24, s69, v26
  s_mul_i32 s76, s52, 3072
  s_add_u32 m0, s76, 81920
  s_nop 0
  buffer_load_dwordx4 v24, s[28:31], 0 offen offset:0 lds
  buffer_load_dwordx4 v24, s[28:31], 0 offen offset:1024 lds
  buffer_load_dwordx4 v24, s[28:31], 0 offen offset:2048 lds
  s_add_u32 m0, s75, 49152
  s_nop 0
  buffer_load_dwordx4 v7, s[24:27], s60 offen offset:0 lds
  s_getpc_b64 s[100:101]
L_pc12:
  s_sub_u32 s100, s100, L_pc12-recurrent_scan__sliding_block__glu_gated_glu__prompt_kernel
  s_subb_u32 s101, s101, 0
  v_min_u32 v9, 23, v0
  s_mul_i32 s58, s92, 24
  v_add_u32 v9, s58, v9
  v_lshlrev_b32 v9, 7, v9
  v_min_u32 v9, L_codeend-recurrent_scan__sliding_block__glu_gated_glu__prompt_kernel-4, v9
  global_load_dword v159, v9, s[100:101]
  s_lshl_b32 s72, s93, 2
  s_and_b32 s58, s92, 3
  s_add_u32 s72, s72, s58
  s_lshr_b32 s73, s92, 2
  s_lshl_b32 s58, s58, 1
  s_add_u32 s58, s58, s73
  s_lshl_b32 s58, s58, 1
  s_lshr_b32 s59, s52, 1
  s_and_b32 s69, s52, 1
  v_mov_b32 v36, v2
  v_add_u32 v32, s58, v36
  v_and_b32 v32, 15, v32
  v_lshrrev_b32 v33, 2, v32
  v_mul_u32_u24 v33, 28, v33
  v_and_b32 v34, 3, v32
  v_lshl_add_u32 v3, v34, 3, v33
  v_add_u32 v3, s59, v3
  v_bfe_u32 v35, v36, 4, 1
  v_lshl_add_u32 v3, v35, 1, v3
  v_cmp_le_u32 vcc, 48, v36
  v_add_u32 v35, 8, v32
  v_and_b32 v35, 15, v35
  v_cndmask_b32 v35, v32, v35, vcc
  v_mov_b32 v34, s59
  v_cndmask_b32 v34, v34, 0, vcc
  v_lshrrev_b32 v33, 2, v35
  v_mul_u32_u24 v33, 28, v33
  v_add_u32 v34, v34, v33
  v_and_b32 v33, 1, v35
  v_lshl_add_u32 v34, v33, 3, v34
  v_bfe_u32 v33, v35, 1, 1
  v_mul_u32_u24 v33, 10, v33
  v_add3_u32 v34, v34, v33, 4
  v_cmp_le_u32 vcc, 32, v36
  s_nop 1
  v_cndmask_b32 v3, v3, v34, vcc
  v_lshrrev_b32 v33, 2, v35
  v_mul_u32_u24 v33, 28, v33
  v_and_b32 v34, 1, v35
  v_add3_u32 v34, v34, v33, 6
  v_bfe_u32 v33, v35, 1, 1
  v_mul_u32_u24 v33, 14, v33
  v_add_u32 v34, v34, v33
  v_cmp_le_u32 vcc, 56, v36
  s_nop 1
  v_cndmask_b32 v3, v3, v34, vcc
  v_add_u32 v33, 8, v32
  v_and_b32 v33, 15, v33
  v_lshlrev_b32 v33, 1, v33
  v_addc_co_u32 v33, vcc, 0, v33, vcc
  v_or_b32 v33, 0x1000, v33
  s_cmp_eq_u32 s59, 0
  s_cselect_b32 s70, 40, 0x100
  v_cmp_le_u32 vcc, s70, v36
  s_nop 1
  v_cndmask_b32 v3, v3, v33, vcc
  s_lshl_b32 s70, s72, 1
  s_add_u32 s70, s70, s69
  s_mul_i32 s71, s70, 112
  s_add_u32 s71, s71, 8192
  s_lshl_b32 s70, s70, 5
  s_add_u32 s70, s70, 1024
  v_cmp_le_u32 vcc, 0x1000, v3
  v_mov_b32 v32, s71
  v_mov_b32 v33, s70
  v_cndmask_b32 v32, v32, v33, vcc
  v_add_u32 v3, v3, v32
  v_lshlrev_b32 v3, 10, v3
  v_add_u32 v36, 64, v2
  v_add_u32 v32, s58, v36
  v_and_b32 v32, 15, v32
  v_lshrrev_b32 v33, 2, v32
  v_mul_u32_u24 v33, 28, v33
  v_and_b32 v34, 3, v32
  v_lshl_add_u32 v4, v34, 3, v33
  v_add_u32 v4, s59, v4
  v_bfe_u32 v35, v36, 4, 1
  v_lshl_add_u32 v4, v35, 1, v4
  v_cmp_le_u32 vcc, 48, v36
  v_add_u32 v35, 8, v32
  v_and_b32 v35, 15, v35
  v_cndmask_b32 v35, v32, v35, vcc
  v_mov_b32 v34, s59
  v_cndmask_b32 v34, v34, 0, vcc
  v_lshrrev_b32 v33, 2, v35
  v_mul_u32_u24 v33, 28, v33
  v_add_u32 v34, v34, v33
  v_and_b32 v33, 1, v35
  v_lshl_add_u32 v34, v33, 3, v34
  v_bfe_u32 v33, v35, 1, 1
  v_mul_u32_u24 v33, 10, v33
  v_add3_u32 v34, v34, v33, 4
  v_cmp_le_u32 vcc, 32, v36
  s_nop 1
  v_cndmask_b32 v4, v4, v34, vcc
  v_lshrrev_b32 v33, 2, v35
  v_mul_u32_u24 v33, 28, v33
  v_and_b32 v34, 1, v35
  v_add3_u32 v34, v34, v33, 6
  v_bfe_u32 v33, v35, 1, 1
  v_mul_u32_u24 v33, 14, v33
  v_add_u32 v34, v34, v33
  v_cmp_le_u32 vcc, 56, v36
  s_nop 1
  v_cndmask_b32 v4, v4, v34, vcc
  v_add_u32 v33, 8, v32
  v_and_b32 v33, 15, v33
  v_lshlrev_b32 v33, 1, v33
  v_addc_co_u32 v33, vcc, 0, v33, vcc
  v_or_b32 v33, 0x1000, v33
  s_cmp_eq_u32 s59, 0
  s_cselect_b32 s70, 40, 0x100
  v_cmp_le_u32 vcc, s70, v36
  s_nop 1
  v_cndmask_b32 v4, v4, v33, vcc
  s_lshl_b32 s70, s72, 1
  s_add_u32 s70, s70, s69
  s_mul_i32 s71, s70, 112
  s_add_u32 s71, s71, 8192
  s_lshl_b32 s70, s70, 5
  s_add_u32 s70, s70, 1024
  v_cmp_le_u32 vcc, 0x1000, v4
  v_mov_b32 v32, s71
  v_mov_b32 v33, s70
  v_cndmask_b32 v32, v32, v33, vcc
  v_add_u32 v4, v4, v32
  v_lshlrev_b32 v4, 10, v4
  v_lshl_add_u32 v36, v2, 1, s69
  v_add_u32 v32, s58, v36
  v_and_b32 v32, 15, v32
  v_lshrrev_b32 v33, 2, v32
  v_mul_u32_u24 v33, 28, v33
  v_and_b32 v34, 3, v32
  v_lshl_add_u32 v9, v34, 3, v33
  v_add_u32 v9, s59, v9
  v_bfe_u32 v35, v36, 4, 1
  v_lshl_add_u32 v9, v35, 1, v9
  v_cmp_le_u32 vcc, 48, v36
  v_add_u32 v35, 8, v32
  v_and_b32 v35, 15, v35
  v_cndmask_b32 v35, v32, v35, vcc
  v_mov_b32 v34, s59
  v_cndmask_b32 v34, v34, 0, vcc
  v_lshrrev_b32 v33, 2, v35
  v_mul_u32_u24 v33, 28, v33
  v_add_u32 v34, v34, v33
  v_and_b32 v33, 1, v35
  v_lshl_add_u32 v34, v33, 3, v34
  v_bfe_u32 v33, v35, 1, 1
  v_mul_u32_u24 v33, 10, v33
  v_add3_u32 v34, v34, v33, 4
  v_cmp_le_u32 vcc, 32, v36
  s_nop 1
  v_cndmask_b32 v9, v9, v34, vcc
  v_lshrrev_b32 v33, 2, v35
  v_mul_u32_u24 v33, 28, v33
  v_and_b32 v34, 1, v35
  v_add3_u32 v34, v34, v33, 6
  v_bfe_u32 v33, v35, 1, 1
  v_mul_u32_u24 v33, 14, v33
  v_add_u32 v34, v34, v33
  v_cmp_le_u32 vcc, 56, v36
  s_nop 1
  v_cndmask_b32 v9, v9, v34, vcc
  v_add_u32 v33, 8, v32
  v_and_b32 v33, 15, v33
  v_lshlrev_b32 v33, 1, v33
  v_addc_co_u32 v33, vcc, 0, v33, vcc
  v_or_b32 v33, 0x1000, v33
  s_cmp_eq_u32 s59, 0
  s_cselect_b32 s70, 40, 0x100
  v_cmp_le_u32 vcc, s70, v36
  s_nop 1
  v_cndmask_b32 v9, v9, v33, vcc
  v_and_b32 v9, 0xfff, v9
  v_lshlrev_b32 v9, 14, v9
  s_mov_b32 s40, s16
  s_mov_b32 s41, s17
  s_mov_b32 s42, 1835008
  s_mov_b32 s43, 0x20000
  s_cmp_eq_u32 s59, 0
  s_cselect_b32 s44, s8, s16
  s_cselect_b32 s45, s9, s17
  s_mov_b32 s46, 524288
  s_cselect_b32 s46, s46, s42
  s_mov_b32 s47, 0x20000
  s_mov_b32 s48, s18
  s_mov_b32 s49, s19
  s_mov_b32 s50, 0x200000
  s_mov_b32 s51, 0x20000
  v_and_b32 v32, 31, v2
  v_bfe_u32 v33, v2, 1, 3
  v_lshrrev_b32 v34, 5, v2
  v_xor_b32 v33, v33, v34
  s_add_u32 s58, s75, 49152
  v_lshl_add_u32 v32, v32, 7, s58
  v_xor_b32 v34, 0, v33
  v_lshl_add_u32 v16, v34, 4, v32
  v_xor_b32 v34, 2, v33
  v_lshl_add_u32 v17, v34, 4, v32
  v_xor_b32 v34, 4, v33
  v_lshl_add_u32 v18, v34, 4, v32
  v_xor_b32 v34, 6, v33
  v_lshl_add_u32 v19, v34, 4, v32
  v_lshrrev_b32 v32, 3, v2
  v_and_b32 v33, 7, v2
  v_bfe_u32 v10, v2, 4, 1
  v_lshlrev_b32 v10, 2, v10
  v_xor_b32 v10, v10, v33
  v_lshlrev_b32 v10, 4, v10
  v_lshl_add_u32 v10, v32, 10, v10
  s_lshl_b32 s58, s73, 7
  v_add_u32 v10, s58, v10
  v_add_u32 v11, 7168, v10
  v_lshlrev_b32 v15, 4, v2
  v_bfe_u32 v32, v2, 2, 2
  v_lshrrev_b32 v33, 5, v2
  v_lshl_add_u32 v32, v33, 2, v32
  v_lshlrev_b32 v27, 7, v32
  v_bfe_u32 v32, v2, 3, 1
  v_lshl_add_u32 v27, v32, 6, v27
  v_bfe_u32 v32, v2, 4, 1
  v_lshl_add_u32 v27, v32, 5, v27
  v_and_b32 v32, 3, v2
  v_lshl_add_u32 v27, v32, 3, v27
  s_lshr_b32 s58, s52, 1
  s_mul_i32 s58, s58, 4160
  v_xor_b32 v27, s58, v27
  v_xor_b32 v28, 64, v27
  v_and_b32 v32, 15, v2
  s_lshl_b32 s58, s93, 7
  v_lshl_add_u32 v23, v32, 2, s58
  s_lshl_b32 s81, s52, 11
  v_bfe_u32 v33, v2, 2, 2
  v_lshrrev_b32 v34, 5, v2
  v_lshl_add_u32 v34, v34, 3, v33
  v_lshlrev_b32 v34, 6, v34
  v_bfe_u32 v32, v2, 4, 1
  v_lshl_add_u32 v34, v32, 5, v34
  v_and_b32 v35, 3, v2
  v_lshl_add_u32 v34, v35, 3, v34
  v_add_u32 v20, 81920, v34
  s_min_u32 s58, s52, 2
  s_lshl_b32 s59, s58, 10
  v_add_u32 v21, s59, v20
  v_mov_b32 v60, 0x3f803f80
  v_mov_b32 v61, 0x3f803f80
  v_mov_b32 v62, 0x3f803f80
  v_mov_b32 v63, 0x3f803f80
  s_lshl_b32 s58, s58, 4
  s_add_u32 s58, s58, s54
  s_add_u32 s58, s58, 112
  s_lshl_b32 s78, s58, 10
  s_lshl_b32 s59, s53, 7
  s_add_u32 s59, s59, 32768
  s_add_u32 s58, s78, s59
  s_cmp_eq_u32 s52, 3
  s_cselect_b32 s58, 1073741824, s58
  v_and_b32 v36, 31, v2
  v_lshl_add_u32 v22, v36, 2, s58
  v_lshlrev_b32 v200, 2, v36
  v_lshrrev_b32 v37, 5, v2
  v_lshl_add_u32 v200, v37, 9, v200
  v_add_u32 v200, 159744, v200
  v_lshlrev_b32 v38, 4, v2
  v_add_u32 v201, 32768, v38
  s_lshl_b32 s58, s52, 8
  s_add_u32 s58, s58, 154624
  v_lshl_add_u32 v220, v36, 2, s58
  v_lshl_add_u32 v221, v37, 4, s58
  v_mul_u32_u24 v222, 1040, v36
  v_add_u32 v222, 66560, v222
  s_sub_u32 s59, 7, s52
  s_lshl_b32 s69, s52, 10
  v_add_u32 v206, s69, v38
  v_add_u32 v202, 32768, v206
  s_lshl_b32 s69, s59, 10
  v_add_u32 v207, s69, v38
  v_add_u32 v203, 32768, v207
  s_lshl_b32 s69, s52, 11
  s_add_u32 s69, s69, 16384
  v_add_u32 v208, s69, v38
  s_lshl_b32 s69, s59, 11
  s_add_u32 s69, s69, 16384
  v_add_u32 v209, s69, v38
  v_cmp_eq_u32 vcc, 0, v32
  v_mov_b32 v39, 1024
  s_nop 0
  v_cndmask_b32 v40, v39, v38, vcc
  v_cndmask_b32 v41, v38, v39, vcc
  s_mul_i32 s69, s52, 2080
  s_add_u32 s69, s69, 65536
  v_add_u32 v210, s69, v40
  v_add_u32 v212, s69, v41
  s_add_u32 s69, s69, 16640
  v_add_u32 v204, s69, v38
  s_mul_i32 s69, s59, 2080
  s_add_u32 s69, s69, 65536
  v_add_u32 v211, s69, v40
  v_add_u32 v213, s69, v41
  s_add_u32 s69, s69, 16640
  v_add_u32 v205, s69, v38
  s_lshl_b32 s96, s53, 4
  s_add_u32 s96, s96, s54
  s_mul_i32 s70, s96, 144
  s_lshl_b32 s96, s96, 15
  s_add_u32 s96, s96, 1048576
  s_add_u32 s97, s96, 8192
  s_mul_i32 s69, s52, 36
  s_add_u32 s70, s70, s69
  v_min_u32 v223, 35, v2
  v_add_u32 v223, s70, v223
  v_lshlrev_b32 v223, 7, v223
  s_sub_u32 s58, s53, 1
  s_max_i32 s58, s58, 0
  s_lshl_b32 s69, s58, 5
  s_add_u32 s69, s69, s55
  s_lshl_b32 s69, s69, 2
  s_add_u32 s69, s69, 7168
  v_mov_b32 v214, s69
  s_lshl_b32 s58, s58, 4
  s_add_u32 s58, s58, s54
  s_lshl_b32 s58, s58, 15
  s_add_u32 s58, s58, 1048576
  s_lshl_b32 s69, s52, 12
  s_add_u32 s58, s58, s69
  v_add_u32 v216, s58, v38
  v_add_u32 v217, 16384, v216
  s_lshr_b32 s58, s60, 15
  s_lshl_b32 s58, s58, 4
  s_add_u32 s58, s58, s54
  s_lshl_b32 s58, s58, 11
  s_add_u32 s58, s58, 5242880
  v_add_u32 v218, s58, v38
  s_lshr_b32 s58, s64, 15
  s_lshl_b32 s58, s58, 4
  s_add_u32 s58, s58, s54
  s_lshl_b32 s58, s58, 11
  s_add_u32 s58, s58, 5242880
  v_add_u32 v219, s58, v38
  s_lshr_b32 s58, s52, 1
  s_lshl_b32 s58, s58, 14
  s_and_b32 s69, s52, 1
  s_lshl_b32 s69, s69, 12
  s_add_u32 s99, s58, s69
  s_mul_i32 s68, s52, 4160
  s_lshl_b32 s58, s53, 7
  s_add_u32 s58, s58, 4096
  v_lshl_add_u32 v36, v2, 2, s58
  s_lshl_b32 s58, s55, 2
  s_add_u32 s58, s58, 5120
  v_and_b32 v37, 7, v2
  v_lshl_add_u32 v37, v37, 7, s58
  v_cmp_gt_u32 vcc, 32, v2
  s_nop 1
  v_cndmask_b32 v192, v37, v36, vcc
  v_and_b32 v36, 31, v2
  s_lshr_b32 s58, s60, 7
  s_add_u32 s58, s58, 16384
  v_lshl_add_u32 v198, v36, 3, s58
  s_lshr_b32 s58, s64, 7
  s_add_u32 s58, s58, 16384
  v_lshl_add_u32 v199, v36, 3, s58
  v_and_b32 v36, 31, v2
  v_lshrrev_b32 v37, 5, v2
  v_lshlrev_b32 v37, 2, v37
  v_sub_u32 v36, v36, v37
  v_mov_b32 v37, 0xf149f2ca
  v_cmp_le_i32 s[84:85], 0, v36
  v_cmp_le_i32 s[86:87], 1, v36
  v_cmp_le_i32 s[88:89], 2, v36
  v_cndmask_b32 v224, v37, 0, s[84:85]
  v_cndmask_b32 v240, 0, v37, s[84:85]
  v_cmp_le_i32 s[90:91], 3, v36
  v_cndmask_b32 v225, v37, 0, s[86:87]
  v_cndmask_b32 v241, 0, v37, s[86:87]
  v_cmp_le_i32 s[84:85], 8, v36
  v_cndmask_b32 v226, v37, 0, s[88:89]
  v_cndmask_b32 v242, 0, v37, s[88:89]
  v_cmp_le_i32 s[86:87], 9, v36
  v_cndmask_b32 v227, v37, 0, s[90:91]
  v_cndmask_b32 v243, 0, v37, s[90:91]
  v_cmp_le_i32 s[88:89], 10, v36
  v_cndmask_b32 v228, v37, 0, s[84:85]
  v_cndmask_b32 v244, 0, v37, s[84:85]
  v_cmp_le_i32 s[90:91], 11, v36
  v_cndmask_b32 v229, v37, 0, s[86:87]
  v_cndmask_b32 v245, 0, v37, s[86:87]
  v_cmp_le_i32 s[84:85], 16, v36
  v_cndmask_b32 v230, v37, 0, s[88:89]
  v_cndmask_b32 v246, 0, v37, s[88:89]
  v_cmp_le_i32 s[86:87], 17, v36
  v_cndmask_b32 v231, v37, 0, s[90:91]
  v_cndmask_b32 v247, 0, v37, s[90:91]
  v_cmp_le_i32 s[88:89], 18, v36
  v_cndmask_b32 v232, v37, 0, s[84:85]
  v_cndmask_b32 v248, 0, v37, s[84:85]
  v_cmp_le_i32 s[90:91], 19, v36
  v_cndmask_b32 v233, v37, 0, s[86:87]
  v_cndmask_b32 v249, 0, v37, s[86:87]
  v_cmp_le_i32 s[84:85], 24, v36
  v_cndmask_b32 v234, v37, 0, s[88:89]
  v_cndmask_b32 v250, 0, v37, s[88:89]
  v_cmp_le_i32 s[86:87], 25, v36
  v_cndmask_b32 v235, v37, 0, s[90:91]
  v_cndmask_b32 v251, 0, v37, s[90:91]
  v_cmp_le_i32 s[88:89], 26, v36
  v_cndmask_b32 v236, v37, 0, s[84:85]
  v_cndmask_b32 v252, 0, v37, s[84:85]
  v_cmp_le_i32 s[90:91], 27, v36
  v_cndmask_b32 v237, v37, 0, s[86:87]
  v_cndmask_b32 v253, 0, v37, s[86:87]
  v_cndmask_b32 v238, v37, 0, s[88:89]
  v_cndmask_b32 v254, 0, v37, s[88:89]
  v_cndmask_b32 v239, v37, 0, s[90:91]
  v_cndmask_b32 v255, 0, v37, s[90:91]
  buffer_load_dwordx4 v8, s[24:27], s61 offen offset:1024 lds
  buffer_load_dwordx4 v7, s[24:27], s62 offen offset:2048 lds
  buffer_load_dwordx4 v8, s[24:27], s63 offen offset:3072 lds
  s_add_u32 m0, s75, 53248
  s_nop 0
  buffer_load_dwordx4 v7, s[24:27], s64 offen offset:0 lds
  buffer_load_dwordx4 v8, s[24:27], s65 offen offset:1024 lds
  buffer_load_dwordx4 v7, s[24:27], s66 offen offset:2048 lds
  buffer_load_dwordx4 v8, s[24:27], s67 offen offset:3072 lds
  s_add_u32 s57, s57, 1
  s_and_b32 s57, s57, 7
  s_lshl_b32 s58, s57, 7
  v_add_u32 v7, s58, v5
  v_add_u32 v8, s58, v6
  s_mul_i32 s58, s57, 196608
  v_add_u32 v24, s58, v26
  s_waitcnt vmcnt(13)
  v_lshlrev_b32 v32, 16, v144
  v_and_b32 v33, 0xffff0000, v144
  v_lshlrev_b32 v34, 16, v145
  v_and_b32 v35, 0xffff0000, v145
  v_lshlrev_b32 v36, 16, v146
  v_and_b32 v37, 0xffff0000, v146
  v_lshlrev_b32 v38, 16, v147
  v_and_b32 v39, 0xffff0000, v147
  s_waitcnt vmcnt(12)
  v_lshlrev_b32 v40, 16, v148
  v_and_b32 v41, 0xffff0000, v148
  v_lshlrev_b32 v42, 16, v149
  v_and_b32 v43, 0xffff0000, v149
  v_lshlrev_b32 v44, 16, v150
  v_and_b32 v45, 0xffff0000, v150
  v_lshlrev_b32 v46, 16, v151
  v_and_b32 v47, 0xffff0000, v151
  v_add_f32 v48, v32, v33
  v_add_f32 v48, v48, v34
  v_add_f32 v48, v48, v35
  v_add_f32 v48, v48, v36
  v_add_f32 v48, v48, v37
  v_add_f32 v48, v48, v38
  v_add_f32 v48, v48, v39
  v_add_f32 v49, v40, v41
  v_add_f32 v49, v49, v42
  v_add_f32 v49, v49, v43
  v_add_f32 v49, v49, v44
  v_add_f32 v49, v49, v45
  v_add_f32 v49, v49, v46
  v_add_f32 v49, v49, v47
  v_add_f32_dpp v48, v48, v48 quad_perm:[1,0,3,2] row_mask:0xf bank_mask:0xf
  s_nop 0
  v_add_f32_dpp v49, v49, v49 quad_perm:[1,0,3,2] row_mask:0xf bank_mask:0xf
  v_add_f32_dpp v48, v48, v48 quad_perm:[2,3,0,1] row_mask:0xf bank_mask:0xf
  s_nop 0
  v_add_f32_dpp v49, v49, v49 quad_perm:[2,3,0,1] row_mask:0xf bank_mask:0xf
  v_add_f32_dpp v48, v48, v48 row_half_mirror row_mask:0xf bank_mask:0xf
  s_nop 0
  v_add_f32_dpp v49, v49, v49 row_half_mirror row_mask:0xf bank_mask:0xf
  v_add_f32_dpp v48, v48, v48 row_mirror row_mask:0xf bank_mask:0xf
  s_nop 0
  v_add_f32_dpp v49, v49, v49 row_mirror row_mask:0xf bank_mask:0xf
  v_mov_b32 v50, v48
  v_mov_b32 v51, v49
  s_nop 0
  v_permlane16_swap_b32 v48, v50
  v_permlane16_swap_b32 v49, v51
  v_add_f32 v48, v48, v50
  v_add_f32 v49, v49, v51
  v_mov_b32 v50, v48
  v_mov_b32 v51, v49
  s_nop 0
  v_permlane32_swap_b32 v48, v50
  v_permlane32_swap_b32 v49, v51
  v_add_f32 v48, v48, v50
  v_add_f32 v49, v49, v51
  v_mul_f32 v48, 0x3b000000, v48
  v_mul_f32 v49, 0x3b000000, v49
  v_sub_f32 v32, v32, v48
  v_sub_f32 v40, v40, v49
  v_sub_f32 v33, v33, v48
  v_sub_f32 v41, v41, v49
  v_sub_f32 v34, v34, v48
  v_sub_f32 v42, v42, v49
  v_sub_f32 v35, v35, v48
  v_sub_f32 v43, v43, v49
  v_sub_f32 v36, v36, v48
  v_sub_f32 v44, v44, v49
  v_sub_f32 v37, v37, v48
  v_sub_f32 v45, v45, v49
  v_sub_f32 v38, v38, v48
  v_sub_f32 v46, v46, v49
  v_sub_f32 v39, v39, v48
  v_sub_f32 v47, v47, v49
  v_mul_f32 v52, v32, v32
  v_mul_f32 v53, v40, v40
  v_fmac_f32 v52, v33, v33
  v_fmac_f32 v53, v41, v41
  v_fmac_f32 v52, v34, v34
  v_fmac_f32 v53, v42, v42
  v_fmac_f32 v52, v35, v35
  v_fmac_f32 v53, v43, v43
  v_fmac_f32 v52, v36, v36
  v_fmac_f32 v53, v44, v44
  v_fmac_f32 v52, v37, v37
  v_fmac_f32 v53, v45, v45
  v_fmac_f32 v52, v38, v38
  v_fmac_f32 v53, v46, v46
  v_fmac_f32 v52, v39, v39
  v_fmac_f32 v53, v47, v47
  s_nop 0
  v_add_f32_dpp v52, v52, v52 quad_perm:[1,0,3,2] row_mask:0xf bank_mask:0xf
  v_add_f32_dpp v53, v53, v53 quad_perm:[1,0,3,2] row_mask:0xf bank_mask:0xf
  s_nop 0
  v_add_f32_dpp v52, v52, v52 quad_perm:[2,3,0,1] row_mask:0xf bank_mask:0xf
  v_add_f32_dpp v53, v53, v53 quad_perm:[2,3,0,1] row_mask:0xf bank_mask:0xf
  s_nop 0
  v_add_f32_dpp v52, v52, v52 row_half_mirror row_mask:0xf bank_mask:0xf
  v_add_f32_dpp v53, v53, v53 row_half_mirror row_mask:0xf bank_mask:0xf
  s_nop 0
  v_add_f32_dpp v52, v52, v52 row_mirror row_mask:0xf bank_mask:0xf
  v_add_f32_dpp v53, v53, v53 row_mirror row_mask:0xf bank_mask:0xf
  v_mov_b32 v50, v52
  v_mov_b32 v51, v53
  s_nop 0
  v_permlane16_swap_b32 v52, v50
  v_permlane16_swap_b32 v53, v51
  v_add_f32 v52, v52, v50
  v_add_f32 v53, v53, v51
  v_mov_b32 v50, v52
  v_mov_b32 v51, v53
  s_nop 0
  v_permlane32_swap_b32 v52, v50
  v_permlane32_swap_b32 v53, v51
  v_add_f32 v52, v52, v50
  v_add_f32 v53, v53, v51
  v_mul_f32 v52, 0x3b000000, v52
  v_mul_f32 v53, 0x3b000000, v53
  v_cvt_pk_bf16_f32 v54, v52, v53
  v_cvt_pk_bf16_f32 v56, -v48, -v48
  v_cvt_pk_bf16_f32 v58, -v49, -v49
  v_lshlrev_b32 v52, 16, v54
  v_and_b32 v53, 0xffff0000, v54
  v_add_f32 v52, 0x3727c5ac, v52
  v_add_f32 v53, 0x3727c5ac, v53
  v_cvt_pk_bf16_f32 v54, v52, v53
  v_lshlrev_b32 v52, 16, v54
  v_and_b32 v53, 0xffff0000, v54
  v_sqrt_f32 v52, v52
  v_sqrt_f32 v53, v53
  v_cmp_eq_u32 vcc, 0, v2
  v_cvt_pk_bf16_f32 v54, v52, v53
  v_mov_b32 v50, 1073741824
  v_mov_b32 v51, s80
  v_lshlrev_b32 v57, 16, v54
  v_and_b32 v59, 0xffff0000, v54
  v_cndmask_b32 v50, v50, v51, vcc
  s_mov_b32 s71, 16384
  buffer_store_dwordx4 v[56:59], v50, s[36:39], s71 offen sc1
  v_readfirstlane_b32 s56, v12
  s_lshl_b32 s58, s53, 5
  s_add_u32 s58, s58, s55
  s_lshl_b32 s58, s58, 2
  s_mul_i32 s56, s56, 1664525
  s_add_u32 s56, s56, 1013904223
  v_cmp_eq_u32 vcc, 0, v0
  v_mov_b32 v14, 1073741824
  v_mov_b32 v13, s58
  v_cndmask_b32 v14, v14, v13, vcc
  v_mov_b32 v13, s56
  s_add_u32 m0, s76, 131072
  s_nop 0
  buffer_load_dwordx4 v24, s[28:31], 0 offen offset:0 lds
  buffer_load_dwordx4 v24, s[28:31], 0 offen offset:1024 lds
  buffer_load_dwordx4 v24, s[28:31], 0 offen offset:2048 lds
  s_add_u32 m0, s75, 98304
  s_nop 0
  buffer_load_dwordx4 v7, s[24:27], s60 offen offset:0 lds
  buffer_load_dwordx4 v8, s[24:27], s61 offen offset:1024 lds
  buffer_load_dwordx4 v7, s[24:27], s62 offen offset:2048 lds
  s_waitcnt vmcnt(6)
  s_barrier
  s_mov_b32 s71, 4096
  buffer_store_dword v13, v14, s[36:39], s71 offen sc1
  ds_read_b64_tr_b16 v[32:33], v20 offset:0
  ds_read_b64_tr_b16 v[34:35], v20 offset:256
  ds_read_b128 v[160:163], v16 offset:0
  ds_read_b64_tr_b16 v[36:37], v20 offset:1024
  ds_read_b64_tr_b16 v[38:39], v20 offset:1280
  ds_read_b128 v[164:167], v16 offset:4096
  ds_read_b64_tr_b16 v[40:41], v20 offset:2048
  ds_read_b64_tr_b16 v[42:43], v20 offset:2304
  ds_read_b64_tr_b16 v[56:57], v21 offset:0
  ds_read_b64_tr_b16 v[58:59], v21 offset:256
  s_waitcnt lgkmcnt(0)
  v_mfma_f32_32x32x16_bf16 v[176:191], v[60:63], v[56:59], 0
  ds_read_b64_tr_b16 v[44:45], v20 offset:3072
  ds_read_b64_tr_b16 v[46:47], v20 offset:3328
  ds_read_b128 v[168:171], v17 offset:0
  buffer_load_dwordx4 v8, s[24:27], s63 offen offset:3072 lds
  v_mfma_f32_32x32x16_bf16 v[64:79], v[32:35], v[160:163], 0
  ds_read_b64_tr_b16 v[48:49], v20 offset:4096
  ds_read_b64_tr_b16 v[50:51], v20 offset:4352
  ds_read_b128 v[172:175], v17 offset:4096
  s_add_u32 m0, s75, 102400
  s_nop 0
  buffer_load_dwordx4 v7, s[24:27], s64 offen offset:0 lds
  v_mfma_f32_32x32x16_bf16 v[80:95], v[32:35], v[164:167], 0
  ds_read_b64_tr_b16 v[52:53], v20 offset:5120
  ds_read_b64_tr_b16 v[54:55], v20 offset:5376
  ds_read_b64_tr_b16 v[56:57], v21 offset:3072
  v_mfma_f32_32x32x16_bf16 v[96:111], v[36:39], v[160:163], 0
  ds_read_b64_tr_b16 v[58:59], v21 offset:3328
  buffer_load_dwordx4 v8, s[24:27], s65 offen offset:1024 lds
  v_mfma_f32_32x32x16_bf16 v[112:127], v[36:39], v[164:167], 0
  v_mfma_f32_32x32x16_bf16 v[128:143], v[160:163], v[40:43], 0
  buffer_load_dwordx4 v7, s[24:27], s66 offen offset:2048 lds
  v_mfma_f32_32x32x16_bf16 v[144:159], v[164:167], v[40:43], 0
  buffer_load_dwordx4 v8, s[24:27], s67 offen offset:3072 lds
  s_add_u32 s57, s57, 1
  s_and_b32 s57, s57, 7
  s_waitcnt lgkmcnt(0)
  v_mfma_f32_32x32x16_bf16 v[176:191], v[60:63], v[56:59], v[176:191]
  ds_read_b64_tr_b16 v[32:33], v20 offset:6144
  ds_read_b64_tr_b16 v[34:35], v20 offset:6400
  ds_read_b128 v[160:163], v18 offset:0
  s_lshl_b32 s58, s57, 7
  v_add_u32 v7, s58, v5
  v_add_u32 v8, s58, v6
  v_mfma_f32_32x32x16_bf16 v[64:79], v[44:47], v[168:171], v[64:79]
  ds_read_b64_tr_b16 v[36:37], v20 offset:7168
  ds_read_b64_tr_b16 v[38:39], v20 offset:7424
  ds_read_b128 v[164:167], v18 offset:4096
  s_mul_i32 s58, s57, 196608
  v_add_u32 v24, s58, v26
  v_mfma_f32_32x32x16_bf16 v[80:95], v[44:47], v[172:175], v[80:95]
  ds_read_b64_tr_b16 v[40:41], v20 offset:8192
  ds_read_b64_tr_b16 v[42:43], v20 offset:8448
  ds_read_b64_tr_b16 v[56:57], v21 offset:6144
  v_mfma_f32_32x32x16_bf16 v[96:111], v[48:51], v[168:171], v[96:111]
  ds_read_b64_tr_b16 v[58:59], v21 offset:6400
  s_add_u32 m0, s76, 32768
  s_nop 0
  buffer_load_dwordx4 v24, s[28:31], 0 offen offset:0 lds
  v_mfma_f32_32x32x16_bf16 v[112:127], v[48:51], v[172:175], v[112:127]
  buffer_load_dwordx4 v24, s[28:31], 0 offen offset:1024 lds
  v_mfma_f32_32x32x16_bf16 v[128:143], v[168:171], v[52:55], v[128:143]
  v_mfma_f32_32x32x16_bf16 v[144:159], v[172:175], v[52:55], v[144:159]
  buffer_load_dwordx4 v24, s[28:31], 0 offen offset:2048 lds
  s_waitcnt lgkmcnt(0)
  v_mfma_f32_32x32x16_bf16 v[176:191], v[60:63], v[56:59], v[176:191]
  ds_read_b64_tr_b16 v[44:45], v20 offset:9216
  ds_read_b64_tr_b16 v[46:47], v20 offset:9472
  ds_read_b128 v[168:171], v19 offset:0
  v_mfma_f32_32x32x16_bf16 v[64:79], v[32:35], v[160:163], v[64:79]
  ds_read_b64_tr_b16 v[48:49], v20 offset:10240
  ds_read_b64_tr_b16 v[50:51], v20 offset:10496
  ds_read_b128 v[172:175], v19 offset:4096
  s_add_u32 m0, s75, 0
  s_nop 0
  buffer_load_dwordx4 v7, s[24:27], s60 offen offset:0 lds
  v_mfma_f32_32x32x16_bf16 v[80:95], v[32:35], v[164:167], v[80:95]
  ds_read_b64_tr_b16 v[52:53], v20 offset:11264
  ds_read_b64_tr_b16 v[54:55], v20 offset:11520
  ds_read_b64_tr_b16 v[56:57], v21 offset:9216
  buffer_load_dwordx4 v8, s[24:27], s61 offen offset:1024 lds
  v_mfma_f32_32x32x16_bf16 v[96:111], v[36:39], v[160:163], v[96:111]
  ds_read_b64_tr_b16 v[58:59], v21 offset:9472
  v_add_u32 v16, 49152, v16
  v_add_u32 v17, 49152, v17
  v_mfma_f32_32x32x16_bf16 v[112:127], v[36:39], v[164:167], v[112:127]
  v_add_u32 v18, 49152, v18
  v_add_u32 v19, 49152, v19
  v_add_u32 v20, 49152, v20
  buffer_load_dwordx4 v7, s[24:27], s62 offen offset:2048 lds
  v_mfma_f32_32x32x16_bf16 v[128:143], v[160:163], v[40:43], v[128:143]
  v_mfma_f32_32x32x16_bf16 v[144:159], v[164:167], v[40:43], v[144:159]
  buffer_load_dwordx4 v8, s[24:27], s63 offen offset:3072 lds
  s_waitcnt lgkmcnt(0)
  v_mfma_f32_32x32x16_bf16 v[176:191], v[60:63], v[56:59], v[176:191]
  s_waitcnt vmcnt(7) lgkmcnt(0)
  s_barrier
  ds_read_b64_tr_b16 v[32:33], v20 offset:0
  ds_read_b64_tr_b16 v[34:35], v20 offset:256
  v_mfma_f32_32x32x16_bf16 v[64:79], v[44:47], v[168:171], v[64:79]
  ds_read_b128 v[160:163], v16 offset:0
  ds_read_b64_tr_b16 v[36:37], v20 offset:1024
  ds_read_b64_tr_b16 v[38:39], v20 offset:1280
  s_add_u32 m0, s75, 4096
  s_nop 0
  buffer_load_dwordx4 v7, s[24:27], s64 offen offset:0 lds
  v_mfma_f32_32x32x16_bf16 v[80:95], v[44:47], v[172:175], v[80:95]
  ds_read_b128 v[164:167], v16 offset:4096
  ds_read_b64_tr_b16 v[40:41], v20 offset:2048
  ds_read_b64_tr_b16 v[42:43], v20 offset:2304
  buffer_load_dwordx4 v8, s[24:27], s65 offen offset:1024 lds
  v_mfma_f32_32x32x16_bf16 v[96:111], v[48:51], v[168:171], v[96:111]
  v_mfma_f32_32x32x16_bf16 v[112:127], v[48:51], v[172:175], v[112:127]
  buffer_load_dwordx4 v7, s[24:27], s66 offen offset:2048 lds
  v_mfma_f32_32x32x16_bf16 v[128:143], v[168:171], v[52:55], v[128:143]
  v_mfma_f32_32x32x16_bf16 v[144:159], v[172:175], v[52:55], v[144:159]
  buffer_load_dwordx4 v8, s[24:27], s67 offen offset:3072 lds
  s_add_u32 s57, s57, 1
  s_and_b32 s57, s57, 7
  s_waitcnt lgkmcnt(5)
  v_mfma_f32_32x32x16_bf16 v[64:79], v[32:35], v[160:163], v[64:79]
  ds_read_b64_tr_b16 v[44:45], v20 offset:3072
  ds_read_b64_tr_b16 v[46:47], v20 offset:3328
  ds_read_b128 v[168:171], v17 offset:0
  v_and_b32 v177, 0xffff0000, v176
  v_sub_f32 v176, v176, v177
  v_cvt_pk_bf16_f32 v177, v177, v176
  s_waitcnt lgkmcnt(5)
  v_mfma_f32_32x32x16_bf16 v[80:95], v[32:35], v[164:167], v[80:95]
  ds_read_b64_tr_b16 v[48:49], v20 offset:4096
  ds_read_b64_tr_b16 v[50:51], v20 offset:4352
  ds_read_b128 v[172:175], v17 offset:4096
  buffer_store_dword v177, v22, s[36:39], 0 offen sc1
  v_mfma_f32_32x32x16_bf16 v[96:111], v[36:39], v[160:163], v[96:111]
  ds_read_b64_tr_b16 v[52:53], v20 offset:5120
  ds_read_b64_tr_b16 v[54:55], v20 offset:5376
  s_lshl_b32 s58, s57, 7
  v_add_u32 v7, s58, v5
  v_add_u32 v8, s58, v6
  v_mfma_f32_32x32x16_bf16 v[112:127], v[36:39], v[164:167], v[112:127]
  s_mul_i32 s58, s57, 196608
  v_add_u32 v24, s58, v26
  s_add_u32 m0, s76, 81920
  s_nop 0
  buffer_load_dwordx4 v24, s[28:31], 0 offen offset:0 lds
  s_waitcnt lgkmcnt(8)
  v_mfma_f32_32x32x16_bf16 v[128:143], v[160:163], v[40:43], v[128:143]
  buffer_load_dwordx4 v24, s[28:31], 0 offen offset:1024 lds
  v_mfma_f32_32x32x16_bf16 v[144:159], v[164:167], v[40:43], v[144:159]
  s_waitcnt lgkmcnt(5)
  v_mfma_f32_32x32x16_bf16 v[64:79], v[44:47], v[168:171], v[64:79]
  ds_read_b64_tr_b16 v[32:33], v20 offset:6144
  ds_read_b64_tr_b16 v[34:35], v20 offset:6400
  ds_read_b128 v[160:163], v18 offset:0
  buffer_load_dwordx4 v24, s[28:31], 0 offen offset:2048 lds
  s_waitcnt lgkmcnt(5)
  v_mfma_f32_32x32x16_bf16 v[80:95], v[44:47], v[172:175], v[80:95]
  ds_read_b64_tr_b16 v[36:37], v20 offset:7168
  ds_read_b64_tr_b16 v[38:39], v20 offset:7424
  ds_read_b128 v[164:167], v18 offset:4096
  v_mfma_f32_32x32x16_bf16 v[96:111], v[48:51], v[168:171], v[96:111]
  ds_read_b64_tr_b16 v[40:41], v20 offset:8192
  ds_read_b64_tr_b16 v[42:43], v20 offset:8448
  s_add_u32 m0, s75, 49152
  s_nop 0
  buffer_load_dwordx4 v7, s[24:27], s60 offen offset:0 lds
  v_mfma_f32_32x32x16_bf16 v[112:127], v[48:51], v[172:175], v[112:127]
  buffer_load_dwordx4 v8, s[24:27], s61 offen offset:1024 lds
  s_waitcnt lgkmcnt(8)
  v_mfma_f32_32x32x16_bf16 v[128:143], v[168:171], v[52:55], v[128:143]
  v_mfma_f32_32x32x16_bf16 v[144:159], v[172:175], v[52:55], v[144:159]
  buffer_load_dwordx4 v7, s[24:27], s62 offen offset:2048 lds
  s_waitcnt lgkmcnt(5)
  v_mfma_f32_32x32x16_bf16 v[64:79], v[32:35], v[160:163], v[64:79]
  ds_read_b64_tr_b16 v[44:45], v20 offset:9216
  ds_read_b64_tr_b16 v[46:47], v20 offset:9472
  ds_read_b128 v[168:171], v19 offset:0
  s_waitcnt lgkmcnt(5)
  v_mfma_f32_32x32x16_bf16 v[80:95], v[32:35], v[164:167], v[80:95]
  ds_read_b64_tr_b16 v[48:49], v20 offset:10240
  ds_read_b64_tr_b16 v[50:51], v20 offset:10496
  ds_read_b128 v[172:175], v19 offset:4096
  buffer_load_dwordx4 v8, s[24:27], s63 offen offset:3072 lds
  v_mfma_f32_32x32x16_bf16 v[96:111], v[36:39], v[160:163], v[96:111]
  ds_read_b64_tr_b16 v[52:53], v20 offset:11264
  ds_read_b64_tr_b16 v[54:55], v20 offset:11520
  v_add_u32 v16, 4294868992, v16
  s_add_u32 m0, s75, 53248
  s_nop 0
  buffer_load_dwordx4 v7, s[24:27], s64 offen offset:0 lds
  v_mfma_f32_32x32x16_bf16 v[112:127], v[36:39], v[164:167], v[112:127]
  v_add_u32 v17, 4294868992, v17
  v_add_u32 v18, 4294868992, v18
  v_add_u32 v19, 4294868992, v19
  s_waitcnt lgkmcnt(8)
  v_mfma_f32_32x32x16_bf16 v[128:143], v[160:163], v[40:43], v[128:143]
  v_add_u32 v20, 4294868992, v20
  buffer_load_dwordx4 v8, s[24:27], s65 offen offset:1024 lds
  v_mfma_f32_32x32x16_bf16 v[144:159], v[164:167], v[40:43], v[144:159]
  s_waitcnt lgkmcnt(5)
  v_mfma_f32_32x32x16_bf16 v[64:79], v[44:47], v[168:171], v[64:79]
  s_waitcnt vmcnt(9) lgkmcnt(0)
  s_barrier
  ds_read_b64_tr_b16 v[32:33], v20 offset:0
  ds_read_b64_tr_b16 v[34:35], v20 offset:256
  v_mfma_f32_32x32x16_bf16 v[80:95], v[44:47], v[172:175], v[80:95]
  ds_read_b128 v[160:163], v16 offset:0
  ds_read_b64_tr_b16 v[36:37], v20 offset:1024
  ds_read_b64_tr_b16 v[38:39], v20 offset:1280
  s_mov_b32 s71, 5120
  buffer_store_dword v13, v14, s[36:39], s71 offen sc1
  v_mfma_f32_32x32x16_bf16 v[96:111], v[48:51], v[168:171], v[96:111]
  ds_read_b128 v[164:167], v16 offset:4096
  ds_read_b64_tr_b16 v[40:41], v20 offset:2048
  ds_read_b64_tr_b16 v[42:43], v20 offset:2304
  buffer_load_dwordx4 v7, s[24:27], s66 offen offset:2048 lds
  v_mfma_f32_32x32x16_bf16 v[112:127], v[48:51], v[172:175], v[112:127]
  v_mfma_f32_32x32x16_bf16 v[128:143], v[168:171], v[52:55], v[128:143]
  buffer_load_dwordx4 v8, s[24:27], s67 offen offset:3072 lds
  s_add_u32 s57, s57, 1
  s_and_b32 s57, s57, 7
  v_mfma_f32_32x32x16_bf16 v[144:159], v[172:175], v[52:55], v[144:159]
  s_lshl_b32 s58, s57, 7
  v_add_u32 v7, s58, v5
  v_add_u32 v8, s58, v6
  s_mul_i32 s58, s57, 196608
  v_add_u32 v24, s58, v26
  s_waitcnt lgkmcnt(5)
  v_mfma_f32_32x32x16_bf16 v[64:79], v[32:35], v[160:163], v[64:79]
  ds_read_b64_tr_b16 v[44:45], v20 offset:3072
  ds_read_b64_tr_b16 v[46:47], v20 offset:3328
  ds_read_b128 v[168:171], v17 offset:0
  s_waitcnt lgkmcnt(5)
  v_mfma_f32_32x32x16_bf16 v[80:95], v[32:35], v[164:167], v[80:95]
  ds_read_b64_tr_b16 v[48:49], v20 offset:4096
  ds_read_b64_tr_b16 v[50:51], v20 offset:4352
  ds_read_b128 v[172:175], v17 offset:4096
  v_mfma_f32_32x32x16_bf16 v[96:111], v[36:39], v[160:163], v[96:111]
  ds_read_b64_tr_b16 v[52:53], v20 offset:5120
  ds_read_b64_tr_b16 v[54:55], v20 offset:5376
  s_add_u32 m0, s76, 131072
  s_nop 0
  buffer_load_dwordx4 v24, s[28:31], 0 offen offset:0 lds
  v_mfma_f32_32x32x16_bf16 v[112:127], v[36:39], v[164:167], v[112:127]
  buffer_load_dwordx4 v24, s[28:31], 0 offen offset:1024 lds
  s_waitcnt lgkmcnt(8)
  v_mfma_f32_32x32x16_bf16 v[128:143], v[160:163], v[40:43], v[128:143]
  v_mfma_f32_32x32x16_bf16 v[144:159], v[164:167], v[40:43], v[144:159]
  buffer_load_dwordx4 v24, s[28:31], 0 offen offset:2048 lds
  s_waitcnt lgkmcnt(5)
  v_mfma_f32_32x32x16_bf16 v[64:79], v[44:47], v[168:171], v[64:79]
  ds_read_b64_tr_b16 v[32:33], v20 offset:6144
  ds_read_b64_tr_b16 v[34:35], v20 offset:6400
  ds_read_b128 v[160:163], v18 offset:0
  s_waitcnt lgkmcnt(5)
  v_mfma_f32_32x32x16_bf16 v[80:95], v[44:47], v[172:175], v[80:95]
  ds_read_b64_tr_b16 v[36:37], v20 offset:7168
  ds_read_b64_tr_b16 v[38:39], v20 offset:7424
  ds_read_b128 v[164:167], v18 offset:4096
  s_add_u32 m0, s75, 98304
  s_nop 0
  buffer_load_dwordx4 v7, s[24:27], s60 offen offset:0 lds
  v_mfma_f32_32x32x16_bf16 v[96:111], v[48:51], v[168:171], v[96:111]
  ds_read_b64_tr_b16 v[40:41], v20 offset:8192
  ds_read_b64_tr_b16 v[42:43], v20 offset:8448
  buffer_load_dwordx4 v8, s[24:27], s61 offen offset:1024 lds
  v_mfma_f32_32x32x16_bf16 v[112:127], v[48:51], v[172:175], v[112:127]
  s_waitcnt lgkmcnt(8)
  v_mfma_f32_32x32x16_bf16 v[128:143], v[168:171], v[52:55], v[128:143]
  buffer_load_dwordx4 v7, s[24:27], s62 offen offset:2048 lds
  v_mfma_f32_32x32x16_bf16 v[144:159], v[172:175], v[52:55], v[144:159]
  s_waitcnt lgkmcnt(5)
  v_mfma_f32_32x32x16_bf16 v[64:79], v[32:35], v[160:163], v[64:79]
  ds_read_b64_tr_b16 v[44:45], v20 offset:9216
  ds_read_b64_tr_b16 v[46:47], v20 offset:9472
  ds_read_b128 v[168:171], v19 offset:0
  buffer_load_dwordx4 v8, s[24:27], s63 offen offset:3072 lds
  s_waitcnt lgkmcnt(5)
  v_mfma_f32_32x32x16_bf16 v[80:95], v[32:35], v[164:167], v[80:95]
  ds_read_b64_tr_b16 v[48:49], v20 offset:10240
  ds_read_b64_tr_b16 v[50:51], v20 offset:10496
  ds_read_b128 v[172:175], v19 offset:4096
  s_add_u32 m0, s75, 102400
  s_nop 0
  buffer_load_dwordx4 v7, s[24:27], s64 offen offset:0 lds
  v_mfma_f32_32x32x16_bf16 v[96:111], v[36:39], v[160:163], v[96:111]
  ds_read_b64_tr_b16 v[52:53], v20 offset:11264
  ds_read_b64_tr_b16 v[54:55], v20 offset:11520
  v_add_u32 v16, 49152, v16
  v_mfma_f32_32x32x16_bf16 v[112:127], v[36:39], v[164:167], v[112:127]
  v_add_u32 v17, 49152, v17
  v_add_u32 v18, 49152, v18
  v_add_u32 v19, 49152, v19
  buffer_load_dwordx4 v8, s[24:27], s65 offen offset:1024 lds
  s_waitcnt lgkmcnt(8)
  v_mfma_f32_32x32x16_bf16 v[128:143], v[160:163], v[40:43], v[128:143]
  v_add_u32 v20, 49152, v20
  v_mfma_f32_32x32x16_bf16 v[144:159], v[164:167], v[40:43], v[144:159]
  buffer_load_dwordx4 v7, s[24:27], s66 offen offset:2048 lds
  s_waitcnt lgkmcnt(5)
  v_mfma_f32_32x32x16_bf16 v[64:79], v[44:47], v[168:171], v[64:79]
  s_waitcnt vmcnt(10) lgkmcnt(0)
  s_barrier
  ds_read_b64_tr_b16 v[32:33], v20 offset:0
  ds_read_b64_tr_b16 v[34:35], v20 offset:256
  v_mfma_f32_32x32x16_bf16 v[80:95], v[44:47], v[172:175], v[80:95]
  ds_read_b128 v[160:163], v16 offset:0
  ds_read_b64_tr_b16 v[36:37], v20 offset:1024
  ds_read_b64_tr_b16 v[38:39], v20 offset:1280
  buffer_load_dwordx4 v8, s[24:27], s67 offen offset:3072 lds
  v_mfma_f32_32x32x16_bf16 v[96:111], v[48:51], v[168:171], v[96:111]
  ds_read_b128 v[164:167], v16 offset:4096
  ds_read_b64_tr_b16 v[40:41], v20 offset:2048
  ds_read_b64_tr_b16 v[42:43], v20 offset:2304
  s_add_u32 s57, s57, 1
  s_and_b32 s57, s57, 7
  v_mfma_f32_32x32x16_bf16 v[112:127], v[48:51], v[172:175], v[112:127]
  s_lshl_b32 s58, s57, 7
  v_add_u32 v7, s58, v5
  v_add_u32 v8, s58, v6
  s_mul_i32 s58, s57, 196608
  v_add_u32 v24, s58, v26
  v_mfma_f32_32x32x16_bf16 v[128:143], v[168:171], v[52:55], v[128:143]
  s_add_u32 m0, s76, 32768
  s_nop 0
  buffer_load_dwordx4 v24, s[28:31], 0 offen offset:0 lds
  v_mfma_f32_32x32x16_bf16 v[144:159], v[172:175], v[52:55], v[144:159]
  buffer_load_dwordx4 v24, s[28:31], 0 offen offset:1024 lds
  s_waitcnt lgkmcnt(5)
  v_mfma_f32_32x32x16_bf16 v[64:79], v[32:35], v[160:163], v[64:79]
  ds_read_b64_tr_b16 v[44:45], v20 offset:3072
  ds_read_b64_tr_b16 v[46:47], v20 offset:3328
  ds_read_b128 v[168:171], v17 offset:0
  s_waitcnt lgkmcnt(5)
  v_mfma_f32_32x32x16_bf16 v[80:95], v[32:35], v[164:167], v[80:95]
  ds_read_b64_tr_b16 v[48:49], v20 offset:4096
  ds_read_b64_tr_b16 v[50:51], v20 offset:4352
  ds_read_b128 v[172:175], v17 offset:4096
  buffer_load_dwordx4 v24, s[28:31], 0 offen offset:2048 lds
  v_mfma_f32_32x32x16_bf16 v[96:111], v[36:39], v[160:163], v[96:111]
  ds_read_b64_tr_b16 v[52:53], v20 offset:5120
  ds_read_b64_tr_b16 v[54:55], v20 offset:5376
  v_mfma_f32_32x32x16_bf16 v[112:127], v[36:39], v[164:167], v[112:127]
  s_add_u32 m0, s75, 0
  s_nop 0
  buffer_load_dwordx4 v7, s[24:27], s60 offen offset:0 lds
  s_waitcnt lgkmcnt(8)
  v_mfma_f32_32x32x16_bf16 v[128:143], v[160:163], v[40:43], v[128:143]
  buffer_load_dwordx4 v8, s[24:27], s61 offen offset:1024 lds
  v_mfma_f32_32x32x16_bf16 v[144:159], v[164:167], v[40:43], v[144:159]
  s_waitcnt lgkmcnt(5)
  v_mfma_f32_32x32x16_bf16 v[64:79], v[44:47], v[168:171], v[64:79]
  ds_read_b64_tr_b16 v[32:33], v20 offset:6144
  ds_read_b64_tr_b16 v[34:35], v20 offset:6400
  ds_read_b128 v[160:163], v18 offset:0
  buffer_load_dwordx4 v7, s[24:27], s62 offen offset:2048 lds
  s_waitcnt lgkmcnt(5)
  v_mfma_f32_32x32x16_bf16 v[80:95], v[44:47], v[172:175], v[80:95]
  ds_read_b64_tr_b16 v[36:37], v20 offset:7168
  ds_read_b64_tr_b16 v[38:39], v20 offset:7424
  ds_read_b128 v[164:167], v18 offset:4096
  v_mfma_f32_32x32x16_bf16 v[96:111], v[48:51], v[168:171], v[96:111]
  ds_read_b64_tr_b16 v[40:41], v20 offset:8192
  ds_read_b64_tr_b16 v[42:43], v20 offset:8448
  buffer_load_dwordx4 v8, s[24:27], s63 offen offset:3072 lds
  v_mfma_f32_32x32x16_bf16 v[112:127], v[48:51], v[172:175], v[112:127]
  s_add_u32 m0, s75, 4096
  s_nop 0
  buffer_load_dwordx4 v7, s[24:27], s64 offen offset:0 lds
  s_waitcnt lgkmcnt(8)
  v_mfma_f32_32x32x16_bf16 v[128:143], v[168:171], v[52:55], v[128:143]
  v_mfma_f32_32x32x16_bf16 v[144:159], v[172:175], v[52:55], v[144:159]
  buffer_load_dwordx4 v8, s[24:27], s65 offen offset:1024 lds
  s_waitcnt lgkmcnt(5)
  v_mfma_f32_32x32x16_bf16 v[64:79], v[32:35], v[160:163], v[64:79]
  ds_read_b64_tr_b16 v[44:45], v20 offset:9216
  ds_read_b64_tr_b16 v[46:47], v20 offset:9472
  ds_read_b128 v[168:171], v19 offset:0
  s_waitcnt lgkmcnt(5)
  v_mfma_f32_32x32x16_bf16 v[80:95], v[32:35], v[164:167], v[80:95]
  ds_read_b64_tr_b16 v[48:49], v20 offset:10240
  ds_read_b64_tr_b16 v[50:51], v20 offset:10496
  ds_read_b128 v[172:175], v19 offset:4096
  buffer_load_dwordx4 v7, s[24:27], s66 offen offset:2048 lds
  v_mfma_f32_32x32x16_bf16 v[96:111], v[36:39], v[160:163], v[96:111]
  ds_read_b64_tr_b16 v[52:53], v20 offset:11264
  ds_read_b64_tr_b16 v[54:55], v20 offset:11520
  v_add_u32 v16, 49152, v16
  buffer_load_dwordx4 v8, s[24:27], s67 offen offset:3072 lds
  v_mfma_f32_32x32x16_bf16 v[112:127], v[36:39], v[164:167], v[112:127]
  v_add_u32 v17, 49152, v17
  v_add_u32 v18, 49152, v18
  v_add_u32 v19, 49152, v19
  s_add_u32 s57, s57, 1
  s_and_b32 s57, s57, 7
  s_waitcnt lgkmcnt(8)
  v_mfma_f32_32x32x16_bf16 v[128:143], v[160:163], v[40:43], v[128:143]
  v_add_u32 v20, 49152, v20
  s_lshl_b32 s58, s57, 7
  v_add_u32 v7, s58, v5
  v_add_u32 v8, s58, v6
  s_mul_i32 s58, s57, 196608
  v_add_u32 v24, s58, v26
  v_mfma_f32_32x32x16_bf16 v[144:159], v[164:167], v[40:43], v[144:159]
  s_waitcnt lgkmcnt(5)
  v_mfma_f32_32x32x16_bf16 v[64:79], v[44:47], v[168:171], v[64:79]
  s_waitcnt vmcnt(11) lgkmcnt(0)
  s_barrier
  ds_read_b64_tr_b16 v[32:33], v20 offset:0
  ds_read_b64_tr_b16 v[34:35], v20 offset:256
  v_mfma_f32_32x32x16_bf16 v[80:95], v[44:47], v[172:175], v[80:95]
  ds_read_b128 v[160:163], v16 offset:0
  ds_read_b64_tr_b16 v[36:37], v20 offset:1024
  ds_read_b64_tr_b16 v[38:39], v20 offset:1280
  v_mfma_f32_32x32x16_bf16 v[96:111], v[48:51], v[168:171], v[96:111]
  ds_read_b128 v[164:167], v16 offset:4096
  ds_read_b64_tr_b16 v[40:41], v20 offset:2048
  ds_read_b64_tr_b16 v[42:43], v20 offset:2304
  v_mfma_f32_32x32x16_bf16 v[112:127], v[48:51], v[172:175], v[112:127]
  s_add_u32 m0, s76, 81920
  s_nop 0
  buffer_load_dwordx4 v24, s[28:31], 0 offen offset:0 lds
  v_mfma_f32_32x32x16_bf16 v[128:143], v[168:171], v[52:55], v[128:143]
  buffer_load_dwordx4 v24, s[28:31], 0 offen offset:1024 lds
  v_mfma_f32_32x32x16_bf16 v[144:159], v[172:175], v[52:55], v[144:159]
  s_waitcnt lgkmcnt(5)
  v_mfma_f32_32x32x16_bf16 v[64:79], v[32:35], v[160:163], v[64:79]
  ds_read_b64_tr_b16 v[44:45], v20 offset:3072
  ds_read_b64_tr_b16 v[46:47], v20 offset:3328
  ds_read_b128 v[168:171], v17 offset:0
  buffer_load_dwordx4 v24, s[28:31], 0 offen offset:2048 lds
  s_waitcnt lgkmcnt(5)
  v_mfma_f32_32x32x16_bf16 v[80:95], v[32:35], v[164:167], v[80:95]
  ds_read_b64_tr_b16 v[48:49], v20 offset:4096
  ds_read_b64_tr_b16 v[50:51], v20 offset:4352
  ds_read_b128 v[172:175], v17 offset:4096
  v_mfma_f32_32x32x16_bf16 v[96:111], v[36:39], v[160:163], v[96:111]
  ds_read_b64_tr_b16 v[52:53], v20 offset:5120
  ds_read_b64_tr_b16 v[54:55], v20 offset:5376
  s_add_u32 m0, s75, 49152
  s_nop 0
  buffer_load_dwordx4 v7, s[24:27], s60 offen offset:0 lds
  v_mfma_f32_32x32x16_bf16 v[112:127], v[36:39], v[164:167], v[112:127]
  buffer_load_dwordx4 v8, s[24:27], s61 offen offset:1024 lds
  s_waitcnt lgkmcnt(8)
  v_mfma_f32_32x32x16_bf16 v[128:143], v[160:163], v[40:43], v[128:143]
  v_mfma_f32_32x32x16_bf16 v[144:159], v[164:167], v[40:43], v[144:159]
  buffer_load_dwordx4 v7, s[24:27], s62 offen offset:2048 lds
  s_waitcnt lgkmcnt(5)
  v_mfma_f32_32x32x16_bf16 v[64:79], v[44:47], v[168:171], v[64:79]
  ds_read_b64_tr_b16 v[32:33], v20 offset:6144
  ds_read_b64_tr_b16 v[34:35], v20 offset:6400
  ds_read_b128 v[160:163], v18 offset:0
  s_waitcnt lgkmcnt(5)
  v_mfma_f32_32x32x16_bf16 v[80:95], v[44:47], v[172:175], v[80:95]
  ds_read_b64_tr_b16 v[36:37], v20 offset:7168
  ds_read_b64_tr_b16 v[38:39], v20 offset:7424
  ds_read_b128 v[164:167], v18 offset:4096
  buffer_load_dwordx4 v8, s[24:27], s63 offen offset:3072 lds
  v_mfma_f32_32x32x16_bf16 v[96:111], v[48:51], v[168:171], v[96:111]
  ds_read_b64_tr_b16 v[40:41], v20 offset:8192
  ds_read_b64_tr_b16 v[42:43], v20 offset:8448
  s_add_u32 m0, s75, 53248
  s_nop 0
  buffer_load_dwordx4 v7, s[24:27], s64 offen offset:0 lds
  v_mfma_f32_32x32x16_bf16 v[112:127], v[48:51], v[172:175], v[112:127]
  s_waitcnt lgkmcnt(8)
  v_mfma_f32_32x32x16_bf16 v[128:143], v[168:171], v[52:55], v[128:143]
  buffer_load_dwordx4 v8, s[24:27], s65 offen offset:1024 lds
  v_mfma_f32_32x32x16_bf16 v[144:159], v[172:175], v[52:55], v[144:159]
  s_waitcnt lgkmcnt(5)
  v_mfma_f32_32x32x16_bf16 v[64:79], v[32:35], v[160:163], v[64:79]
  ds_read_b64_tr_b16 v[44:45], v20 offset:9216
  ds_read_b64_tr_b16 v[46:47], v20 offset:9472
  ds_read_b128 v[168:171], v19 offset:0
  buffer_load_dwordx4 v7, s[24:27], s66 offen offset:2048 lds
  s_waitcnt lgkmcnt(5)
  v_mfma_f32_32x32x16_bf16 v[80:95], v[32:35], v[164:167], v[80:95]
  ds_read_b64_tr_b16 v[48:49], v20 offset:10240
  ds_read_b64_tr_b16 v[50:51], v20 offset:10496
  ds_read_b128 v[172:175], v19 offset:4096
  buffer_load_dwordx4 v8, s[24:27], s67 offen offset:3072 lds
  v_mfma_f32_32x32x16_bf16 v[96:111], v[36:39], v[160:163], v[96:111]
  ds_read_b64_tr_b16 v[52:53], v20 offset:11264
  ds_read_b64_tr_b16 v[54:55], v20 offset:11520
  v_add_u32 v16, 4294868992, v16
  s_add_u32 s57, s57, 1
  s_and_b32 s57, s57, 7
  v_mfma_f32_32x32x16_bf16 v[112:127], v[36:39], v[164:167], v[112:127]
  v_add_u32 v17, 4294868992, v17
  v_add_u32 v18, 4294868992, v18
  v_add_u32 v19, 4294868992, v19
  s_lshl_b32 s58, s57, 7
  v_add_u32 v7, s58, v5
  v_add_u32 v8, s58, v6
  s_waitcnt lgkmcnt(8)
  v_mfma_f32_32x32x16_bf16 v[128:143], v[160:163], v[40:43], v[128:143]
  v_add_u32 v20, 4294868992, v20
  s_mul_i32 s58, s57, 196608
  v_add_u32 v24, s58, v26
  v_mfma_f32_32x32x16_bf16 v[144:159], v[164:167], v[40:43], v[144:159]
  s_waitcnt lgkmcnt(5)
  v_mfma_f32_32x32x16_bf16 v[64:79], v[44:47], v[168:171], v[64:79]
  s_waitcnt vmcnt(11) lgkmcnt(0)
  s_barrier
  ds_read_b64_tr_b16 v[32:33], v20 offset:0
  ds_read_b64_tr_b16 v[34:35], v20 offset:256
  v_mfma_f32_32x32x16_bf16 v[80:95], v[44:47], v[172:175], v[80:95]
  ds_read_b128 v[160:163], v16 offset:0
  ds_read_b64_tr_b16 v[36:37], v20 offset:1024
  ds_read_b64_tr_b16 v[38:39], v20 offset:1280
  v_mfma_f32_32x32x16_bf16 v[96:111], v[48:51], v[168:171], v[96:111]
  ds_read_b128 v[164:167], v16 offset:4096
  ds_read_b64_tr_b16 v[40:41], v20 offset:2048
  ds_read_b64_tr_b16 v[42:43], v20 offset:2304
  v_mfma_f32_32x32x16_bf16 v[112:127], v[48:51], v[172:175], v[112:127]
  s_add_u32 m0, s76, 131072
  s_nop 0
  buffer_load_dwordx4 v24, s[28:31], 0 offen offset:0 lds
  v_mfma_f32_32x32x16_bf16 v[128:143], v[168:171], v[52:55], v[128:143]
  buffer_load_dwordx4 v24, s[28:31], 0 offen offset:1024 lds
  v_mfma_f32_32x32x16_bf16 v[144:159], v[172:175], v[52:55], v[144:159]
  s_waitcnt lgkmcnt(5)
  v_mfma_f32_32x32x16_bf16 v[64:79], v[32:35], v[160:163], v[64:79]
  ds_read_b64_tr_b16 v[44:45], v20 offset:3072
  ds_read_b64_tr_b16 v[46:47], v20 offset:3328
  ds_read_b128 v[168:171], v17 offset:0
  buffer_load_dwordx4 v24, s[28:31], 0 offen offset:2048 lds
  s_waitcnt lgkmcnt(5)
  v_mfma_f32_32x32x16_bf16 v[80:95], v[32:35], v[164:167], v[80:95]
  ds_read_b64_tr_b16 v[48:49], v20 offset:4096
  ds_read_b64_tr_b16 v[50:51], v20 offset:4352
  ds_read_b128 v[172:175], v17 offset:4096
  v_mfma_f32_32x32x16_bf16 v[96:111], v[36:39], v[160:163], v[96:111]
  ds_read_b64_tr_b16 v[52:53], v20 offset:5120
  ds_read_b64_tr_b16 v[54:55], v20 offset:5376
  s_add_u32 m0, s75, 98304
  s_nop 0
  buffer_load_dwordx4 v7, s[24:27], s60 offen offset:0 lds
  v_mfma_f32_32x32x16_bf16 v[112:127], v[36:39], v[164:167], v[112:127]
  buffer_load_dwordx4 v8, s[24:27], s61 offen offset:1024 lds
  s_waitcnt lgkmcnt(8)
  v_mfma_f32_32x32x16_bf16 v[128:143], v[160:163], v[40:43], v[128:143]
  v_mfma_f32_32x32x16_bf16 v[144:159], v[164:167], v[40:43], v[144:159]
  buffer_load_dwordx4 v7, s[24:27], s62 offen offset:2048 lds
  s_waitcnt lgkmcnt(5)
  v_mfma_f32_32x32x16_bf16 v[64:79], v[44:47], v[168:171], v[64:79]
  ds_read_b64_tr_b16 v[32:33], v20 offset:6144
  ds_read_b64_tr_b16 v[34:35], v20 offset:6400
  ds_read_b128 v[160:163], v18 offset:0
  s_waitcnt lgkmcnt(5)
  v_mfma_f32_32x32x16_bf16 v[80:95], v[44:47], v[172:175], v[80:95]
  ds_read_b64_tr_b16 v[36:37], v20 offset:7168
  ds_read_b64_tr_b16 v[38:39], v20 offset:7424
  ds_read_b128 v[164:167], v18 offset:4096
  buffer_load_dwordx4 v8, s[24:27], s63 offen offset:3072 lds
  v_mfma_f32_32x32x16_bf16 v[96:111], v[48:51], v[168:171], v[96:111]
  ds_read_b64_tr_b16 v[40:41], v20 offset:8192
  ds_read_b64_tr_b16 v[42:43], v20 offset:8448
  s_add_u32 m0, s75, 102400
  s_nop 0
  buffer_load_dwordx4 v7, s[24:27], s64 offen offset:0 lds
  v_mfma_f32_32x32x16_bf16 v[112:127], v[48:51], v[172:175], v[112:127]
  s_waitcnt lgkmcnt(8)
  v_mfma_f32_32x32x16_bf16 v[128:143], v[168:171], v[52:55], v[128:143]
  buffer_load_dwordx4 v8, s[24:27], s65 offen offset:1024 lds
  v_mfma_f32_32x32x16_bf16 v[144:159], v[172:175], v[52:55], v[144:159]
  s_waitcnt lgkmcnt(5)
  v_mfma_f32_32x32x16_bf16 v[64:79], v[32:35], v[160:163], v[64:79]
  ds_read_b64_tr_b16 v[44:45], v20 offset:9216
  ds_read_b64_tr_b16 v[46:47], v20 offset:9472
  ds_read_b128 v[168:171], v19 offset:0
  buffer_load_dwordx4 v7, s[24:27], s66 offen offset:2048 lds
  s_waitcnt lgkmcnt(5)
  v_mfma_f32_32x32x16_bf16 v[80:95], v[32:35], v[164:167], v[80:95]
  ds_read_b64_tr_b16 v[48:49], v20 offset:10240
  ds_read_b64_tr_b16 v[50:51], v20 offset:10496
  ds_read_b128 v[172:175], v19 offset:4096
  buffer_load_dwordx4 v8, s[24:27], s67 offen offset:3072 lds
  v_mfma_f32_32x32x16_bf16 v[96:111], v[36:39], v[160:163], v[96:111]
  ds_read_b64_tr_b16 v[52:53], v20 offset:11264
  ds_read_b64_tr_b16 v[54:55], v20 offset:11520
  v_add_u32 v16, 49152, v16
  s_add_u32 s57, s57, 1
  s_and_b32 s57, s57, 7
  v_mfma_f32_32x32x16_bf16 v[112:127], v[36:39], v[164:167], v[112:127]
  v_add_u32 v17, 49152, v17
  v_add_u32 v18, 49152, v18
  v_add_u32 v19, 49152, v19
  s_lshl_b32 s58, s57, 7
  v_add_u32 v7, s58, v5
  v_add_u32 v8, s58, v6
  s_waitcnt lgkmcnt(8)
  v_mfma_f32_32x32x16_bf16 v[128:143], v[160:163], v[40:43], v[128:143]
  v_add_u32 v20, 49152, v20
  s_mul_i32 s58, s57, 196608
  v_add_u32 v24, s58, v26
  buffer_load_dword v193, v192, s[36:39], 0 offen sc1
  v_mfma_f32_32x32x16_bf16 v[144:159], v[164:167], v[40:43], v[144:159]
  s_waitcnt lgkmcnt(5)
  v_mfma_f32_32x32x16_bf16 v[64:79], v[44:47], v[168:171], v[64:79]
  s_waitcnt vmcnt(12) lgkmcnt(0)
  s_barrier
  ds_read_b64_tr_b16 v[32:33], v20 offset:0
  ds_read_b64_tr_b16 v[34:35], v20 offset:256
  v_mfma_f32_32x32x16_bf16 v[80:95], v[44:47], v[172:175], v[80:95]
  ds_read_b128 v[160:163], v16 offset:0
  ds_read_b64_tr_b16 v[36:37], v20 offset:1024
  ds_read_b64_tr_b16 v[38:39], v20 offset:1280
  v_mfma_f32_32x32x16_bf16 v[96:111], v[48:51], v[168:171], v[96:111]
  ds_read_b128 v[164:167], v16 offset:4096
  ds_read_b64_tr_b16 v[40:41], v20 offset:2048
  ds_read_b64_tr_b16 v[42:43], v20 offset:2304
  v_mfma_f32_32x32x16_bf16 v[112:127], v[48:51], v[172:175], v[112:127]
  v_mfma_f32_32x32x16_bf16 v[128:143], v[168:171], v[52:55], v[128:143]
  v_mfma_f32_32x32x16_bf16 v[144:159], v[172:175], v[52:55], v[144:159]
  s_waitcnt lgkmcnt(5)
  v_mfma_f32_32x32x16_bf16 v[64:79], v[32:35], v[160:163], v[64:79]
  ds_read_b64_tr_b16 v[44:45], v20 offset:3072
  ds_read_b64_tr_b16 v[46:47], v20 offset:3328
  ds_read_b128 v[168:171], v17 offset:0
  s_waitcnt lgkmcnt(5)
  v_mfma_f32_32x32x16_bf16 v[80:95], v[32:35], v[164:167], v[80:95]
  ds_read_b64_tr_b16 v[48:49], v20 offset:4096
  ds_read_b64_tr_b16 v[50:51], v20 offset:4352
  ds_read_b128 v[172:175], v17 offset:4096
  v_mfma_f32_32x32x16_bf16 v[96:111], v[36:39], v[160:163], v[96:111]
  ds_read_b64_tr_b16 v[52:53], v20 offset:5120
  ds_read_b64_tr_b16 v[54:55], v20 offset:5376
  v_mfma_f32_32x32x16_bf16 v[112:127], v[36:39], v[164:167], v[112:127]
  s_waitcnt lgkmcnt(8)
  v_mfma_f32_32x32x16_bf16 v[128:143], v[160:163], v[40:43], v[128:143]
  v_mfma_f32_32x32x16_bf16 v[144:159], v[164:167], v[40:43], v[144:159]
  s_waitcnt lgkmcnt(5)
  v_mfma_f32_32x32x16_bf16 v[64:79], v[44:47], v[168:171], v[64:79]
  ds_read_b64_tr_b16 v[32:33], v20 offset:6144
  ds_read_b64_tr_b16 v[34:35], v20 offset:6400
  ds_read_b128 v[160:163], v18 offset:0
  s_waitcnt vmcnt(0)
  v_cmp_ne_u32 vcc, s56, v193
  s_nop 0
  s_cbranch_vccnz L_slow13
L_back13:
  s_waitcnt lgkmcnt(5)
  v_mfma_f32_32x32x16_bf16 v[80:95], v[44:47], v[172:175], v[80:95]
  ds_read_b64_tr_b16 v[36:37], v20 offset:7168
  ds_read_b64_tr_b16 v[38:39], v20 offset:7424
  ds_read_b128 v[164:167], v18 offset:4096
  buffer_load_dwordx2 v[194:195], v198, s[36:39], 0 offen sc1
  v_mfma_f32_32x32x16_bf16 v[96:111], v[48:51], v[168:171], v[96:111]
  ds_read_b64_tr_b16 v[40:41], v20 offset:8192
  ds_read_b64_tr_b16 v[42:43], v20 offset:8448
  buffer_load_dwordx2 v[196:197], v199, s[36:39], 0 offen sc1
  v_mfma_f32_32x32x16_bf16 v[112:127], v[48:51], v[172:175], v[112:127]
  s_waitcnt lgkmcnt(8)
  v_mfma_f32_32x32x16_bf16 v[128:143], v[168:171], v[52:55], v[128:143]
  s_lshl_b32 s70, s52, 10
  s_add_u32 m0, s70, 159744
  s_nop 0
  buffer_load_dwordx4 v201, s[36:39], s78 offen sc1 lds
  v_mfma_f32_32x32x16_bf16 v[144:159], v[172:175], v[52:55], v[144:159]
  s_waitcnt lgkmcnt(5)
  v_mfma_f32_32x32x16_bf16 v[64:79], v[32:35], v[160:163], v[64:79]
  ds_read_b64_tr_b16 v[44:45], v20 offset:9216
  ds_read_b64_tr_b16 v[46:47], v20 offset:9472
  ds_read_b128 v[168:171], v19 offset:0
  buffer_load_dword v192, v223, s[40:43], 0 offen
  s_waitcnt lgkmcnt(5)
  v_mfma_f32_32x32x16_bf16 v[80:95], v[32:35], v[164:167], v[80:95]
  ds_read_b64_tr_b16 v[48:49], v20 offset:10240
  ds_read_b64_tr_b16 v[50:51], v20 offset:10496
  ds_read_b128 v[172:175], v19 offset:4096
  v_mfma_f32_32x32x16_bf16 v[96:111], v[36:39], v[160:163], v[96:111]
  ds_read_b64_tr_b16 v[52:53], v20 offset:11264
  ds_read_b64_tr_b16 v[54:55], v20 offset:11520
  v_add_u32 v16, 49152, v16
  v_mfma_f32_32x32x16_bf16 v[112:127], v[36:39], v[164:167], v[112:127]
  v_add_u32 v17, 49152, v17
  v_add_u32 v18, 49152, v18
  v_add_u32 v19, 49152, v19
  s_waitcnt lgkmcnt(8)
  v_mfma_f32_32x32x16_bf16 v[128:143], v[160:163], v[40:43], v[128:143]
  v_add_u32 v20, 49152, v20
  s_mov_b32 s84, s8
  s_mov_b32 s85, s9
  s_mov_b32 s86, 524288
  s_mov_b32 s87, 0x20000
  v_subrev_u32 v223, 1835008, v223
  v_mfma_f32_32x32x16_bf16 v[144:159], v[164:167], v[40:43], v[144:159]
  buffer_load_dword v193, v223, s[84:87], 0 offen
  s_waitcnt lgkmcnt(5)
  v_mfma_f32_32x32x16_bf16 v[64:79], v[44:47], v[168:171], v[64:79]
  s_waitcnt lgkmcnt(0)
  s_barrier
  ds_read_b64_tr_b16 v[32:33], v20 offset:0
  ds_read_b64_tr_b16 v[34:35], v20 offset:256
  v_mfma_f32_32x32x16_bf16 v[80:95], v[44:47], v[172:175], v[80:95]
  ds_read_b128 v[160:163], v16 offset:0
  ds_read_b64_tr_b16 v[36:37], v20 offset:1024
  ds_read_b64_tr_b16 v[38:39], v20 offset:1280
  v_mfma_f32_32x32x16_bf16 v[96:111], v[48:51], v[168:171], v[96:111]
  ds_read_b128 v[164:167], v16 offset:4096
  ds_read_b64_tr_b16 v[40:41], v20 offset:2048
  ds_read_b64_tr_b16 v[42:43], v20 offset:2304
  v_mfma_f32_32x32x16_bf16 v[112:127], v[48:51], v[172:175], v[112:127]
  v_mfma_f32_32x32x16_bf16 v[128:143], v[168:171], v[52:55], v[128:143]
  v_mfma_f32_32x32x16_bf16 v[144:159], v[172:175], v[52:55], v[144:159]
  s_waitcnt lgkmcnt(5)
  v_mfma_f32_32x32x16_bf16 v[64:79], v[32:35], v[160:163], v[64:79]
  ds_read_b64_tr_b16 v[44:45], v20 offset:3072
  ds_read_b64_tr_b16 v[46:47], v20 offset:3328
  ds_read_b128 v[168:171], v17 offset:0
  s_waitcnt lgkmcnt(5)
  v_mfma_f32_32x32x16_bf16 v[80:95], v[32:35], v[164:167], v[80:95]
  ds_read_b64_tr_b16 v[48:49], v20 offset:4096
  ds_read_b64_tr_b16 v[50:51], v20 offset:4352
  ds_read_b128 v[172:175], v17 offset:4096
  v_mfma_f32_32x32x16_bf16 v[96:111], v[36:39], v[160:163], v[96:111]
  ds_read_b64_tr_b16 v[52:53], v20 offset:5120
  ds_read_b64_tr_b16 v[54:55], v20 offset:5376
  v_mfma_f32_32x32x16_bf16 v[112:127], v[36:39], v[164:167], v[112:127]
  s_waitcnt lgkmcnt(8)
  v_mfma_f32_32x32x16_bf16 v[128:143], v[160:163], v[40:43], v[128:143]
  v_mfma_f32_32x32x16_bf16 v[144:159], v[164:167], v[40:43], v[144:159]
  s_waitcnt lgkmcnt(5)
  v_mfma_f32_32x32x16_bf16 v[64:79], v[44:47], v[168:171], v[64:79]
  ds_read_b64_tr_b16 v[32:33], v20 offset:6144
  ds_read_b64_tr_b16 v[34:35], v20 offset:6400
  ds_read_b128 v[160:163], v18 offset:0
  s_waitcnt lgkmcnt(5)
  v_mfma_f32_32x32x16_bf16 v[80:95], v[44:47], v[172:175], v[80:95]
  ds_read_b64_tr_b16 v[36:37], v20 offset:7168
  ds_read_b64_tr_b16 v[38:39], v20 offset:7424
  ds_read_b128 v[164:167], v18 offset:4096
  v_mfma_f32_32x32x16_bf16 v[96:111], v[48:51], v[168:171], v[96:111]
  ds_read_b64_tr_b16 v[40:41], v20 offset:8192
  ds_read_b64_tr_b16 v[42:43], v20 offset:8448
  v_mfma_f32_32x32x16_bf16 v[112:127], v[48:51], v[172:175], v[112:127]
  s_waitcnt lgkmcnt(8)
  v_mfma_f32_32x32x16_bf16 v[128:143], v[168:171], v[52:55], v[128:143]
  v_mfma_f32_32x32x16_bf16 v[144:159], v[172:175], v[52:55], v[144:159]
  s_waitcnt lgkmcnt(5)
  v_mfma_f32_32x32x16_bf16 v[64:79], v[32:35], v[160:163], v[64:79]
  ds_read_b64_tr_b16 v[44:45], v20 offset:9216
  ds_read_b64_tr_b16 v[46:47], v20 offset:9472
  ds_read_b128 v[168:171], v19 offset:0
  s_waitcnt lgkmcnt(5)
  v_mfma_f32_32x32x16_bf16 v[80:95], v[32:35], v[164:167], v[80:95]
  ds_read_b64_tr_b16 v[48:49], v20 offset:10240
  ds_read_b64_tr_b16 v[50:51], v20 offset:10496
  ds_read_b128 v[172:175], v19 offset:4096
  v_mfma_f32_32x32x16_bf16 v[96:111], v[36:39], v[160:163], v[96:111]
  ds_read_b64_tr_b16 v[52:53], v20 offset:11264
  ds_read_b64_tr_b16 v[54:55], v20 offset:11520
  v_mfma_f32_32x32x16_bf16 v[112:127], v[36:39], v[164:167], v[112:127]
  s_waitcnt lgkmcnt(8)
  v_mfma_f32_32x32x16_bf16 v[128:143], v[160:163], v[40:43], v[128:143]
  v_mfma_f32_32x32x16_bf16 v[144:159], v[164:167], v[40:43], v[144:159]
  s_waitcnt lgkmcnt(5)
  v_mfma_f32_32x32x16_bf16 v[64:79], v[44:47], v[168:171], v[64:79]
  s_waitcnt vmcnt(2) lgkmcnt(0)
  s_barrier
  ds_read_b32 v36, v200 offset:1024
  ds_read_b32 v37, v200 offset:1152
  ds_read_b32 v38, v200 offset:1280
  ds_read_b32 v39, v200 offset:1408
  v_mfma_f32_32x32x16_bf16 v[80:95], v[44:47], v[172:175], v[80:95]
  ds_read_b32 v40, v200 offset:2048
  ds_read_b32 v41, v200 offset:2176
  ds_read_b32 v42, v200 offset:2304
  ds_read_b32 v43, v200 offset:2432
  ds_read_b32 v32, v200 offset:0
  v_mfma_f32_32x32x16_bf16 v[96:111], v[48:51], v[168:171], v[96:111]
  ds_read_b32 v33, v200 offset:128
  ds_read_b32 v34, v200 offset:256
  ds_read_b32 v35, v200 offset:384
  v_mov_b32 v176, v194
  v_mov_b32 v177, v194
  v_mfma_f32_32x32x16_bf16 v[112:127], v[48:51], v[172:175], v[112:127]
  v_mov_b32 v178, v194
  v_mov_b32 v179, v194
  v_rcp_f32 v184, v195
  v_mov_b32 v180, v196
  v_mov_b32 v181, v196
  v_mfma_f32_32x32x16_bf16 v[128:143], v[168:171], v[52:55], v[128:143]
  v_mov_b32 v182, v196
  v_mov_b32 v183, v196
  v_rcp_f32 v185, v197
  v_mfma_f32_32x32x16_bf16 v[144:159], v[172:175], v[52:55], v[144:159]
  ds_write_b32 v220, v184
  ds_write_b32 v220, v185 offset:128
  s_waitcnt lgkmcnt(10)
  v_mfma_f32_32x32x16_bf16 v[96:111], v[36:39], v[176:179], v[96:111]
  v_mul_f32 v186, 0x3eb8aa3b, v184
  v_mul_f32 v187, 0x3eb8aa3b, v185
  v_and_b32 v48, 31, v2
  s_cmp_eq_u32 s53, 0
  s_cselect_b32 s69, 16, 0
  v_cmp_le_u32 vcc, s69, v48
  v_mfma_f32_32x32x16_bf16 v[112:127], v[36:39], v[180:183], v[112:127]
  v_mov_b32 v52, 0x3f803f80
  v_cndmask_b32 v52, 0, v52, vcc
  v_mov_b32 v53, v52
  v_mov_b32 v54, v52
  s_waitcnt lgkmcnt(6)
  v_mfma_f32_32x32x16_bf16 v[128:143], v[176:179], v[40:43], v[128:143]
  v_mov_b32 v55, v52
  ds_write_b128 v222, v[52:55]
  ds_read_b128 v[160:163], v221 offset:0
  ds_read_b128 v[164:167], v221 offset:32
  v_mfma_f32_32x32x16_bf16 v[144:159], v[180:183], v[40:43], v[144:159]
  ds_read_b128 v[168:171], v221 offset:64
  ds_read_b128 v[172:175], v221 offset:96
  s_waitcnt lgkmcnt(7)
  v_mfma_f32_32x32x16_bf16 v[64:79], v[32:35], v[176:179], v[64:79]
  v_mfma_f32_32x32x16_bf16 v[80:95], v[32:35], v[180:183], v[80:95]
  v_mul_f32 v96, v184, v96
  v_mul_f32 v97, v184, v97
  v_mul_f32 v98, v184, v98
  v_mul_f32 v99, v184, v99
  v_mul_f32 v100, v184, v100
  v_mul_f32 v101, v184, v101
  v_mul_f32 v102, v184, v102
  v_mul_f32 v103, v184, v103
  v_mul_f32 v104, v184, v104
  v_mul_f32 v105, v184, v105
  v_mul_f32 v106, v184, v106
  v_mul_f32 v107, v184, v107
  v_mul_f32 v108, v184, v108
  v_mul_f32 v109, v184, v109
  v_mul_f32 v110, v184, v110
  v_mul_f32 v111, v184, v111
  v_cvt_pk_bf16_f32 v96, v96, v97
  v_cvt_pk_bf16_f32 v97, v98, v99
  v_cvt_pk_bf16_f32 v98, v100, v101
  v_cvt_pk_bf16_f32 v99, v102, v103
  v_cvt_pk_bf16_f32 v100, v104, v105
  v_cvt_pk_bf16_f32 v101, v106, v107
  v_cvt_pk_bf16_f32 v102, v108, v109
  v_cvt_pk_bf16_f32 v103, v110, v111
  buffer_store_dwordx4 v[96:99], v206, s[36:39], s96 offen sc1
  ds_write_b128 v202, v[96:99] offset:8192
  buffer_store_dwordx4 v[100:103], v206, s[36:39], s97 offen sc1
  ds_write_b128 v202, v[100:103] offset:24576
  v_mul_f32 v112, v185, v112
  v_mul_f32 v113, v185, v113
  v_mul_f32 v114, v185, v114
  v_mul_f32 v115, v185, v115
  v_mul_f32 v116, v185, v116
  v_mul_f32 v117, v185, v117
  v_mul_f32 v118, v185, v118
  v_mul_f32 v119, v185, v119
  v_mul_f32 v120, v185, v120
  v_mul_f32 v121, v185, v121
  v_mul_f32 v122, v185, v122
  v_mul_f32 v123, v185, v123
  v_mul_f32 v124, v185, v124
  v_mul_f32 v125, v185, v125
  v_mul_f32 v126, v185, v126
  v_mul_f32 v127, v185, v127
  v_cvt_pk_bf16_f32 v112, v112, v113
  v_cvt_pk_bf16_f32 v113, v114, v115
  v_cvt_pk_bf16_f32 v114, v116, v117
  v_cvt_pk_bf16_f32 v115, v118, v119
  v_cvt_pk_bf16_f32 v116, v120, v121
  v_cvt_pk_bf16_f32 v117, v122, v123
  v_cvt_pk_bf16_f32 v118, v124, v125
  v_cvt_pk_bf16_f32 v119, v126, v127
  buffer_store_dwordx4 v[112:115], v207, s[36:39], s96 offen sc1
  ds_write_b128 v203, v[112:115] offset:8192
  buffer_store_dwordx4 v[116:119], v207, s[36:39], s97 offen sc1
  ds_write_b128 v203, v[116:119] offset:24576
  s_waitcnt lgkmcnt(7)
  v_mul_f32 v128, v160, v128
  v_mul_f32 v129, v161, v129
  v_mul_f32 v130, v162, v130
  v_mul_f32 v131, v163, v131
  s_waitcnt lgkmcnt(6)
  v_mul_f32 v132, v164, v132
  v_mul_f32 v133, v165, v133
  v_mul_f32 v134, v166, v134
  v_mul_f32 v135, v167, v135
  s_waitcnt lgkmcnt(5)
  v_mul_f32 v136, v168, v136
  v_mul_f32 v137, v169, v137
  v_mul_f32 v138, v170, v138
  v_mul_f32 v139, v171, v139
  s_waitcnt lgkmcnt(4)
  v_mul_f32 v140, v172, v140
  v_mul_f32 v141, v173, v141
  v_mul_f32 v142, v174, v142
  v_mul_f32 v143, v175, v143
  ds_read_b128 v[160:163], v221 offset:128
  ds_read_b128 v[164:167], v221 offset:160
  ds_read_b128 v[168:171], v221 offset:192
  ds_read_b128 v[172:175], v221 offset:224
  v_cvt_pk_bf16_f32 v128, v128, v129
  v_cvt_pk_bf16_f32 v129, v130, v131
  v_cvt_pk_bf16_f32 v130, v132, v133
  v_cvt_pk_bf16_f32 v131, v134, v135
  v_cvt_pk_bf16_f32 v132, v136, v137
  v_cvt_pk_bf16_f32 v133, v138, v139
  v_cvt_pk_bf16_f32 v134, v140, v141
  v_cvt_pk_bf16_f32 v135, v142, v143
  buffer_store_dwordx4 v[128:131], v208, s[36:39], s96 offen offset:0 sc1
  ds_write_b128 v204, v[128:131] offset:0
  buffer_store_dwordx4 v[132:135], v208, s[36:39], s96 offen offset:1024 sc1
  ds_write_b128 v204, v[132:135] offset:1040
  s_waitcnt lgkmcnt(5)
  v_mul_f32 v144, v160, v144
  v_mul_f32 v145, v161, v145
  v_mul_f32 v146, v162, v146
  v_mul_f32 v147, v163, v147
  s_waitcnt lgkmcnt(4)
  v_mul_f32 v148, v164, v148
  v_mul_f32 v149, v165, v149
  v_mul_f32 v150, v166, v150
  v_mul_f32 v151, v167, v151
  s_waitcnt lgkmcnt(3)
  v_mul_f32 v152, v168, v152
  v_mul_f32 v153, v169, v153
  v_mul_f32 v154, v170, v154
  v_mul_f32 v155, v171, v155
  s_waitcnt lgkmcnt(2)
  v_mul_f32 v156, v172, v156
  v_mul_f32 v157, v173, v157
  v_mul_f32 v158, v174, v158
  v_mul_f32 v159, v175, v159
  v_cvt_pk_bf16_f32 v144, v144, v145
  v_cvt_pk_bf16_f32 v145, v146, v147
  v_cvt_pk_bf16_f32 v146, v148, v149
  v_cvt_pk_bf16_f32 v147, v150, v151
  v_cvt_pk_bf16_f32 v148, v152, v153
  v_cvt_pk_bf16_f32 v149, v154, v155
  v_cvt_pk_bf16_f32 v150, v156, v157
  v_cvt_pk_bf16_f32 v151, v158, v159
  buffer_store_dwordx4 v[144:147], v209, s[36:39], s96 offen offset:0 sc1
  ds_write_b128 v205, v[144:147] offset:0
  buffer_store_dwordx4 v[148:151], v209, s[36:39], s96 offen offset:1024 sc1
  ds_write_b128 v205, v[148:151] offset:1040
  v_mul_f32 v64, v186, v64
  v_mul_f32 v65, v186, v65
  v_mul_f32 v66, v186, v66
  v_mul_f32 v67, v186, v67
  v_mul_f32 v68, v186, v68
  v_mul_f32 v69, v186, v69
  v_mul_f32 v70, v186, v70
  v_mul_f32 v71, v186, v71
  v_mul_f32 v72, v186, v72
  v_mul_f32 v73, v186, v73
  v_mul_f32 v74, v186, v74
  v_mul_f32 v75, v186, v75
  v_mul_f32 v76, v186, v76
  v_mul_f32 v77, v186, v77
  v_mul_f32 v78, v186, v78
  v_mul_f32 v79, v186, v79
  v_cvt_pk_bf16_f32 v32, v64, v65
  v_cvt_pk_bf16_f32 v33, v66, v67
  v_cvt_pk_bf16_f32 v34, v68, v69
  v_cvt_pk_bf16_f32 v35, v70, v71
  v_cvt_pk_bf16_f32 v36, v72, v73
  v_cvt_pk_bf16_f32 v37, v74, v75
  v_cvt_pk_bf16_f32 v38, v76, v77
  v_cvt_pk_bf16_f32 v39, v78, v79
  v_mul_f32 v80, v187, v80
  v_mul_f32 v81, v187, v81
  v_mul_f32 v82, v187, v82
  v_mul_f32 v83, v187, v83
  v_mul_f32 v84, v187, v84
  v_mul_f32 v85, v187, v85
  v_mul_f32 v86, v187, v86
  v_mul_f32 v87, v187, v87
  v_mul_f32 v88, v187, v88
  v_mul_f32 v89, v187, v89
  v_mul_f32 v90, v187, v90
  v_mul_f32 v91, v187, v91
  v_mul_f32 v92, v187, v92
  v_mul_f32 v93, v187, v93
  v_mul_f32 v94, v187, v94
  v_mul_f32 v95, v187, v95
  v_cvt_pk_bf16_f32 v40, v80, v81
  v_cvt_pk_bf16_f32 v41, v82, v83
  v_cvt_pk_bf16_f32 v42, v84, v85
  v_cvt_pk_bf16_f32 v43, v86, v87
  v_cvt_pk_bf16_f32 v44, v88, v89
  v_cvt_pk_bf16_f32 v45, v90, v91
  v_cvt_pk_bf16_f32 v46, v92, v93
  v_cvt_pk_bf16_f32 v47, v94, v95
  v_dot2_f32_bf16 v48, v96, v96, 0
  v_dot2_f32_bf16 v49, v100, v100, 0
  v_dot2_f32_bf16 v50, v112, v112, 0
  v_dot2_f32_bf16 v51, v116, v116, 0
  v_dot2_f32_bf16 v52, v32, v32, 0
  v_dot2_f32_bf16 v53, v36, v36, 0
  v_dot2_f32_bf16 v54, v40, v40, 0
  v_dot2_f32_bf16 v55, v44, v44, 0
  v_dot2_f32_bf16 v48, v97, v97, v48
  v_dot2_f32_bf16 v49, v101, v101, v49
  v_dot2_f32_bf16 v50, v113, v113, v50
  v_dot2_f32_bf16 v51, v117, v117, v51
  v_dot2_f32_bf16 v52, v33, v33, v52
  v_dot2_f32_bf16 v53, v37, v37, v53
  v_dot2_f32_bf16 v54, v41, v41, v54
  v_dot2_f32_bf16 v55, v45, v45, v55
  v_dot2_f32_bf16 v48, v98, v98, v48
  v_dot2_f32_bf16 v49, v102, v102, v49
  v_dot2_f32_bf16 v50, v114, v114, v50
  v_dot2_f32_bf16 v51, v118, v118, v51
  v_dot2_f32_bf16 v52, v34, v34, v52
  v_dot2_f32_bf16 v53, v38, v38, v53
  v_dot2_f32_bf16 v54, v42, v42, v54
  v_dot2_f32_bf16 v55, v46, v46, v55
  v_dot2_f32_bf16 v48, v99, v99, v48
  v_dot2_f32_bf16 v49, v103, v103, v49
  v_dot2_f32_bf16 v50, v115, v115, v50
  v_dot2_f32_bf16 v51, v119, v119, v51
  v_dot2_f32_bf16 v52, v35, v35, v52
  v_dot2_f32_bf16 v53, v39, v39, v53
  v_dot2_f32_bf16 v54, v43, v43, v54
  v_dot2_f32_bf16 v55, v47, v47, v55
  v_max3_f32 v48, v48, v49, v50
  s_nop 0
  v_max3_f32 v52, v52, v53, v54
  v_max_f32 v48, v48, v51
  v_max_f32 v52, v52, v55
  v_cmp_nge_f32 vcc, 0x42de0000, v48
  s_nop 0
  s_mov_b64 s[84:85], vcc
  v_cmp_nge_f32 vcc, 0x41666666, v52
  s_lshl_b32 s58, s52, 2
  s_add_u32 s58, s58, 153600
  v_mov_b32 v49, s58
  s_or_b64 s[84:85], s[84:85], vcc
  s_cselect_b32 s58, 1, 0
  v_mov_b32 v48, s58
  ds_write_b32 v49, v48
  v_mov_b32 v49, 153600
  s_waitcnt lgkmcnt(0)
  s_barrier
  ds_read_b128 v[52:55], v49
  ds_read_b128 a[0:3], v203 offset:8192
  ds_read_b128 a[4:7], v203 offset:7168
  ds_read_b128 a[8:11], v211 offset:16640
  ds_read_b128 a[12:15], v211 offset:17680
  s_waitcnt lgkmcnt(4)
  v_or3_b32 v52, v52, v53, v54
  v_or_b32 v52, v52, v55
  s_nop 0
  v_readfirstlane_b32 s98, v52
  s_nop 0
  s_cmp_lg_u32 s98, 0
  s_cbranch_scc1 L_exactA
  s_waitcnt lgkmcnt(3)
  v_mfma_f32_32x32x16_bf16 v[64:79], a[0:3], v[40:43], v[224:239]
  s_nop 11
  v_exp_f32 v64, v64
  v_exp_f32 v65, v65
  v_exp_f32 v66, v66
  v_exp_f32 v67, v67
  s_waitcnt lgkmcnt(2)
  v_mfma_f32_32x32x16_bf16 v[80:95], a[4:7], v[40:43], 0
  v_exp_f32 v68, v68
  v_exp_f32 v69, v69
  v_exp_f32 v70, v70
  v_exp_f32 v71, v71
  v_cvt_pk_bf16_f32 v64, v64, v65
  v_cvt_pk_bf16_f32 v65, v66, v67
  v_cvt_pk_bf16_f32 v66, v68, v69
  v_cvt_pk_bf16_f32 v67, v70, v71
  v_exp_f32 v72, v72
  v_exp_f32 v73, v73
  s_waitcnt lgkmcnt(1)
  v_mfma_f32_32x32x16_bf16 v[128:143], a[8:11], v[64:67], 0
  v_exp_f32 v74, v74
  v_exp_f32 v75, v75
  v_exp_f32 v76, v76
  v_exp_f32 v77, v77
  v_exp_f32 v78, v78
  v_exp_f32 v79, v79
  v_cvt_pk_bf16_f32 v68, v72, v73
  v_cvt_pk_bf16_f32 v69, v74, v75
  v_cvt_pk_bf16_f32 v70, v76, v77
  v_cvt_pk_bf16_f32 v71, v78, v79
  ds_read_b128 a[0:3], v203 offset:6144
  ds_read_b128 a[16:19], v211 offset:14560
  ds_read_b128 a[20:23], v211 offset:15600
  s_waitcnt lgkmcnt(3)
  v_mfma_f32_32x32x16_bf16 v[128:143], a[12:15], v[68:71], v[128:143]
  v_exp_f32 v80, v80
  v_exp_f32 v81, v81
  v_exp_f32 v82, v82
  v_exp_f32 v83, v83
  s_waitcnt lgkmcnt(2)
  v_mfma_f32_32x32x16_bf16 v[64:79], a[0:3], v[40:43], 0
  v_exp_f32 v84, v84
  v_exp_f32 v85, v85
  v_exp_f32 v86, v86
  v_exp_f32 v87, v87
  v_cvt_pk_bf16_f32 v80, v80, v81
  v_cvt_pk_bf16_f32 v81, v82, v83
  v_cvt_pk_bf16_f32 v82, v84, v85
  v_cvt_pk_bf16_f32 v83, v86, v87
  v_exp_f32 v88, v88
  v_exp_f32 v89, v89
  s_waitcnt lgkmcnt(1)
  v_mfma_f32_32x32x16_bf16 v[128:143], a[16:19], v[80:83], v[128:143]
  v_exp_f32 v90, v90
  v_exp_f32 v91, v91
  v_exp_f32 v92, v92
  v_exp_f32 v93, v93
  v_exp_f32 v94, v94
  v_exp_f32 v95, v95
  v_cvt_pk_bf16_f32 v84, v88, v89
  v_cvt_pk_bf16_f32 v85, v90, v91
  v_cvt_pk_bf16_f32 v86, v92, v93
  v_cvt_pk_bf16_f32 v87, v94, v95
  ds_read_b128 a[4:7], v203 offset:5120
  ds_read_b128 a[8:11], v211 offset:12480
  ds_read_b128 a[12:15], v211 offset:13520
  s_waitcnt lgkmcnt(3)
  v_mfma_f32_32x32x16_bf16 v[128:143], a[20:23], v[84:87], v[128:143]
  v_exp_f32 v64, v64
  v_exp_f32 v65, v65
  v_exp_f32 v66, v66
  v_exp_f32 v67, v67
  s_waitcnt lgkmcnt(2)
  v_mfma_f32_32x32x16_bf16 v[80:95], a[4:7], v[40:43], 0
  v_exp_f32 v68, v68
  v_exp_f32 v69, v69
  v_exp_f32 v70, v70
  v_exp_f32 v71, v71
  v_cvt_pk_bf16_f32 v64, v64, v65
  v_cvt_pk_bf16_f32 v65, v66, v67
  v_cvt_pk_bf16_f32 v66, v68, v69
  v_cvt_pk_bf16_f32 v67, v70, v71
  v_exp_f32 v72, v72
  v_exp_f32 v73, v73
  s_waitcnt lgkmcnt(1)
  v_mfma_f32_32x32x16_bf16 v[128:143], a[8:11], v[64:67], v[128:143]
  v_exp_f32 v74, v74
  v_exp_f32 v75, v75
  v_exp_f32 v76, v76
  v_exp_f32 v77, v77
  v_exp_f32 v78, v78
  v_exp_f32 v79, v79
  v_cvt_pk_bf16_f32 v68, v72, v73
  v_cvt_pk_bf16_f32 v69, v74, v75
  v_cvt_pk_bf16_f32 v70, v76, v77
  v_cvt_pk_bf16_f32 v71, v78, v79
  ds_read_b128 a[0:3], v203 offset:4096
  ds_read_b128 a[16:19], v211 offset:10400
  ds_read_b128 a[20:23], v211 offset:11440
  s_waitcnt lgkmcnt(3)
  v_mfma_f32_32x32x16_bf16 v[128:143], a[12:15], v[68:71], v[128:143]
  v_exp_f32 v80, v80
  v_exp_f32 v81, v81
  v_exp_f32 v82, v82
  v_exp_f32 v83, v83
  s_waitcnt lgkmcnt(2)
  v_mfma_f32_32x32x16_bf16 v[64:79], a[0:3], v[40:43], 0
  v_exp_f32 v84, v84
  v_exp_f32 v85, v85
  v_exp_f32 v86, v86
  v_exp_f32 v87, v87
  s_waitcnt vmcnt(0)
  s_barrier
  s_add_u32 s71, s56, s98
  v_mov_b32 v48, s71
  s_mov_b32 s71, 7168
  buffer_store_dword v48, v14, s[36:39], s71 offen sc1
  v_cvt_pk_bf16_f32 v80, v80, v81
  v_cvt_pk_bf16_f32 v81, v82, v83
  v_cvt_pk_bf16_f32 v82, v84, v85
  v_cvt_pk_bf16_f32 v83, v86, v87
  v_exp_f32 v88, v88
  v_exp_f32 v89, v89
  s_waitcnt lgkmcnt(1)
  v_mfma_f32_32x32x16_bf16 v[128:143], a[16:19], v[80:83], v[128:143]
  v_exp_f32 v90, v90
  v_exp_f32 v91, v91
  v_exp_f32 v92, v92
  v_exp_f32 v93, v93
  v_exp_f32 v94, v94
  v_exp_f32 v95, v95
  v_cvt_pk_bf16_f32 v84, v88, v89
  v_cvt_pk_bf16_f32 v85, v90, v91
  v_cvt_pk_bf16_f32 v86, v92, v93
  v_cvt_pk_bf16_f32 v87, v94, v95
  ds_read_b128 a[4:7], v202 offset:8192
  ds_read_b128 a[8:11], v211 offset:8320
  ds_read_b128 a[12:15], v211 offset:9360
  s_waitcnt lgkmcnt(3)
  v_mfma_f32_32x32x16_bf16 v[128:143], a[20:23], v[84:87], v[128:143]
  v_exp_f32 v64, v64
  v_exp_f32 v65, v65
  v_exp_f32 v66, v66
  v_exp_f32 v67, v67
  s_waitcnt lgkmcnt(2)
  v_mfma_f32_32x32x16_bf16 v[80:95], a[4:7], v[32:35], v[224:239]
  v_exp_f32 v68, v68
  v_exp_f32 v69, v69
  v_exp_f32 v70, v70
  v_exp_f32 v71, v71
  v_cvt_pk_bf16_f32 v64, v64, v65
  v_cvt_pk_bf16_f32 v65, v66, v67
  v_cvt_pk_bf16_f32 v66, v68, v69
  v_cvt_pk_bf16_f32 v67, v70, v71
  v_exp_f32 v72, v72
  v_exp_f32 v73, v73
  s_waitcnt lgkmcnt(1)
  v_mfma_f32_32x32x16_bf16 v[128:143], a[8:11], v[64:67], v[128:143]
  v_exp_f32 v74, v74
  v_exp_f32 v75, v75
  v_exp_f32 v76, v76
  v_exp_f32 v77, v77
  v_exp_f32 v78, v78
  v_exp_f32 v79, v79
  v_cvt_pk_bf16_f32 v68, v72, v73
  v_cvt_pk_bf16_f32 v69, v74, v75
  v_cvt_pk_bf16_f32 v70, v76, v77
  v_cvt_pk_bf16_f32 v71, v78, v79
  ds_read_b128 a[0:3], v203 offset:24576
  ds_read_b128 a[16:19], v210 offset:16640
  ds_read_b128 a[20:23], v210 offset:17680
  s_waitcnt lgkmcnt(3)
  v_mfma_f32_32x32x16_bf16 v[128:143], a[12:15], v[68:71], v[128:143]
  v_exp_f32 v80, v80
  v_exp_f32 v81, v81
  v_exp_f32 v82, v82
  v_exp_f32 v83, v83
  s_waitcnt lgkmcnt(2)
  v_mfma_f32_32x32x16_bf16 v[64:79], a[0:3], v[44:47], v[224:239]
  v_exp_f32 v84, v84
  v_exp_f32 v85, v85
  v_exp_f32 v86, v86
  v_exp_f32 v87, v87
  v_cvt_pk_bf16_f32 v80, v80, v81
  v_cvt_pk_bf16_f32 v81, v82, v83
  v_cvt_pk_bf16_f32 v82, v84, v85
  v_cvt_pk_bf16_f32 v83, v86, v87
  v_exp_f32 v88, v88
  v_exp_f32 v89, v89
  s_waitcnt lgkmcnt(1)
  v_mfma_f32_32x32x16_bf16 v[96:111], a[16:19], v[80:83], 0
  v_exp_f32 v90, v90
  v_exp_f32 v91, v91
  v_exp_f32 v92, v92
  v_exp_f32 v93, v93
  v_exp_f32 v94, v94
  v_exp_f32 v95, v95
  v_cvt_pk_bf16_f32 v84, v88, v89
  v_cvt_pk_bf16_f32 v85, v90, v91
  v_cvt_pk_bf16_f32 v86, v92, v93
  v_cvt_pk_bf16_f32 v87, v94, v95
  ds_read_b128 a[4:7], v203 offset:23552
  ds_read_b128 a[8:11], v213 offset:16640
  ds_read_b128 a[12:15], v213 offset:17680
  s_waitcnt lgkmcnt(3)
  v_mfma_f32_32x32x16_bf16 v[96:111], a[20:23], v[84:87], v[96:111]
  v_exp_f32 v64, v64
  v_exp_f32 v65, v65
  v_exp_f32 v66, v66
  v_exp_f32 v67, v67
  s_waitcnt lgkmcnt(2)
  v_mfma_f32_32x32x16_bf16 v[80:95], a[4:7], v[44:47], 0
  v_exp_f32 v68, v68
  v_exp_f32 v69, v69
  v_exp_f32 v70, v70
  v_exp_f32 v71, v71
  v_cvt_pk_bf16_f32 v64, v64, v65
  v_cvt_pk_bf16_f32 v65, v66, v67
  v_cvt_pk_bf16_f32 v66, v68, v69
  v_cvt_pk_bf16_f32 v67, v70, v71
  v_exp_f32 v72, v72
  v_exp_f32 v73, v73
  s_waitcnt lgkmcnt(1)
  v_mfma_f32_32x32x16_bf16 v[144:159], a[8:11], v[64:67], 0
  v_exp_f32 v74, v74
  v_exp_f32 v75, v75
  v_exp_f32 v76, v76
  v_exp_f32 v77, v77
  v_exp_f32 v78, v78
  v_exp_f32 v79, v79
  v_cvt_pk_bf16_f32 v68, v72, v73
  v_cvt_pk_bf16_f32 v69, v74, v75
  v_cvt_pk_bf16_f32 v70, v76, v77
  v_cvt_pk_bf16_f32 v71, v78, v79
  ds_read_b128 a[0:3], v203 offset:22528
  ds_read_b128 a[16:19], v213 offset:14560
  ds_read_b128 a[20:23], v213 offset:15600
  s_waitcnt lgkmcnt(3)
  v_mfma_f32_32x32x16_bf16 v[144:159], a[12:15], v[68:71], v[144:159]
  v_exp_f32 v80, v80
  v_exp_f32 v81, v81
  v_exp_f32 v82, v82
  v_exp_f32 v83, v83
  s_waitcnt lgkmcnt(2)
  v_mfma_f32_32x32x16_bf16 v[64:79], a[0:3], v[44:47], 0
  v_exp_f32 v84, v84
  v_exp_f32 v85, v85
  v_exp_f32 v86, v86
  v_exp_f32 v87, v87
  v_cvt_pk_bf16_f32 v80, v80, v81
  v_cvt_pk_bf16_f32 v81, v82, v83
  v_cvt_pk_bf16_f32 v82, v84, v85
  v_cvt_pk_bf16_f32 v83, v86, v87
  v_exp_f32 v88, v88
  v_exp_f32 v89, v89
  s_waitcnt lgkmcnt(1)
  v_mfma_f32_32x32x16_bf16 v[144:159], a[16:19], v[80:83], v[144:159]
  v_exp_f32 v90, v90
  v_exp_f32 v91, v91
  v_exp_f32 v92, v92
  v_exp_f32 v93, v93
  v_exp_f32 v94, v94
  v_exp_f32 v95, v95
  v_cvt_pk_bf16_f32 v84, v88, v89
  v_cvt_pk_bf16_f32 v85, v90, v91
  v_cvt_pk_bf16_f32 v86, v92, v93
  v_cvt_pk_bf16_f32 v87, v94, v95
  ds_read_b128 a[4:7], v203 offset:21504
  ds_read_b128 a[8:11], v213 offset:12480
  ds_read_b128 a[12:15], v213 offset:13520
  s_waitcnt lgkmcnt(3)
  v_mfma_f32_32x32x16_bf16 v[144:159], a[20:23], v[84:87], v[144:159]
  v_exp_f32 v64, v64
  v_exp_f32 v65, v65
  v_exp_f32 v66, v66
  v_exp_f32 v67, v67
  s_waitcnt lgkmcnt(2)
  v_mfma_f32_32x32x16_bf16 v[80:95], a[4:7], v[44:47], 0
  v_exp_f32 v68, v68
  v_exp_f32 v69, v69
  v_exp_f32 v70, v70
  v_exp_f32 v71, v71
  buffer_load_dword v215, v214, s[36:39], 0 offen sc1
  v_cvt_pk_bf16_f32 v64, v64, v65
  v_cvt_pk_bf16_f32 v65, v66, v67
  v_cvt_pk_bf16_f32 v66, v68, v69
  v_cvt_pk_bf16_f32 v67, v70, v71
  v_exp_f32 v72, v72
  v_exp_f32 v73, v73
  s_waitcnt lgkmcnt(1)
  v_mfma_f32_32x32x16_bf16 v[144:159], a[8:11], v[64:67], v[144:159]
  v_exp_f32 v74, v74
  v_exp_f32 v75, v75
  v_exp_f32 v76, v76
  v_exp_f32 v77, v77
  v_exp_f32 v78, v78
  v_exp_f32 v79, v79
  v_cvt_pk_bf16_f32 v68, v72, v73
  v_cvt_pk_bf16_f32 v69, v74, v75
  v_cvt_pk_bf16_f32 v70, v76, v77
  v_cvt_pk_bf16_f32 v71, v78, v79
  ds_read_b128 a[0:3], v203 offset:20480
  ds_read_b128 a[16:19], v213 offset:10400
  ds_read_b128 a[20:23], v213 offset:11440
  s_waitcnt lgkmcnt(3)
  v_mfma_f32_32x32x16_bf16 v[144:159], a[12:15], v[68:71], v[144:159]
  v_exp_f32 v80, v80
  v_exp_f32 v81, v81
  v_exp_f32 v82, v82
  v_exp_f32 v83, v83
  s_waitcnt lgkmcnt(2)
  v_mfma_f32_32x32x16_bf16 v[64:79], a[0:3], v[44:47], 0
  v_exp_f32 v84, v84
  v_exp_f32 v85, v85
  v_exp_f32 v86, v86
  v_exp_f32 v87, v87
  v_cvt_pk_bf16_f32 v80, v80, v81
  v_cvt_pk_bf16_f32 v81, v82, v83
  v_cvt_pk_bf16_f32 v82, v84, v85
  v_cvt_pk_bf16_f32 v83, v86, v87
  v_exp_f32 v88, v88
  v_exp_f32 v89, v89
  s_waitcnt lgkmcnt(1)
  v_mfma_f32_32x32x16_bf16 v[144:159], a[16:19], v[80:83], v[144:159]
  v_exp_f32 v90, v90
  v_exp_f32 v91, v91
  v_exp_f32 v92, v92
  v_exp_f32 v93, v93
  v_exp_f32 v94, v94
  v_exp_f32 v95, v95
  v_cvt_pk_bf16_f32 v84, v88, v89
  v_cvt_pk_bf16_f32 v85, v90, v91
  v_cvt_pk_bf16_f32 v86, v92, v93
  v_cvt_pk_bf16_f32 v87, v94, v95
  ds_read_b128 a[4:7], v202 offset:24576
  ds_read_b128 a[8:11], v213 offset:8320
  ds_read_b128 a[12:15], v213 offset:9360
  s_waitcnt lgkmcnt(3)
  v_mfma_f32_32x32x16_bf16 v[144:159], a[20:23], v[84:87], v[144:159]
  v_exp_f32 v64, v64
  v_exp_f32 v65, v65
  v_exp_f32 v66, v66
  v_exp_f32 v67, v67
  s_waitcnt lgkmcnt(2)
  v_mfma_f32_32x32x16_bf16 v[80:95], a[4:7], v[36:39], v[224:239]
  v_exp_f32 v68, v68
  v_exp_f32 v69, v69
  v_exp_f32 v70, v70
  v_exp_f32 v71, v71
  v_cvt_pk_bf16_f32 v64, v64, v65
  v_cvt_pk_bf16_f32 v65, v66, v67
  v_cvt_pk_bf16_f32 v66, v68, v69
  v_cvt_pk_bf16_f32 v67, v70, v71
  v_exp_f32 v72, v72
  v_exp_f32 v73, v73
  s_waitcnt lgkmcnt(1)
  v_mfma_f32_32x32x16_bf16 v[144:159], a[8:11], v[64:67], v[144:159]
  v_exp_f32 v74, v74
  v_exp_f32 v75, v75
  v_exp_f32 v76, v76
  v_exp_f32 v77, v77
  v_exp_f32 v78, v78
  v_exp_f32 v79, v79
  v_cvt_pk_bf16_f32 v68, v72, v73
  v_cvt_pk_bf16_f32 v69, v74, v75
  v_cvt_pk_bf16_f32 v70, v76, v77
  v_cvt_pk_bf16_f32 v71, v78, v79
  ds_read_b128 a[16:19], v212 offset:16640
  ds_read_b128 a[20:23], v212 offset:17680
  s_waitcnt lgkmcnt(2)
  v_mfma_f32_32x32x16_bf16 v[144:159], a[12:15], v[68:71], v[144:159]
  v_exp_f32 v80, v80
  v_exp_f32 v81, v81
  v_exp_f32 v82, v82
  v_exp_f32 v83, v83
  v_exp_f32 v84, v84
  v_exp_f32 v85, v85
  v_exp_f32 v86, v86
  v_exp_f32 v87, v87
  s_waitcnt vmcnt(0)
  v_subrev_u32 v215, s56, v215
  v_cmp_lt_u32 vcc, 1, v215
  s_nop 0
  s_cbranch_vccnz L_slow14
L_back14:
  v_cvt_pk_bf16_f32 v80, v80, v81
  v_cvt_pk_bf16_f32 v81, v82, v83
  v_cvt_pk_bf16_f32 v82, v84, v85
  v_cvt_pk_bf16_f32 v83, v86, v87
  v_exp_f32 v88, v88
  v_exp_f32 v89, v89
  s_waitcnt lgkmcnt(1)
  v_mfma_f32_32x32x16_bf16 v[112:127], a[16:19], v[80:83], 0
  v_exp_f32 v90, v90
  v_exp_f32 v91, v91
  v_exp_f32 v92, v92
  v_exp_f32 v93, v93
  v_exp_f32 v94, v94
  v_exp_f32 v95, v95
  v_cvt_pk_bf16_f32 v84, v88, v89
  v_cvt_pk_bf16_f32 v85, v90, v91
  v_cvt_pk_bf16_f32 v86, v92, v93
  v_cvt_pk_bf16_f32 v87, v94, v95
  s_waitcnt lgkmcnt(0)
  s_nop 0
  v_mfma_f32_32x32x16_bf16 v[112:127], a[20:23], v[84:87], v[112:127]
  s_cmp_eq_u32 s53, 0
  s_cbranch_scc1 L_zero_halo15
  s_add_u32 m0, s99, 32768
  s_nop 0
  buffer_load_dwordx4 v216, s[36:39], 0 offen offset:0 sc1 lds
  buffer_load_dwordx4 v216, s[36:39], 0 offen offset:1024 sc1 lds
  buffer_load_dwordx4 v216, s[36:39], 0 offen offset:2048 sc1 lds
  buffer_load_dwordx4 v216, s[36:39], 0 offen offset:3072 sc1 lds
  s_add_u32 m0, s68, 65536
  s_nop 0
  buffer_load_dwordx4 v217, s[36:39], 0 offen offset:0 sc1 lds
  s_add_u32 m0, s68, 65552
  s_nop 0
  buffer_load_dwordx4 v217, s[36:39], 0 offen offset:1024 sc1 lds
  s_add_u32 m0, s68, 65568
  s_nop 0
  buffer_load_dwordx4 v217, s[36:39], 0 offen offset:2048 sc1 lds
  s_add_u32 m0, s68, 65584
  s_nop 0
  buffer_load_dwordx4 v217, s[36:39], 0 offen offset:3072 sc1 lds
L_halo_done15:
  v_readfirstlane_b32 s58, v215
  s_waitcnt vmcnt(0) lgkmcnt(0)
  s_barrier
  s_cmp_lg_u32 s58, 0
  s_cbranch_scc1 L_exactB
  ds_read_b128 a[0:3], v202 offset:7168
  ds_read_b128 a[4:7], v202 offset:6144
  ds_read_b128 a[8:11], v210 offset:14560
  ds_read_b128 a[12:15], v210 offset:15600
  s_waitcnt lgkmcnt(3)
  v_mfma_f32_32x32x16_bf16 v[64:79], a[0:3], v[32:35], 0
  s_nop 11
  v_exp_f32 v64, v64
  v_exp_f32 v65, v65
  v_exp_f32 v66, v66
  v_exp_f32 v67, v67
  s_waitcnt lgkmcnt(2)
  v_mfma_f32_32x32x16_bf16 v[80:95], a[4:7], v[32:35], 0
  v_exp_f32 v68, v68
  v_exp_f32 v69, v69
  v_exp_f32 v70, v70
  v_exp_f32 v71, v71
  v_readlane_b32 s84, v9, 0
  v_cvt_pk_bf16_f32 v64, v64, v65
  v_cvt_pk_bf16_f32 v65, v66, v67
  v_cvt_pk_bf16_f32 v66, v68, v69
  v_cvt_pk_bf16_f32 v67, v70, v71
  v_exp_f32 v72, v72
  v_exp_f32 v73, v73
  s_waitcnt lgkmcnt(1)
  v_mfma_f32_32x32x16_bf16 v[96:111], a[8:11], v[64:67], v[96:111]
  v_exp_f32 v74, v74
  v_exp_f32 v75, v75
  v_exp_f32 v76, v76
  v_exp_f32 v77, v77
  v_exp_f32 v78, v78
  v_exp_f32 v79, v79
  s_add_u32 m0, s81, 102400
  v_readlane_b32 s85, v9, 1
  v_cvt_pk_bf16_f32 v68, v72, v73
  v_cvt_pk_bf16_f32 v69, v74, v75
  v_cvt_pk_bf16_f32 v70, v76, v77
  v_cvt_pk_bf16_f32 v71, v78, v79
  ds_read_b128 a[0:3], v202 offset:5120
  ds_read_b128 a[16:19], v210 offset:12480
  ds_read_b128 a[20:23], v210 offset:13520
  s_waitcnt lgkmcnt(3)
  v_mfma_f32_32x32x16_bf16 v[96:111], a[12:15], v[68:71], v[96:111]
  buffer_load_dwordx4 v10, s[40:43], s84 offen lds
  v_exp_f32 v80, v80
  v_exp_f32 v81, v81
  v_exp_f32 v82, v82
  v_exp_f32 v83, v83
  s_waitcnt lgkmcnt(2)
  v_mfma_f32_32x32x16_bf16 v[64:79], a[0:3], v[32:35], 0
  v_exp_f32 v84, v84
  v_exp_f32 v85, v85
  v_exp_f32 v86, v86
  v_exp_f32 v87, v87
  buffer_load_dwordx4 v11, s[40:43], s84 offen offset:1024 lds
  v_cvt_pk_bf16_f32 v80, v80, v81
  v_cvt_pk_bf16_f32 v81, v82, v83
  v_cvt_pk_bf16_f32 v82, v84, v85
  v_cvt_pk_bf16_f32 v83, v86, v87
  v_exp_f32 v88, v88
  v_exp_f32 v89, v89
  s_waitcnt lgkmcnt(1)
  v_mfma_f32_32x32x16_bf16 v[96:111], a[16:19], v[80:83], v[96:111]
  v_exp_f32 v90, v90
  v_exp_f32 v91, v91
  v_exp_f32 v92, v92
  v_exp_f32 v93, v93
  v_exp_f32 v94, v94
  v_exp_f32 v95, v95
  v_cvt_pk_bf16_f32 v84, v88, v89
  v_cvt_pk_bf16_f32 v85, v90, v91
  v_cvt_pk_bf16_f32 v86, v92, v93
  v_cvt_pk_bf16_f32 v87, v94, v95
  ds_read_b128 a[4:7], v202 offset:4096
  ds_read_b128 a[8:11], v210 offset:10400
  ds_read_b128 a[12:15], v210 offset:11440
  s_waitcnt lgkmcnt(3)
  v_mfma_f32_32x32x16_bf16 v[96:111], a[20:23], v[84:87], v[96:111]
  v_exp_f32 v64, v64
  v_exp_f32 v65, v65
  v_exp_f32 v66, v66
  v_exp_f32 v67, v67
  s_waitcnt lgkmcnt(2)
  v_mfma_f32_32x32x16_bf16 v[80:95], a[4:7], v[32:35], 0
  v_exp_f32 v68, v68
  v_exp_f32 v69, v69
  v_exp_f32 v70, v70
  v_exp_f32 v71, v71
  s_add_u32 m0, s81, 110592
  v_readlane_b32 s86, v9, 2
  v_cvt_pk_bf16_f32 v64, v64, v65
  v_cvt_pk_bf16_f32 v65, v66, v67
  v_cvt_pk_bf16_f32 v66, v68, v69
  v_cvt_pk_bf16_f32 v67, v70, v71
  v_exp_f32 v72, v72
  v_exp_f32 v73, v73
  s_waitcnt lgkmcnt(1)
  v_mfma_f32_32x32x16_bf16 v[96:111], a[8:11], v[64:67], v[96:111]
  v_exp_f32 v74, v74
  v_exp_f32 v75, v75
  v_exp_f32 v76, v76
  v_exp_f32 v77, v77
  v_exp_f32 v78, v78
  v_exp_f32 v79, v79
  buffer_load_dwordx4 v10, s[40:43], s85 offen lds
  v_cvt_pk_bf16_f32 v68, v72, v73
  v_cvt_pk_bf16_f32 v69, v74, v75
  v_cvt_pk_bf16_f32 v70, v76, v77
  v_cvt_pk_bf16_f32 v71, v78, v79
  ds_read_b128 a[0:3], v202 offset:3072
  ds_read_b128 a[16:19], v210 offset:8320
  ds_read_b128 a[20:23], v210 offset:9360
  s_waitcnt lgkmcnt(3)
  v_mfma_f32_32x32x16_bf16 v[96:111], a[12:15], v[68:71], v[96:111]
  v_exp_f32 v80, v80
  v_exp_f32 v81, v81
  v_exp_f32 v82, v82
  v_exp_f32 v83, v83
  s_waitcnt lgkmcnt(2)
  v_mfma_f32_32x32x16_bf16 v[64:79], a[0:3], v[32:35], 0
  v_exp_f32 v84, v84
  v_exp_f32 v85, v85
  v_exp_f32 v86, v86
  v_exp_f32 v87, v87
  buffer_load_dwordx4 v11, s[40:43], s85 offen offset:1024 lds
  v_cvt_pk_bf16_f32 v80, v80, v81
  v_cvt_pk_bf16_f32 v81, v82, v83
  v_cvt_pk_bf16_f32 v82, v84, v85
  v_cvt_pk_bf16_f32 v83, v86, v87
  v_exp_f32 v88, v88
  v_exp_f32 v89, v89
  s_waitcnt lgkmcnt(1)
  v_mfma_f32_32x32x16_bf16 v[96:111], a[16:19], v[80:83], v[96:111]
  v_exp_f32 v90, v90
  v_exp_f32 v91, v91
  v_exp_f32 v92, v92
  v_exp_f32 v93, v93
  v_exp_f32 v94, v94
  v_exp_f32 v95, v95
  v_cvt_pk_bf16_f32 v84, v88, v89
  v_cvt_pk_bf16_f32 v85, v90, v91
  v_cvt_pk_bf16_f32 v86, v92, v93
  v_cvt_pk_bf16_f32 v87, v94, v95
  ds_read_b128 a[4:7], v202 offset:2048
  ds_read_b128 a[8:11], v210 offset:6240
  ds_read_b128 a[12:15], v210 offset:7280
  s_waitcnt lgkmcnt(3)
  v_mfma_f32_32x32x16_bf16 v[96:111], a[20:23], v[84:87], v[96:111]
  v_exp_f32 v64, v64
  v_exp_f32 v65, v65
  v_exp_f32 v66, v66
  v_exp_f32 v67, v67
  s_waitcnt lgkmcnt(2)
  v_mfma_f32_32x32x16_bf16 v[80:95], a[4:7], v[32:35], 0
  v_exp_f32 v68, v68
  v_exp_f32 v69, v69
  v_exp_f32 v70, v70
  v_exp_f32 v71, v71
  s_add_u32 m0, s81, 118784
  v_readlane_b32 s87, v9, 3
  v_cvt_pk_bf16_f32 v64, v64, v65
  v_cvt_pk_bf16_f32 v65, v66, v67
  v_cvt_pk_bf16_f32 v66, v68, v69
  v_cvt_pk_bf16_f32 v67, v70, v71
  v_exp_f32 v72, v72
  v_exp_f32 v73, v73
  s_waitcnt lgkmcnt(1)
  v_mfma_f32_32x32x16_bf16 v[96:111], a[8:11], v[64:67], v[96:111]
  v_exp_f32 v74, v74
  v_exp_f32 v75, v75
  v_exp_f32 v76, v76
  v_exp_f32 v77, v77
  v_exp_f32 v78, v78
  v_exp_f32 v79, v79
  buffer_load_dwordx4 v10, s[40:43], s86 offen lds
  v_cvt_pk_bf16_f32 v68, v72, v73
  v_cvt_pk_bf16_f32 v69, v74, v75
  v_cvt_pk_bf16_f32 v70, v76, v77
  v_cvt_pk_bf16_f32 v71, v78, v79
  ds_read_b128 a[0:3], v202 offset:1024
  ds_read_b128 a[16:19], v210 offset:4160
  ds_read_b128 a[20:23], v210 offset:5200
  s_waitcnt lgkmcnt(3)
  v_mfma_f32_32x32x16_bf16 v[96:111], a[12:15], v[68:71], v[96:111]
  v_exp_f32 v80, v80
  v_exp_f32 v81, v81
  v_exp_f32 v82, v82
  v_exp_f32 v83, v83
  s_waitcnt lgkmcnt(2)
  v_mfma_f32_32x32x16_bf16 v[64:79], a[0:3], v[32:35], 0
  v_exp_f32 v84, v84
  v_exp_f32 v85, v85
  v_exp_f32 v86, v86
  v_exp_f32 v87, v87
  buffer_load_dwordx4 v11, s[40:43], s86 offen offset:1024 lds
  v_cvt_pk_bf16_f32 v80, v80, v81
  v_cvt_pk_bf16_f32 v81, v82, v83
  v_cvt_pk_bf16_f32 v82, v84, v85
  v_cvt_pk_bf16_f32 v83, v86, v87
  v_exp_f32 v88, v88
  v_exp_f32 v89, v89
  s_waitcnt lgkmcnt(1)
  v_mfma_f32_32x32x16_bf16 v[96:111], a[16:19], v[80:83], v[96:111]
  v_exp_f32 v90, v90
  v_exp_f32 v91, v91
  v_exp_f32 v92, v92
  v_exp_f32 v93, v93
  v_exp_f32 v94, v94
  v_exp_f32 v95, v95
  v_cvt_pk_bf16_f32 v84, v88, v89
  v_cvt_pk_bf16_f32 v85, v90, v91
  v_cvt_pk_bf16_f32 v86, v92, v93
  v_cvt_pk_bf16_f32 v87, v94, v95
  ds_read_b128 a[4:7], v202 offset:0
  ds_read_b128 a[8:11], v210 offset:2080
  ds_read_b128 a[12:15], v210 offset:3120
  s_waitcnt lgkmcnt(3)
  v_mfma_f32_32x32x16_bf16 v[96:111], a[20:23], v[84:87], v[96:111]
  v_exp_f32 v64, v64
  v_exp_f32 v65, v65
  v_exp_f32 v66, v66
  v_exp_f32 v67, v67
  s_waitcnt lgkmcnt(2)
  v_mfma_f32_32x32x16_bf16 v[80:95], a[4:7], v[32:35], v[240:255]
  v_exp_f32 v68, v68
  v_exp_f32 v69, v69
  v_exp_f32 v70, v70
  v_exp_f32 v71, v71
  s_add_u32 m0, s81, 126976
  v_readlane_b32 s84, v9, 4
  v_cvt_pk_bf16_f32 v64, v64, v65
  v_cvt_pk_bf16_f32 v65, v66, v67
  v_cvt_pk_bf16_f32 v66, v68, v69
  v_cvt_pk_bf16_f32 v67, v70, v71
  v_exp_f32 v72, v72
  v_exp_f32 v73, v73
  s_waitcnt lgkmcnt(1)
  v_mfma_f32_32x32x16_bf16 v[96:111], a[8:11], v[64:67], v[96:111]
  v_exp_f32 v74, v74
  v_exp_f32 v75, v75
  v_exp_f32 v76, v76
  v_exp_f32 v77, v77
  v_exp_f32 v78, v78
  v_exp_f32 v79, v79
  buffer_load_dwordx4 v10, s[40:43], s87 offen lds
  v_cvt_pk_bf16_f32 v68, v72, v73
  v_cvt_pk_bf16_f32 v69, v74, v75
  v_cvt_pk_bf16_f32 v70, v76, v77
  v_cvt_pk_bf16_f32 v71, v78, v79
  ds_read_b128 a[0:3], v203 offset:3072
  ds_read_b128 a[16:19], v210 offset:0
  ds_read_b128 a[20:23], v210 offset:1040
  s_waitcnt lgkmcnt(3)
  v_mfma_f32_32x32x16_bf16 v[96:111], a[12:15], v[68:71], v[96:111]
  v_exp_f32 v80, v80
  v_exp_f32 v81, v81
  v_exp_f32 v82, v82
  v_exp_f32 v83, v83
  s_waitcnt lgkmcnt(2)
  v_mfma_f32_32x32x16_bf16 v[64:79], a[0:3], v[40:43], 0
  v_exp_f32 v84, v84
  v_exp_f32 v85, v85
  v_exp_f32 v86, v86
  v_exp_f32 v87, v87
  buffer_load_dwordx4 v11, s[40:43], s87 offen offset:1024 lds
  v_cvt_pk_bf16_f32 v80, v80, v81
  v_cvt_pk_bf16_f32 v81, v82, v83
  v_cvt_pk_bf16_f32 v82, v84, v85
  v_cvt_pk_bf16_f32 v83, v86, v87
  v_exp_f32 v88, v88
  v_exp_f32 v89, v89
  s_waitcnt lgkmcnt(1)
  v_mfma_f32_32x32x16_bf16 v[96:111], a[16:19], v[80:83], v[96:111]
  v_exp_f32 v90, v90
  v_exp_f32 v91, v91
  v_exp_f32 v92, v92
  v_exp_f32 v93, v93
  v_exp_f32 v94, v94
  v_exp_f32 v95, v95
  v_cvt_pk_bf16_f32 v84, v88, v89
  v_cvt_pk_bf16_f32 v85, v90, v91
  v_cvt_pk_bf16_f32 v86, v92, v93
  v_cvt_pk_bf16_f32 v87, v94, v95
  ds_read_b128 a[4:7], v203 offset:2048
  ds_read_b128 a[8:11], v211 offset:6240
  ds_read_b128 a[12:15], v211 offset:7280
  s_waitcnt lgkmcnt(3)
  v_mfma_f32_32x32x16_bf16 v[96:111], a[20:23], v[84:87], v[96:111]
  v_exp_f32 v64, v64
  v_exp_f32 v65, v65
  v_exp_f32 v66, v66
  v_exp_f32 v67, v67
  s_waitcnt lgkmcnt(2)
  v_mfma_f32_32x32x16_bf16 v[80:95], a[4:7], v[40:43], 0
  v_exp_f32 v68, v68
  v_exp_f32 v69, v69
  v_exp_f32 v70, v70
  v_exp_f32 v71, v71
  s_nop 1
  v_rcp_f32 v104, v104
  s_nop 0
  v_mul_f32 v96, v96, v104
  v_mul_f32 v97, v97, v104
  v_mul_f32 v98, v98, v104
  v_mul_f32 v99, v99, v104
  v_mul_f32 v100, v100, v104
  v_cvt_pk_bf16_f32 v64, v64, v65
  v_cvt_pk_bf16_f32 v65, v66, v67
  v_cvt_pk_bf16_f32 v66, v68, v69
  v_cvt_pk_bf16_f32 v67, v70, v71
  v_exp_f32 v72, v72
  v_exp_f32 v73, v73
  s_waitcnt lgkmcnt(1)
  v_mfma_f32_32x32x16_bf16 v[128:143], a[8:11], v[64:67], v[128:143]
  v_exp_f32 v74, v74
  v_exp_f32 v75, v75
  v_exp_f32 v76, v76
  v_exp_f32 v77, v77
  v_exp_f32 v78, v78
  v_exp_f32 v79, v79
  v_mul_f32 v101, v101, v104
  v_mul_f32 v102, v102, v104
  v_mul_f32 v103, v103, v104
  v_cvt_pk_bf16_f32 v96, v96, v97
  v_cvt_pk_bf16_f32 v97, v98, v99
  v_cvt_pk_bf16_f32 v98, v100, v101
  v_cvt_pk_bf16_f32 v68, v72, v73
  v_cvt_pk_bf16_f32 v69, v74, v75
  v_cvt_pk_bf16_f32 v70, v76, v77
  v_cvt_pk_bf16_f32 v71, v78, v79
  ds_read_b128 a[0:3], v203 offset:1024
  ds_read_b128 a[16:19], v211 offset:4160
  ds_read_b128 a[20:23], v211 offset:5200
  s_waitcnt lgkmcnt(3)
  v_mfma_f32_32x32x16_bf16 v[128:143], a[12:15], v[68:71], v[128:143]
  v_cvt_pk_bf16_f32 v99, v102, v103
  buffer_store_dwordx4 v[96:99], v218, s[36:39], 0 offen offset:0 sc1
  s_add_u32 m0, s81, 135168
  v_readlane_b32 s85, v9, 5
  buffer_load_dwordx4 v10, s[40:43], s84 offen lds
  v_exp_f32 v80, v80
  v_exp_f32 v81, v81
  v_exp_f32 v82, v82
  v_exp_f32 v83, v83
  s_waitcnt lgkmcnt(2)
  v_mfma_f32_32x32x16_bf16 v[64:79], a[0:3], v[40:43], 0
  v_exp_f32 v84, v84
  v_exp_f32 v85, v85
  v_exp_f32 v86, v86
  v_exp_f32 v87, v87
  buffer_load_dwordx4 v11, s[40:43], s84 offen offset:1024 lds
  v_cvt_pk_bf16_f32 v80, v80, v81
  v_cvt_pk_bf16_f32 v81, v82, v83
  v_cvt_pk_bf16_f32 v82, v84, v85
  v_cvt_pk_bf16_f32 v83, v86, v87
  v_exp_f32 v88, v88
  v_exp_f32 v89, v89
  s_waitcnt lgkmcnt(1)
  v_mfma_f32_32x32x16_bf16 v[128:143], a[16:19], v[80:83], v[128:143]
  v_exp_f32 v90, v90
  v_exp_f32 v91, v91
  v_exp_f32 v92, v92
  v_exp_f32 v93, v93
  v_exp_f32 v94, v94
  v_exp_f32 v95, v95
  v_cvt_pk_bf16_f32 v84, v88, v89
  v_cvt_pk_bf16_f32 v85, v90, v91
  v_cvt_pk_bf16_f32 v86, v92, v93
  v_cvt_pk_bf16_f32 v87, v94, v95
  ds_read_b128 a[4:7], v203 offset:0
  ds_read_b128 a[8:11], v211 offset:2080
  ds_read_b128 a[12:15], v211 offset:3120
  s_waitcnt lgkmcnt(3)
  v_mfma_f32_32x32x16_bf16 v[128:143], a[20:23], v[84:87], v[128:143]
  v_exp_f32 v64, v64
  v_exp_f32 v65, v65
  v_exp_f32 v66, v66
  v_exp_f32 v67, v67
  s_waitcnt lgkmcnt(2)
  v_mfma_f32_32x32x16_bf16 v[80:95], a[4:7], v[40:43], v[240:255]
  v_exp_f32 v68, v68
  v_exp_f32 v69, v69
  v_exp_f32 v70, v70
  v_exp_f32 v71, v71
  s_add_u32 m0, s81, 143360
  v_readlane_b32 s86, v9, 6
  v_cvt_pk_bf16_f32 v64, v64, v65
  v_cvt_pk_bf16_f32 v65, v66, v67
  v_cvt_pk_bf16_f32 v66, v68, v69
  v_cvt_pk_bf16_f32 v67, v70, v71
  v_exp_f32 v72, v72
  v_exp_f32 v73, v73
  s_waitcnt lgkmcnt(1)
  v_mfma_f32_32x32x16_bf16 v[128:143], a[8:11], v[64:67], v[128:143]
  v_exp_f32 v74, v74
  v_exp_f32 v75, v75
  v_exp_f32 v76, v76
  v_exp_f32 v77, v77
  v_exp_f32 v78, v78
  v_exp_f32 v79, v79
  buffer_load_dwordx4 v10, s[40:43], s85 offen lds
  v_cvt_pk_bf16_f32 v68, v72, v73
  v_cvt_pk_bf16_f32 v69, v74, v75
  v_cvt_pk_bf16_f32 v70, v76, v77
  v_cvt_pk_bf16_f32 v71, v78, v79
  ds_read_b128 a[0:3], v202 offset:23552
  ds_read_b128 a[16:19], v211 offset:0
  ds_read_b128 a[20:23], v211 offset:1040
  s_waitcnt lgkmcnt(3)
  v_mfma_f32_32x32x16_bf16 v[128:143], a[12:15], v[68:71], v[128:143]
  buffer_load_dwordx4 v11, s[40:43], s85 offen offset:1024 lds
  v_exp_f32 v80, v80
  v_exp_f32 v81, v81
  v_exp_f32 v82, v82
  v_exp_f32 v83, v83
  s_waitcnt lgkmcnt(2)
  v_mfma_f32_32x32x16_bf16 v[64:79], a[0:3], v[36:39], 0
  v_exp_f32 v84, v84
  v_exp_f32 v85, v85
  v_exp_f32 v86, v86
  v_exp_f32 v87, v87
  s_add_u32 m0, s81, 151552
  v_readlane_b32 s87, v9, 7
  buffer_load_dwordx4 v10, s[40:43], s86 offen lds
  v_cvt_pk_bf16_f32 v80, v80, v81
  v_cvt_pk_bf16_f32 v81, v82, v83
  v_cvt_pk_bf16_f32 v82, v84, v85
  v_cvt_pk_bf16_f32 v83, v86, v87
  v_exp_f32 v88, v88
  v_exp_f32 v89, v89
  s_waitcnt lgkmcnt(1)
  v_mfma_f32_32x32x16_bf16 v[128:143], a[16:19], v[80:83], v[128:143]
  v_exp_f32 v90, v90
  v_exp_f32 v91, v91
  v_exp_f32 v92, v92
  v_exp_f32 v93, v93
  v_exp_f32 v94, v94
  v_exp_f32 v95, v95
  buffer_load_dwordx4 v11, s[40:43], s86 offen offset:1024 lds
  s_cmp_lt_u32 s52, 2
  s_mov_b32 s82, 8192
  s_cselect_b32 s82, 8192, s82
  v_cvt_pk_bf16_f32 v84, v88, v89
  v_cvt_pk_bf16_f32 v85, v90, v91
  v_cvt_pk_bf16_f32 v86, v92, v93
  v_cvt_pk_bf16_f32 v87, v94, v95
  ds_read_b128 a[4:7], v202 offset:22528
  ds_read_b128 a[8:11], v212 offset:14560
  ds_read_b128 a[12:15], v212 offset:15600
  s_waitcnt lgkmcnt(3)
  v_mfma_f32_32x32x16_bf16 v[128:143], a[20:23], v[84:87], v[128:143]
  buffer_load_dword v25, v23, s[36:39], s82 offen sc1
  v_exp_f32 v64, v64
  v_exp_f32 v65, v65
  v_exp_f32 v66, v66
  v_exp_f32 v67, v67
  s_waitcnt lgkmcnt(2)
  v_mfma_f32_32x32x16_bf16 v[80:95], a[4:7], v[36:39], 0
  v_exp_f32 v68, v68
  v_exp_f32 v69, v69
  v_exp_f32 v70, v70
  v_exp_f32 v71, v71
  s_nop 0
  v_rcp_f32 v136, v136
  s_nop 0
  v_mul_f32 v128, v128, v136
  v_mul_f32 v129, v129, v136
  v_mul_f32 v130, v130, v136
  v_mul_f32 v131, v131, v136
  v_mul_f32 v132, v132, v136
  v_cvt_pk_bf16_f32 v64, v64, v65
  v_cvt_pk_bf16_f32 v65, v66, v67
  v_cvt_pk_bf16_f32 v66, v68, v69
  v_cvt_pk_bf16_f32 v67, v70, v71
  v_exp_f32 v72, v72
  v_exp_f32 v73, v73
  s_waitcnt lgkmcnt(1)
  v_mfma_f32_32x32x16_bf16 v[112:127], a[8:11], v[64:67], v[112:127]
  v_exp_f32 v74, v74
  v_exp_f32 v75, v75
  v_exp_f32 v76, v76
  v_exp_f32 v77, v77
  v_exp_f32 v78, v78
  v_exp_f32 v79, v79
  v_mul_f32 v133, v133, v136
  v_mul_f32 v134, v134, v136
  v_mul_f32 v135, v135, v136
  v_cvt_pk_bf16_f32 v128, v128, v129
  v_cvt_pk_bf16_f32 v129, v130, v131
  v_cvt_pk_bf16_f32 v130, v132, v133
  v_cvt_pk_bf16_f32 v68, v72, v73
  v_cvt_pk_bf16_f32 v69, v74, v75
  v_cvt_pk_bf16_f32 v70, v76, v77
  v_cvt_pk_bf16_f32 v71, v78, v79
  ds_read_b128 a[0:3], v202 offset:21504
  ds_read_b128 a[16:19], v212 offset:12480
  ds_read_b128 a[20:23], v212 offset:13520
  s_waitcnt lgkmcnt(3)
  v_mfma_f32_32x32x16_bf16 v[112:127], a[12:15], v[68:71], v[112:127]
  v_cvt_pk_bf16_f32 v131, v134, v135
  buffer_store_dwordx4 v[128:131], v219, s[36:39], 0 offen offset:0 sc1
  s_add_u32 m0, s81, 0
  v_readlane_b32 s84, v9, 8
  buffer_load_dwordx4 v10, s[40:43], s87 offen lds
  buffer_load_dwordx4 v11, s[40:43], s87 offen offset:1024 lds
  v_exp_f32 v80, v80
  v_exp_f32 v81, v81
  v_exp_f32 v82, v82
  v_exp_f32 v83, v83
  s_waitcnt lgkmcnt(2)
  v_mfma_f32_32x32x16_bf16 v[64:79], a[0:3], v[36:39], 0
  v_exp_f32 v84, v84
  v_exp_f32 v85, v85
  v_exp_f32 v86, v86
  v_exp_f32 v87, v87
  s_add_u32 m0, s81, 8192
  v_readlane_b32 s85, v9, 9
  v_cvt_pk_bf16_f32 v80, v80, v81
  v_cvt_pk_bf16_f32 v81, v82, v83
  v_cvt_pk_bf16_f32 v82, v84, v85
  v_cvt_pk_bf16_f32 v83, v86, v87
  v_exp_f32 v88, v88
  v_exp_f32 v89, v89
  s_waitcnt lgkmcnt(1)
  v_mfma_f32_32x32x16_bf16 v[112:127], a[16:19], v[80:83], v[112:127]
  v_exp_f32 v90, v90
  v_exp_f32 v91, v91
  v_exp_f32 v92, v92
  v_exp_f32 v93, v93
  v_exp_f32 v94, v94
  v_exp_f32 v95, v95
  buffer_load_dwordx4 v10, s[40:43], s84 offen lds
  v_cvt_pk_bf16_f32 v84, v88, v89
  v_cvt_pk_bf16_f32 v85, v90, v91
  v_cvt_pk_bf16_f32 v86, v92, v93
  v_cvt_pk_bf16_f32 v87, v94, v95
  ds_read_b128 a[4:7], v202 offset:20480
  ds_read_b128 a[8:11], v212 offset:10400
  ds_read_b128 a[12:15], v212 offset:11440
  s_waitcnt lgkmcnt(3)
  v_mfma_f32_32x32x16_bf16 v[112:127], a[20:23], v[84:87], v[112:127]
  buffer_load_dwordx4 v11, s[40:43], s84 offen offset:1024 lds
  v_exp_f32 v64, v64
  v_exp_f32 v65, v65
  v_exp_f32 v66, v66
  v_exp_f32 v67, v67
  s_waitcnt lgkmcnt(2)
  v_mfma_f32_32x32x16_bf16 v[80:95], a[4:7], v[36:39], 0
  v_exp_f32 v68, v68
  v_exp_f32 v69, v69
  v_exp_f32 v70, v70
  v_exp_f32 v71, v71
  s_add_u32 m0, s81, 16384
  v_readlane_b32 s86, v9, 10
  v_cvt_pk_bf16_f32 v64, v64, v65
  v_cvt_pk_bf16_f32 v65, v66, v67
  v_cvt_pk_bf16_f32 v66, v68, v69
  v_cvt_pk_bf16_f32 v67, v70, v71
  v_exp_f32 v72, v72
  v_exp_f32 v73, v73
  s_waitcnt lgkmcnt(1)
  v_mfma_f32_32x32x16_bf16 v[112:127], a[8:11], v[64:67], v[112:127]
  v_exp_f32 v74, v74
  v_exp_f32 v75, v75
  v_exp_f32 v76, v76
  v_exp_f32 v77, v77
  v_exp_f32 v78, v78
  v_exp_f32 v79, v79
  buffer_load_dwordx4 v10, s[40:43], s85 offen lds
  v_cvt_pk_bf16_f32 v68, v72, v73
  v_cvt_pk_bf16_f32 v69, v74, v75
  v_cvt_pk_bf16_f32 v70, v76, v77
  v_cvt_pk_bf16_f32 v71, v78, v79
  ds_read_b128 a[0:3], v202 offset:19456
  ds_read_b128 a[16:19], v212 offset:8320
  ds_read_b128 a[20:23], v212 offset:9360
  s_waitcnt lgkmcnt(3)
  v_mfma_f32_32x32x16_bf16 v[112:127], a[12:15], v[68:71], v[112:127]
  buffer_load_dwordx4 v11, s[40:43], s85 offen offset:1024 lds
  v_exp_f32 v80, v80
  v_exp_f32 v81, v81
  v_exp_f32 v82, v82
  v_exp_f32 v83, v83
  s_waitcnt lgkmcnt(2)
  v_mfma_f32_32x32x16_bf16 v[64:79], a[0:3], v[36:39], 0
  v_exp_f32 v84, v84
  v_exp_f32 v85, v85
  v_exp_f32 v86, v86
  v_exp_f32 v87, v87
  s_add_u32 m0, s81, 24576
  v_readlane_b32 s87, v9, 11
  buffer_load_dwordx4 v10, s[40:43], s86 offen lds
  v_cvt_pk_bf16_f32 v80, v80, v81
  v_cvt_pk_bf16_f32 v81, v82, v83
  v_cvt_pk_bf16_f32 v82, v84, v85
  v_cvt_pk_bf16_f32 v83, v86, v87
  v_exp_f32 v88, v88
  v_exp_f32 v89, v89
  s_waitcnt lgkmcnt(1)
  v_mfma_f32_32x32x16_bf16 v[112:127], a[16:19], v[80:83], v[112:127]
  v_exp_f32 v90, v90
  v_exp_f32 v91, v91
  v_exp_f32 v92, v92
  v_exp_f32 v93, v93
  v_exp_f32 v94, v94
  v_exp_f32 v95, v95
  buffer_load_dwordx4 v11, s[40:43], s86 offen offset:1024 lds
  s_waitcnt vmcnt(9)
  v_cmp_ne_u32 vcc, s56, v25
  s_nop 0
  s_cbranch_vccnz L_slow16
L_back16:
  v_cvt_pk_bf16_f32 v84, v88, v89
  v_cvt_pk_bf16_f32 v85, v90, v91
  v_cvt_pk_bf16_f32 v86, v92, v93
  v_cvt_pk_bf16_f32 v87, v94, v95
  ds_read_b128 a[4:7], v202 offset:18432
  ds_read_b128 a[8:11], v212 offset:6240
  ds_read_b128 a[12:15], v212 offset:7280
  s_waitcnt lgkmcnt(3)
  v_mfma_f32_32x32x16_bf16 v[112:127], a[20:23], v[84:87], v[112:127]
  v_exp_f32 v64, v64
  v_exp_f32 v65, v65
  v_exp_f32 v66, v66
  v_exp_f32 v67, v67
  s_waitcnt lgkmcnt(2)
  v_mfma_f32_32x32x16_bf16 v[80:95], a[4:7], v[36:39], 0
  v_exp_f32 v68, v68
  v_exp_f32 v69, v69
  v_exp_f32 v70, v70
  v_exp_f32 v71, v71
  v_readlane_b32 s88, v3, 0
  v_readlane_b32 s89, v3, 1
  v_cvt_pk_bf16_f32 v64, v64, v65
  v_cvt_pk_bf16_f32 v65, v66, v67
  v_cvt_pk_bf16_f32 v66, v68, v69
  v_cvt_pk_bf16_f32 v67, v70, v71
  v_exp_f32 v72, v72
  v_exp_f32 v73, v73
  s_waitcnt lgkmcnt(1)
  v_mfma_f32_32x32x16_bf16 v[112:127], a[8:11], v[64:67], v[112:127]
  v_exp_f32 v74, v74
  v_exp_f32 v75, v75
  v_exp_f32 v76, v76
  v_exp_f32 v77, v77
  v_exp_f32 v78, v78
  v_exp_f32 v79, v79
  v_readlane_b32 s90, v3, 2
  buffer_load_dwordx4 a[64:67], v15, s[36:39], s88 offen sc1
  v_cvt_pk_bf16_f32 v68, v72, v73
  v_cvt_pk_bf16_f32 v69, v74, v75
  v_cvt_pk_bf16_f32 v70, v76, v77
  v_cvt_pk_bf16_f32 v71, v78, v79
  ds_read_b128 a[0:3], v202 offset:17408
  ds_read_b128 a[16:19], v212 offset:4160
  ds_read_b128 a[20:23], v212 offset:5200
  s_waitcnt lgkmcnt(3)
  v_mfma_f32_32x32x16_bf16 v[112:127], a[12:15], v[68:71], v[112:127]
  v_readlane_b32 s91, v3, 3
  buffer_load_dwordx4 a[68:71], v15, s[36:39], s89 offen sc1
  v_exp_f32 v80, v80
  v_exp_f32 v81, v81
  v_exp_f32 v82, v82
  v_exp_f32 v83, v83
  s_waitcnt lgkmcnt(2)
  v_mfma_f32_32x32x16_bf16 v[64:79], a[0:3], v[36:39], 0
  v_exp_f32 v84, v84
  v_exp_f32 v85, v85
  v_exp_f32 v86, v86
  v_exp_f32 v87, v87
  s_waitcnt vmcnt(10)
  s_barrier
  s_mov_b32 s71, 12288
  buffer_store_dword v13, v14, s[36:39], s71 offen sc1
  v_readlane_b32 s88, v3, 4
  v_cvt_pk_bf16_f32 v80, v80, v81
  v_cvt_pk_bf16_f32 v81, v82, v83
  v_cvt_pk_bf16_f32 v82, v84, v85
  v_cvt_pk_bf16_f32 v83, v86, v87
  v_exp_f32 v88, v88
  v_exp_f32 v89, v89
  s_waitcnt lgkmcnt(1)
  v_mfma_f32_32x32x16_bf16 v[112:127], a[16:19], v[80:83], v[112:127]
  v_exp_f32 v90, v90
  v_exp_f32 v91, v91
  v_exp_f32 v92, v92
  v_exp_f32 v93, v93
  v_exp_f32 v94, v94
  v_exp_f32 v95, v95
  buffer_load_dwordx4 a[72:75], v15, s[36:39], s90 offen sc1
  v_readlane_b32 s89, v3, 5
  v_cvt_pk_bf16_f32 v84, v88, v89
  v_cvt_pk_bf16_f32 v85, v90, v91
  v_cvt_pk_bf16_f32 v86, v92, v93
  v_cvt_pk_bf16_f32 v87, v94, v95
  ds_read_b128 a[4:7], v202 offset:16384
  ds_read_b128 a[8:11], v212 offset:2080
  ds_read_b128 a[12:15], v212 offset:3120
  s_waitcnt lgkmcnt(3)
  v_mfma_f32_32x32x16_bf16 v[112:127], a[20:23], v[84:87], v[112:127]
  buffer_load_dwordx4 a[76:79], v15, s[36:39], s91 offen sc1
  v_exp_f32 v64, v64
  v_exp_f32 v65, v65
  v_exp_f32 v66, v66
  v_exp_f32 v67, v67
  s_waitcnt lgkmcnt(2)
  v_mfma_f32_32x32x16_bf16 v[80:95], a[4:7], v[36:39], v[240:255]
  v_exp_f32 v68, v68
  v_exp_f32 v69, v69
  v_exp_f32 v70, v70
  v_exp_f32 v71, v71
  v_readlane_b32 s90, v3, 6
  buffer_load_dwordx4 a[80:83], v15, s[36:39], s88 offen sc1
  v_cvt_pk_bf16_f32 v64, v64, v65
  v_cvt_pk_bf16_f32 v65, v66, v67
  v_cvt_pk_bf16_f32 v66, v68, v69
  v_cvt_pk_bf16_f32 v67, v70, v71
  v_exp_f32 v72, v72
  v_exp_f32 v73, v73
  s_waitcnt lgkmcnt(1)
  v_mfma_f32_32x32x16_bf16 v[112:127], a[8:11], v[64:67], v[112:127]
  v_exp_f32 v74, v74
  v_exp_f32 v75, v75
  v_exp_f32 v76, v76
  v_exp_f32 v77, v77
  v_exp_f32 v78, v78
  v_exp_f32 v79, v79
  v_readlane_b32 s91, v3, 7
  buffer_load_dwordx4 a[84:87], v15, s[36:39], s89 offen sc1
  v_cvt_pk_bf16_f32 v68, v72, v73
  v_cvt_pk_bf16_f32 v69, v74, v75
  v_cvt_pk_bf16_f32 v70, v76, v77
  v_cvt_pk_bf16_f32 v71, v78, v79
  ds_read_b128 a[0:3], v203 offset:19456
  ds_read_b128 a[16:19], v212 offset:0
  ds_read_b128 a[20:23], v212 offset:1040
  s_waitcnt lgkmcnt(3)
  v_mfma_f32_32x32x16_bf16 v[112:127], a[12:15], v[68:71], v[112:127]
  v_exp_f32 v80, v80
  v_exp_f32 v81, v81
  v_exp_f32 v82, v82
  v_exp_f32 v83, v83
  s_waitcnt lgkmcnt(2)
  v_mfma_f32_32x32x16_bf16 v[64:79], a[0:3], v[44:47], 0
  v_exp_f32 v84, v84
  v_exp_f32 v85, v85
  v_exp_f32 v86, v86
  v_exp_f32 v87, v87
  v_readlane_b32 s88, v3, 8
  buffer_load_dwordx4 a[88:91], v15, s[36:39], s90 offen sc1
  v_cvt_pk_bf16_f32 v80, v80, v81
  v_cvt_pk_bf16_f32 v81, v82, v83
  v_cvt_pk_bf16_f32 v82, v84, v85
  v_cvt_pk_bf16_f32 v83, v86, v87
  v_exp_f32 v88, v88
  v_exp_f32 v89, v89
  s_waitcnt lgkmcnt(1)
  v_mfma_f32_32x32x16_bf16 v[112:127], a[16:19], v[80:83], v[112:127]
  v_exp_f32 v90, v90
  v_exp_f32 v91, v91
  v_exp_f32 v92, v92
  v_exp_f32 v93, v93
  v_exp_f32 v94, v94
  v_exp_f32 v95, v95
  v_readlane_b32 s89, v3, 9
  buffer_load_dwordx4 a[92:95], v15, s[36:39], s91 offen sc1
  v_cvt_pk_bf16_f32 v84, v88, v89
  v_cvt_pk_bf16_f32 v85, v90, v91
  v_cvt_pk_bf16_f32 v86, v92, v93
  v_cvt_pk_bf16_f32 v87, v94, v95
  ds_read_b128 a[4:7], v203 offset:18432
  ds_read_b128 a[8:11], v213 offset:6240
  ds_read_b128 a[12:15], v213 offset:7280
  s_waitcnt lgkmcnt(3)
  v_mfma_f32_32x32x16_bf16 v[112:127], a[20:23], v[84:87], v[112:127]
  v_exp_f32 v64, v64
  v_exp_f32 v65, v65
  v_exp_f32 v66, v66
  v_exp_f32 v67, v67
  s_waitcnt lgkmcnt(2)
  v_mfma_f32_32x32x16_bf16 v[80:95], a[4:7], v[44:47], 0
  v_exp_f32 v68, v68
  v_exp_f32 v69, v69
  v_exp_f32 v70, v70
  v_exp_f32 v71, v71
  s_nop 1
  v_rcp_f32 v112, v112
  s_nop 0
  v_mul_f32 v120, v120, v112
  v_mul_f32 v121, v121, v112
  v_mul_f32 v122, v122, v112
  v_mul_f32 v123, v123, v112
  v_mul_f32 v124, v124, v112
  v_cvt_pk_bf16_f32 v64, v64, v65
  v_cvt_pk_bf16_f32 v65, v66, v67
  v_cvt_pk_bf16_f32 v66, v68, v69
  v_cvt_pk_bf16_f32 v67, v70, v71
  v_exp_f32 v72, v72
  v_exp_f32 v73, v73
  s_waitcnt lgkmcnt(1)
  v_mfma_f32_32x32x16_bf16 v[144:159], a[8:11], v[64:67], v[144:159]
  v_exp_f32 v74, v74
  v_exp_f32 v75, v75
  v_exp_f32 v76, v76
  v_exp_f32 v77, v77
  v_exp_f32 v78, v78
  v_exp_f32 v79, v79
  v_mul_f32 v125, v125, v112
  v_mul_f32 v126, v126, v112
  v_mul_f32 v127, v127, v112
  v_cvt_pk_bf16_f32 v120, v120, v121
  v_cvt_pk_bf16_f32 v121, v122, v123
  v_cvt_pk_bf16_f32 v122, v124, v125
  v_cvt_pk_bf16_f32 v68, v72, v73
  v_cvt_pk_bf16_f32 v69, v74, v75
  v_cvt_pk_bf16_f32 v70, v76, v77
  v_cvt_pk_bf16_f32 v71, v78, v79
  ds_read_b128 a[0:3], v203 offset:17408
  ds_read_b128 a[16:19], v213 offset:4160
  ds_read_b128 a[20:23], v213 offset:5200
  s_waitcnt lgkmcnt(3)
  v_mfma_f32_32x32x16_bf16 v[144:159], a[12:15], v[68:71], v[144:159]
  v_cvt_pk_bf16_f32 v123, v126, v127
  buffer_store_dwordx4 v[120:123], v218, s[36:39], 0 offen offset:1024 sc1
  v_readlane_b32 s90, v3, 10
  buffer_load_dwordx4 a[96:99], v15, s[36:39], s88 offen sc1
  v_readlane_b32 s91, v3, 11
  buffer_load_dwordx4 a[100:103], v15, s[36:39], s89 offen sc1
  v_exp_f32 v80, v80
  v_exp_f32 v81, v81
  v_exp_f32 v82, v82
  v_exp_f32 v83, v83
  s_waitcnt lgkmcnt(2)
  v_mfma_f32_32x32x16_bf16 v[64:79], a[0:3], v[44:47], 0
  v_exp_f32 v84, v84
  v_exp_f32 v85, v85
  v_exp_f32 v86, v86
  v_exp_f32 v87, v87
  v_readlane_b32 s88, v3, 12
  buffer_load_dwordx4 a[104:107], v15, s[36:39], s90 offen sc1
  v_cvt_pk_bf16_f32 v80, v80, v81
  v_cvt_pk_bf16_f32 v81, v82, v83
  v_cvt_pk_bf16_f32 v82, v84, v85
  v_cvt_pk_bf16_f32 v83, v86, v87
  v_exp_f32 v88, v88
  v_exp_f32 v89, v89
  s_waitcnt lgkmcnt(1)
  v_mfma_f32_32x32x16_bf16 v[144:159], a[16:19], v[80:83], v[144:159]
  v_exp_f32 v90, v90
  v_exp_f32 v91, v91
  v_exp_f32 v92, v92
  v_exp_f32 v93, v93
  v_exp_f32 v94, v94
  v_exp_f32 v95, v95
  v_readlane_b32 s89, v3, 13
  buffer_load_dwordx4 a[108:111], v15, s[36:39], s91 offen sc1
  v_cvt_pk_bf16_f32 v84, v88, v89
  v_cvt_pk_bf16_f32 v85, v90, v91
  v_cvt_pk_bf16_f32 v86, v92, v93
  v_cvt_pk_bf16_f32 v87, v94, v95
  ds_read_b128 a[4:7], v203 offset:16384
  ds_read_b128 a[8:11], v213 offset:2080
  ds_read_b128 a[12:15], v213 offset:3120
  s_waitcnt lgkmcnt(3)
  v_mfma_f32_32x32x16_bf16 v[144:159], a[20:23], v[84:87], v[144:159]
  v_exp_f32 v64, v64
  v_exp_f32 v65, v65
  v_exp_f32 v66, v66
  v_exp_f32 v67, v67
  s_waitcnt lgkmcnt(2)
  v_mfma_f32_32x32x16_bf16 v[80:95], a[4:7], v[44:47], v[240:255]
  v_exp_f32 v68, v68
  v_exp_f32 v69, v69
  v_exp_f32 v70, v70
  v_exp_f32 v71, v71
  v_readlane_b32 s90, v3, 14
  buffer_load_dwordx4 a[112:115], v15, s[36:39], s88 offen sc1
  v_cvt_pk_bf16_f32 v64, v64, v65
  v_cvt_pk_bf16_f32 v65, v66, v67
  v_cvt_pk_bf16_f32 v66, v68, v69
  v_cvt_pk_bf16_f32 v67, v70, v71
  v_exp_f32 v72, v72
  v_exp_f32 v73, v73
  s_waitcnt lgkmcnt(1)
  v_mfma_f32_32x32x16_bf16 v[144:159], a[8:11], v[64:67], v[144:159]
  v_exp_f32 v74, v74
  v_exp_f32 v75, v75
  v_exp_f32 v76, v76
  v_exp_f32 v77, v77
  v_exp_f32 v78, v78
  v_exp_f32 v79, v79
  v_readlane_b32 s91, v3, 15
  buffer_load_dwordx4 a[116:119], v15, s[36:39], s89 offen sc1
  v_cvt_pk_bf16_f32 v68, v72, v73
  v_cvt_pk_bf16_f32 v69, v74, v75
  v_cvt_pk_bf16_f32 v70, v76, v77
  v_cvt_pk_bf16_f32 v71, v78, v79
  ds_read_b128 a[16:19], v213 offset:0
  ds_read_b128 a[20:23], v213 offset:1040
  s_waitcnt lgkmcnt(2)
  v_mfma_f32_32x32x16_bf16 v[144:159], a[12:15], v[68:71], v[144:159]
  v_exp_f32 v80, v80
  v_exp_f32 v81, v81
  v_exp_f32 v82, v82
  v_exp_f32 v83, v83
  v_exp_f32 v84, v84
  v_exp_f32 v85, v85
  v_exp_f32 v86, v86
  v_exp_f32 v87, v87
  v_readlane_b32 s88, v3, 16
  buffer_load_dwordx4 a[120:123], v15, s[36:39], s90 offen sc1
  v_cvt_pk_bf16_f32 v80, v80, v81
  v_cvt_pk_bf16_f32 v81, v82, v83
  v_cvt_pk_bf16_f32 v82, v84, v85
  v_cvt_pk_bf16_f32 v83, v86, v87
  v_exp_f32 v88, v88
  v_exp_f32 v89, v89
  s_waitcnt lgkmcnt(1)
  v_mfma_f32_32x32x16_bf16 v[144:159], a[16:19], v[80:83], v[144:159]
  v_exp_f32 v90, v90
  v_exp_f32 v91, v91
  v_exp_f32 v92, v92
  v_exp_f32 v93, v93
  v_exp_f32 v94, v94
  v_exp_f32 v95, v95
  v_readlane_b32 s89, v3, 17
  buffer_load_dwordx4 a[124:127], v15, s[36:39], s91 offen sc1
  v_cvt_pk_bf16_f32 v84, v88, v89
  v_cvt_pk_bf16_f32 v85, v90, v91
  v_cvt_pk_bf16_f32 v86, v92, v93
  v_cvt_pk_bf16_f32 v87, v94, v95
  s_waitcnt lgkmcnt(0)
  s_nop 0
  v_mfma_f32_32x32x16_bf16 v[144:159], a[20:23], v[84:87], v[144:159]
  s_cmp_lt_u32 s52, 2
  s_mov_b32 s82, 9216
  s_cselect_b32 s82, 9216, s82
  buffer_load_dword v25, v23, s[36:39], s82 offen sc1
  s_nop 7
  v_rcp_f32 v144, v144
  s_nop 0
  v_mul_f32 v152, v152, v144
  v_mul_f32 v153, v153, v144
  v_mul_f32 v154, v154, v144
  v_mul_f32 v155, v155, v144
  v_mul_f32 v156, v156, v144
  v_mul_f32 v157, v157, v144
  v_mul_f32 v158, v158, v144
  v_mul_f32 v159, v159, v144
  v_cvt_pk_bf16_f32 v152, v152, v153
  v_cvt_pk_bf16_f32 v153, v154, v155
  v_cvt_pk_bf16_f32 v154, v156, v157
  v_cvt_pk_bf16_f32 v155, v158, v159
  buffer_store_dwordx4 v[152:155], v219, s[36:39], 0 offen offset:1024 sc1
L_attn_done:
  v_add_u32 v148, 65536, v27
  v_add_u32 v149, 65536, v28
  v_add_u32 v150, 131072, v27
  v_add_u32 v151, 131072, v28
  s_lshl_b32 s58, s72, 1
  s_and_b32 s69, s52, 1
  s_add_u32 s58, s58, s69
  s_lshl_b32 s58, s58, 15
  s_lshl_b32 s69, s73, 7
  s_add_u32 s58, s58, s69
  s_lshr_b32 s69, s52, 1
  s_lshl_b32 s69, s69, 6
  s_add_u32 s58, s58, s69
  v_mov_b32 v145, s58
  v_and_b32 v144, 31, v2
  v_lshl_add_u32 v144, v144, 10, v145
  v_lshrrev_b32 v146, 5, v2
  v_lshl_add_u32 v145, v146, 3, v144
  v_lshl_add_u32 v144, v146, 4, v144
  s_lshl_b32 s58, s52, 12
  v_lshl_add_u32 v146, v2, 4, s58
  v_xor_b32 v147, 0x2000, v146
  s_waitcnt lgkmcnt(0)
  s_barrier
  ds_read_b64_tr_b16 v[32:33], v148 offset:36864
  ds_read_b64_tr_b16 v[34:35], v148 offset:37888
  ds_read_b64_tr_b16 v[36:37], v149 offset:36864
  ds_read_b64_tr_b16 v[38:39], v149 offset:37888
  s_waitcnt vmcnt(19) lgkmcnt(2)
  v_mfma_f32_32x32x16_bf16 v[64:79], v[32:35], a[64:67], 0
  ds_read_b64_tr_b16 v[40:41], v148 offset:38912
  ds_read_b64_tr_b16 v[42:43], v148 offset:39936
  buffer_load_dwordx2 v[128:129], v145, s[24:27], 0 offen offset:0
  buffer_load_dwordx2 v[130:131], v145, s[24:27], 0 offen offset:16
  s_add_u32 m0, s81, 65536
  v_readlane_b32 s84, v9, 12
  s_waitcnt lgkmcnt(2)
  v_mfma_f32_32x32x16_bf16 v[80:95], v[36:39], a[64:67], 0
  ds_read_b64_tr_b16 v[44:45], v149 offset:38912
  ds_read_b64_tr_b16 v[46:47], v149 offset:39936
  buffer_load_dwordx2 v[132:133], v145, s[24:27], 0 offen offset:32
  s_waitcnt vmcnt(21) lgkmcnt(2)
  v_mfma_f32_32x32x16_bf16 v[64:79], v[40:43], a[68:71], v[64:79]
  ds_read_b64_tr_b16 v[32:33], v148 offset:45056
  ds_read_b64_tr_b16 v[34:35], v148 offset:46080
  buffer_load_dwordx2 v[134:135], v145, s[24:27], 0 offen offset:48
  s_waitcnt vmcnt(5)
  v_cmp_ne_u32 vcc, s56, v25
  s_nop 0
  s_cbranch_vccnz L_slow84
L_back84:
  v_readlane_b32 s90, v3, 18
  s_waitcnt lgkmcnt(2)
  v_mfma_f32_32x32x16_bf16 v[80:95], v[44:47], a[68:71], v[80:95]
  ds_read_b64_tr_b16 v[36:37], v149 offset:45056
  ds_read_b64_tr_b16 v[38:39], v149 offset:46080
  buffer_load_dwordx4 v10, s[40:43], s87 offen lds
  s_waitcnt lgkmcnt(2)
  v_mfma_f32_32x32x16_bf16 v[64:79], v[32:35], a[72:75], v[64:79]
  ds_read_b64_tr_b16 v[40:41], v148 offset:47104
  ds_read_b64_tr_b16 v[42:43], v148 offset:48128
  buffer_load_dwordx4 a[128:131], v15, s[36:39], s88 offen sc1
  v_readlane_b32 s91, v3, 19
  s_waitcnt lgkmcnt(2)
  v_mfma_f32_32x32x16_bf16 v[80:95], v[36:39], a[72:75], v[80:95]
  ds_read_b64_tr_b16 v[44:45], v149 offset:47104
  ds_read_b64_tr_b16 v[46:47], v149 offset:48128
  buffer_load_dwordx4 a[132:135], v15, s[36:39], s89 offen sc1
  v_readlane_b32 s88, v3, 20
  s_waitcnt lgkmcnt(2)
  v_mfma_f32_32x32x16_bf16 v[64:79], v[40:43], a[76:79], v[64:79]
  ds_read_b64_tr_b16 v[32:33], v148 offset:53248
  ds_read_b64_tr_b16 v[34:35], v148 offset:54272
  buffer_load_dwordx4 v11, s[40:43], s87 offen offset:1024 lds
  s_add_u32 m0, s81, 73728
  v_readlane_b32 s85, v9, 13
  s_waitcnt lgkmcnt(2)
  v_mfma_f32_32x32x16_bf16 v[80:95], v[44:47], a[76:79], v[80:95]
  ds_read_b64_tr_b16 v[36:37], v149 offset:53248
  ds_read_b64_tr_b16 v[38:39], v149 offset:54272
  buffer_load_dwordx4 v10, s[40:43], s84 offen lds
  s_waitcnt lgkmcnt(2)
  v_mfma_f32_32x32x16_bf16 v[64:79], v[32:35], a[80:83], v[64:79]
  ds_read_b64_tr_b16 v[40:41], v148 offset:55296
  ds_read_b64_tr_b16 v[42:43], v148 offset:56320
  buffer_load_dwordx4 a[136:139], v15, s[36:39], s90 offen sc1
  v_readlane_b32 s89, v3, 21
  s_waitcnt lgkmcnt(2)
  v_mfma_f32_32x32x16_bf16 v[80:95], v[36:39], a[80:83], v[80:95]
  ds_read_b64_tr_b16 v[44:45], v149 offset:55296
  ds_read_b64_tr_b16 v[46:47], v149 offset:56320
  buffer_load_dwordx4 a[140:143], v15, s[36:39], s91 offen sc1
  v_readlane_b32 s90, v3, 22
  s_waitcnt lgkmcnt(2)
  v_mfma_f32_32x32x16_bf16 v[64:79], v[40:43], a[84:87], v[64:79]
  ds_read_b64_tr_b16 v[32:33], v148 offset:61440
  ds_read_b64_tr_b16 v[34:35], v148 offset:62464
  buffer_load_dwordx4 v11, s[40:43], s84 offen offset:1024 lds
  s_add_u32 m0, s81, 81920
  v_readlane_b32 s86, v9, 14
  s_waitcnt lgkmcnt(2)
  v_mfma_f32_32x32x16_bf16 v[80:95], v[44:47], a[84:87], v[80:95]
  ds_read_b64_tr_b16 v[36:37], v149 offset:61440
  ds_read_b64_tr_b16 v[38:39], v149 offset:62464
  buffer_load_dwordx4 v10, s[40:43], s85 offen lds
  s_waitcnt lgkmcnt(2)
  v_mfma_f32_32x32x16_bf16 v[64:79], v[32:35], a[88:91], v[64:79]
  ds_read_b64_tr_b16 v[40:41], v148 offset:63488
  ds_read_b64_tr_b16 v[42:43], v148 offset:64512
  buffer_load_dwordx4 a[144:147], v15, s[36:39], s88 offen sc1
  v_readlane_b32 s91, v3, 23
  s_waitcnt lgkmcnt(2)
  v_mfma_f32_32x32x16_bf16 v[80:95], v[36:39], a[88:91], v[80:95]
  ds_read_b64_tr_b16 v[44:45], v149 offset:63488
  ds_read_b64_tr_b16 v[46:47], v149 offset:64512
  buffer_load_dwordx4 a[148:151], v15, s[36:39], s89 offen sc1
  v_readlane_b32 s88, v3, 24
  s_waitcnt lgkmcnt(2)
  v_mfma_f32_32x32x16_bf16 v[64:79], v[40:43], a[92:95], v[64:79]
  s_waitcnt lgkmcnt(0)
  s_barrier
  ds_read_b64_tr_b16 v[32:33], v150 offset:4096
  buffer_load_dwordx4 v11, s[40:43], s85 offen offset:1024 lds
  v_mfma_f32_32x32x16_bf16 v[80:95], v[44:47], a[92:95], v[80:95]
  ds_read_b64_tr_b16 v[34:35], v150 offset:5120
  ds_read_b64_tr_b16 v[36:37], v151 offset:4096
  ds_read_b64_tr_b16 v[38:39], v151 offset:5120
  s_add_u32 m0, s81, 90112
  v_readlane_b32 s87, v9, 15
  buffer_load_dwordx4 v10, s[40:43], s86 offen lds
  s_waitcnt lgkmcnt(2)
  v_mfma_f32_32x32x16_bf16 v[64:79], v[32:35], a[96:99], v[64:79]
  ds_read_b64_tr_b16 v[40:41], v150 offset:6144
  ds_read_b64_tr_b16 v[42:43], v150 offset:7168
  buffer_load_dwordx4 a[152:155], v15, s[36:39], s90 offen sc1
  v_readlane_b32 s89, v3, 25
  s_waitcnt lgkmcnt(2)
  v_mfma_f32_32x32x16_bf16 v[80:95], v[36:39], a[96:99], v[80:95]
  ds_read_b64_tr_b16 v[44:45], v151 offset:6144
  ds_read_b64_tr_b16 v[46:47], v151 offset:7168
  buffer_load_dwordx4 a[156:159], v15, s[36:39], s91 offen sc1
  v_readlane_b32 s90, v3, 26
  s_waitcnt lgkmcnt(2)
  v_mfma_f32_32x32x16_bf16 v[64:79], v[40:43], a[100:103], v[64:79]
  ds_read_b64_tr_b16 v[32:33], v150 offset:12288
  ds_read_b64_tr_b16 v[34:35], v150 offset:13312
  buffer_load_dwordx4 v11, s[40:43], s86 offen offset:1024 lds
  s_add_u32 m0, s81, 32768
  v_readlane_b32 s84, v9, 16
  s_waitcnt lgkmcnt(2)
  v_mfma_f32_32x32x16_bf16 v[80:95], v[44:47], a[100:103], v[80:95]
  ds_read_b64_tr_b16 v[36:37], v151 offset:12288
  ds_read_b64_tr_b16 v[38:39], v151 offset:13312
  buffer_load_dwordx4 v10, s[40:43], s87 offen lds
  s_waitcnt lgkmcnt(2)
  v_mfma_f32_32x32x16_bf16 v[64:79], v[32:35], a[104:107], v[64:79]
  ds_read_b64_tr_b16 v[40:41], v150 offset:14336
  ds_read_b64_tr_b16 v[42:43], v150 offset:15360
  buffer_load_dwordx4 a[64:67], v15, s[36:39], s88 offen sc1
  v_readlane_b32 s91, v3, 27
  s_waitcnt lgkmcnt(2)
  v_mfma_f32_32x32x16_bf16 v[80:95], v[36:39], a[104:107], v[80:95]
  ds_read_b64_tr_b16 v[44:45], v151 offset:14336
  ds_read_b64_tr_b16 v[46:47], v151 offset:15360
  buffer_load_dwordx4 a[68:71], v15, s[36:39], s89 offen sc1
  v_readlane_b32 s88, v3, 28
  s_waitcnt lgkmcnt(2)
  v_mfma_f32_32x32x16_bf16 v[64:79], v[40:43], a[108:111], v[64:79]
  ds_read_b64_tr_b16 v[32:33], v150 offset:20480
  ds_read_b64_tr_b16 v[34:35], v150 offset:21504
  buffer_load_dwordx4 v11, s[40:43], s87 offen offset:1024 lds
  s_add_u32 m0, s81, 40960
  v_readlane_b32 s85, v9, 17
  s_waitcnt lgkmcnt(2)
  v_mfma_f32_32x32x16_bf16 v[80:95], v[44:47], a[108:111], v[80:95]
  ds_read_b64_tr_b16 v[36:37], v151 offset:20480
  ds_read_b64_tr_b16 v[38:39], v151 offset:21504
  buffer_load_dwordx4 v10, s[40:43], s84 offen lds
  s_waitcnt lgkmcnt(2)
  v_mfma_f32_32x32x16_bf16 v[64:79], v[32:35], a[112:115], v[64:79]
  ds_read_b64_tr_b16 v[40:41], v150 offset:22528
  ds_read_b64_tr_b16 v[42:43], v150 offset:23552
  buffer_load_dwordx4 a[72:75], v15, s[36:39], s90 offen sc1
  v_readlane_b32 s89, v3, 29
  s_waitcnt lgkmcnt(2)
  v_mfma_f32_32x32x16_bf16 v[80:95], v[36:39], a[112:115], v[80:95]
  ds_read_b64_tr_b16 v[44:45], v151 offset:22528
  ds_read_b64_tr_b16 v[46:47], v151 offset:23552
  buffer_load_dwordx4 a[76:79], v15, s[36:39], s91 offen sc1
  v_readlane_b32 s90, v3, 30
  s_waitcnt lgkmcnt(2)
  v_mfma_f32_32x32x16_bf16 v[64:79], v[40:43], a[116:119], v[64:79]
  ds_read_b64_tr_b16 v[32:33], v27 offset:0
  ds_read_b64_tr_b16 v[34:35], v27 offset:1024
  buffer_load_dwordx4 v11, s[40:43], s84 offen offset:1024 lds
  s_add_u32 m0, s81, 49152
  v_readlane_b32 s86, v9, 18
  s_waitcnt lgkmcnt(2)
  v_mfma_f32_32x32x16_bf16 v[80:95], v[44:47], a[116:119], v[80:95]
  ds_read_b64_tr_b16 v[36:37], v28 offset:0
  ds_read_b64_tr_b16 v[38:39], v28 offset:1024
  buffer_load_dwordx4 v10, s[40:43], s85 offen lds
  s_waitcnt lgkmcnt(2)
  v_mfma_f32_32x32x16_bf16 v[64:79], v[32:35], a[120:123], v[64:79]
  ds_read_b64_tr_b16 v[40:41], v27 offset:2048
  ds_read_b64_tr_b16 v[42:43], v27 offset:3072
  buffer_load_dwordx4 a[80:83], v15, s[36:39], s88 offen sc1
  v_readlane_b32 s91, v3, 31
  s_waitcnt lgkmcnt(2)
  v_mfma_f32_32x32x16_bf16 v[80:95], v[36:39], a[120:123], v[80:95]
  ds_read_b64_tr_b16 v[44:45], v28 offset:2048
  ds_read_b64_tr_b16 v[46:47], v28 offset:3072
  buffer_load_dwordx4 a[84:87], v15, s[36:39], s89 offen sc1
  v_readlane_b32 s88, v3, 32
  s_waitcnt lgkmcnt(2)
  v_mfma_f32_32x32x16_bf16 v[64:79], v[40:43], a[124:127], v[64:79]
  s_waitcnt vmcnt(23) lgkmcnt(0)
  s_barrier
  ds_read_b64_tr_b16 v[32:33], v27 offset:8192
  s_mov_b32 s71, 13312
  buffer_store_dword v13, v14, s[36:39], s71 offen sc1
  v_mfma_f32_32x32x16_bf16 v[80:95], v[44:47], a[124:127], v[80:95]
  ds_read_b64_tr_b16 v[34:35], v27 offset:9216
  ds_read_b64_tr_b16 v[36:37], v28 offset:8192
  ds_read_b64_tr_b16 v[38:39], v28 offset:9216
  buffer_load_dwordx4 v11, s[40:43], s85 offen offset:1024 lds
  s_add_u32 m0, s81, 57344
  v_readlane_b32 s87, v9, 19
  s_waitcnt lgkmcnt(2)
  v_mfma_f32_32x32x16_bf16 v[64:79], v[32:35], a[128:131], v[64:79]
  ds_read_b64_tr_b16 v[40:41], v27 offset:10240
  ds_read_b64_tr_b16 v[42:43], v27 offset:11264
  buffer_load_dwordx4 a[88:91], v15, s[36:39], s90 offen sc1
  s_cmp_lt_u32 s52, 2
  s_mov_b32 s82, 10240
  s_cselect_b32 s82, 10240, s82
  s_waitcnt lgkmcnt(2)
  v_mfma_f32_32x32x16_bf16 v[80:95], v[36:39], a[128:131], v[80:95]
  ds_read_b64_tr_b16 v[44:45], v28 offset:10240
  ds_read_b64_tr_b16 v[46:47], v28 offset:11264
  buffer_load_dword v25, v23, s[36:39], s82 offen sc1
  v_readlane_b32 s89, v3, 33
  s_waitcnt lgkmcnt(2)
  v_mfma_f32_32x32x16_bf16 v[64:79], v[40:43], a[132:135], v[64:79]
  ds_read_b64_tr_b16 v[32:33], v27 offset:16384
  ds_read_b64_tr_b16 v[34:35], v27 offset:17408
  buffer_load_dwordx4 a[92:95], v15, s[36:39], s91 offen sc1
  s_waitcnt vmcnt(1)
  v_cmp_ne_u32 vcc, s56, v25
  s_nop 0
  s_cbranch_vccnz L_slow85
L_back85:
  s_waitcnt lgkmcnt(2)
  v_mfma_f32_32x32x16_bf16 v[80:95], v[44:47], a[132:135], v[80:95]
  ds_read_b64_tr_b16 v[36:37], v28 offset:16384
  ds_read_b64_tr_b16 v[38:39], v28 offset:17408
  s_cmp_lt_u32 s52, 2
  s_mov_b32 s82, 10240
  s_cselect_b32 s82, 12352, s82
  buffer_load_dword v25, v23, s[36:39], s82 offen sc1
  v_readlane_b32 s90, v3, 34
  s_waitcnt lgkmcnt(2)
  v_mfma_f32_32x32x16_bf16 v[64:79], v[32:35], a[136:139], v[64:79]
  ds_read_b64_tr_b16 v[40:41], v27 offset:18432
  ds_read_b64_tr_b16 v[42:43], v27 offset:19456
  buffer_load_dwordx4 a[96:99], v15, s[36:39], s88 offen sc1
  v_readlane_b32 s91, v3, 35
  s_waitcnt lgkmcnt(2)
  v_mfma_f32_32x32x16_bf16 v[80:95], v[36:39], a[136:139], v[80:95]
  ds_read_b64_tr_b16 v[44:45], v28 offset:18432
  ds_read_b64_tr_b16 v[46:47], v28 offset:19456
  buffer_load_dwordx4 a[100:103], v15, s[36:39], s89 offen sc1
  v_readlane_b32 s88, v3, 36
  s_waitcnt lgkmcnt(2)
  v_mfma_f32_32x32x16_bf16 v[64:79], v[40:43], a[140:143], v[64:79]
  ds_read_b64_tr_b16 v[32:33], v27 offset:24576
  ds_read_b64_tr_b16 v[34:35], v27 offset:25600
  buffer_load_dwordx4 v10, s[40:43], s86 offen lds
  s_waitcnt lgkmcnt(2)
  v_mfma_f32_32x32x16_bf16 v[80:95], v[44:47], a[140:143], v[80:95]
  ds_read_b64_tr_b16 v[36:37], v28 offset:24576
  ds_read_b64_tr_b16 v[38:39], v28 offset:25600
  buffer_load_dwordx4 v11, s[40:43], s86 offen offset:1024 lds
  s_add_u32 m0, s81, 102400
  v_readlane_b32 s84, v9, 20
  s_waitcnt lgkmcnt(2)
  v_mfma_f32_32x32x16_bf16 v[64:79], v[32:35], a[144:147], v[64:79]
  ds_read_b64_tr_b16 v[40:41], v27 offset:26624
  ds_read_b64_tr_b16 v[42:43], v27 offset:27648
  buffer_load_dwordx4 a[104:107], v15, s[36:39], s90 offen sc1
  v_readlane_b32 s89, v3, 37
  v_lshlrev_b32 v48, 16, v128
  v_lshlrev_b32 v50, 16, v129
  s_waitcnt lgkmcnt(2)
  v_mfma_f32_32x32x16_bf16 v[80:95], v[36:39], a[144:147], v[80:95]
  ds_read_b64_tr_b16 v[44:45], v28 offset:26624
  ds_read_b64_tr_b16 v[46:47], v28 offset:27648
  buffer_load_dwordx4 a[108:111], v15, s[36:39], s91 offen sc1
  v_readlane_b32 s90, v3, 38
  v_lshlrev_b32 v52, 16, v130
  v_lshlrev_b32 v54, 16, v131
  s_waitcnt lgkmcnt(2)
  v_mfma_f32_32x32x16_bf16 v[64:79], v[40:43], a[148:151], v[64:79]
  ds_read_b64_tr_b16 v[32:33], v148 offset:0
  ds_read_b64_tr_b16 v[34:35], v148 offset:1024
  v_lshlrev_b32 v136, 16, v132
  v_lshlrev_b32 v138, 16, v133
  v_lshlrev_b32 v140, 16, v134
  v_lshlrev_b32 v142, 16, v135
  v_and_b32 v49, 0xffff0000, v128
  s_waitcnt lgkmcnt(2)
  v_mfma_f32_32x32x16_bf16 v[80:95], v[44:47], a[148:151], v[80:95]
  ds_read_b64_tr_b16 v[36:37], v149 offset:0
  ds_read_b64_tr_b16 v[38:39], v149 offset:1024
  v_and_b32 v51, 0xffff0000, v129
  v_and_b32 v53, 0xffff0000, v130
  v_and_b32 v55, 0xffff0000, v131
  v_and_b32 v137, 0xffff0000, v132
  v_and_b32 v139, 0xffff0000, v133
  s_waitcnt lgkmcnt(2)
  v_mfma_f32_32x32x16_bf16 v[64:79], v[32:35], a[152:155], v[64:79]
  ds_read_b64_tr_b16 v[40:41], v148 offset:2048
  ds_read_b64_tr_b16 v[42:43], v148 offset:3072
  buffer_load_dwordx4 a[112:115], v15, s[36:39], s88 offen sc1
  v_readlane_b32 s91, v3, 39
  buffer_load_dwordx4 a[116:119], v15, s[36:39], s89 offen sc1
  s_waitcnt lgkmcnt(2)
  v_mfma_f32_32x32x16_bf16 v[80:95], v[36:39], a[152:155], v[80:95]
  ds_read_b64_tr_b16 v[44:45], v149 offset:2048
  ds_read_b64_tr_b16 v[46:47], v149 offset:3072
  v_readlane_b32 s88, v3, 40
  buffer_load_dwordx4 a[120:123], v15, s[36:39], s90 offen sc1
  v_readlane_b32 s89, v3, 41
  v_and_b32 v141, 0xffff0000, v134
  s_waitcnt lgkmcnt(2)
  v_mfma_f32_32x32x16_bf16 v[64:79], v[40:43], a[156:159], v[64:79]
  s_waitcnt lgkmcnt(0)
  s_barrier
  ds_read_b64_tr_b16 v[32:33], v148 offset:8192
  v_and_b32 v143, 0xffff0000, v135
  buffer_load_dwordx4 v10, s[40:43], s87 offen lds
  v_mfma_f32_32x32x16_bf16 v[80:95], v[44:47], a[156:159], v[80:95]
  ds_read_b64_tr_b16 v[34:35], v148 offset:9216
  ds_read_b64_tr_b16 v[36:37], v149 offset:8192
  ds_read_b64_tr_b16 v[38:39], v149 offset:9216
  buffer_load_dwordx4 v11, s[40:43], s87 offen offset:1024 lds
  s_add_u32 m0, s81, 110592
  v_readlane_b32 s85, v9, 21
  s_waitcnt lgkmcnt(2)
  v_mfma_f32_32x32x16_bf16 v[64:79], v[32:35], a[64:67], v[64:79]
  ds_read_b64_tr_b16 v[40:41], v148 offset:10240
  ds_read_b64_tr_b16 v[42:43], v148 offset:11264
  buffer_load_dwordx4 v10, s[44:47], s84 offen lds
  s_waitcnt lgkmcnt(2)
  v_mfma_f32_32x32x16_bf16 v[80:95], v[36:39], a[64:67], v[80:95]
  ds_read_b64_tr_b16 v[44:45], v149 offset:10240
  ds_read_b64_tr_b16 v[46:47], v149 offset:11264
  buffer_load_dwordx4 v11, s[44:47], s84 offen offset:1024 lds
  s_add_u32 m0, s81, 118784
  v_readlane_b32 s86, v9, 22
  s_waitcnt lgkmcnt(2)
  v_mfma_f32_32x32x16_bf16 v[64:79], v[40:43], a[68:71], v[64:79]
  ds_read_b64_tr_b16 v[32:33], v148 offset:16384
  ds_read_b64_tr_b16 v[34:35], v148 offset:17408
  buffer_load_dwordx4 a[124:127], v15, s[36:39], s91 offen sc1
  s_waitcnt vmcnt(14)
  v_cmp_ne_u32 vcc, s56, v25
  s_nop 0
  s_cbranch_vccnz L_slow86
L_back86:
  s_waitcnt lgkmcnt(2)
  v_mfma_f32_32x32x16_bf16 v[80:95], v[44:47], a[68:71], v[80:95]
  ds_read_b64_tr_b16 v[36:37], v149 offset:16384
  ds_read_b64_tr_b16 v[38:39], v149 offset:17408
  v_readlane_b32 s90, v3, 42
  buffer_load_dwordx4 a[128:131], v15, s[36:39], s88 offen sc1
  v_readlane_b32 s91, v3, 43
  s_waitcnt lgkmcnt(2)
  v_mfma_f32_32x32x16_bf16 v[64:79], v[32:35], a[72:75], v[64:79]
  ds_read_b64_tr_b16 v[40:41], v148 offset:18432
  ds_read_b64_tr_b16 v[42:43], v148 offset:19456
  buffer_load_dwordx4 v10, s[44:47], s85 offen lds
  s_waitcnt lgkmcnt(2)
  v_mfma_f32_32x32x16_bf16 v[80:95], v[36:39], a[72:75], v[80:95]
  ds_read_b64_tr_b16 v[44:45], v149 offset:18432
  ds_read_b64_tr_b16 v[46:47], v149 offset:19456
  buffer_load_dwordx4 v11, s[44:47], s85 offen offset:1024 lds
  s_add_u32 m0, s81, 126976
  v_readlane_b32 s87, v9, 23
  s_waitcnt lgkmcnt(2)
  v_mfma_f32_32x32x16_bf16 v[64:79], v[40:43], a[76:79], v[64:79]
  ds_read_b64_tr_b16 v[32:33], v148 offset:24576
  ds_read_b64_tr_b16 v[34:35], v148 offset:25600
  buffer_load_dwordx4 a[132:135], v15, s[36:39], s89 offen sc1
  v_readlane_b32 s88, v3, 44
  s_waitcnt lgkmcnt(2)
  v_mfma_f32_32x32x16_bf16 v[80:95], v[44:47], a[76:79], v[80:95]
  ds_read_b64_tr_b16 v[36:37], v149 offset:24576
  ds_read_b64_tr_b16 v[38:39], v149 offset:25600
  buffer_load_dwordx4 a[136:139], v15, s[36:39], s90 offen sc1
  v_readlane_b32 s89, v3, 45
  s_waitcnt lgkmcnt(2)
  v_mfma_f32_32x32x16_bf16 v[64:79], v[32:35], a[80:83], v[64:79]
  ds_read_b64_tr_b16 v[40:41], v148 offset:26624
  ds_read_b64_tr_b16 v[42:43], v148 offset:27648
  buffer_load_dwordx4 v10, s[44:47], s86 offen lds
  s_waitcnt lgkmcnt(2)
  v_mfma_f32_32x32x16_bf16 v[80:95], v[36:39], a[80:83], v[80:95]
  ds_read_b64_tr_b16 v[44:45], v149 offset:26624
  ds_read_b64_tr_b16 v[46:47], v149 offset:27648
  buffer_load_dwordx4 v11, s[44:47], s86 offen offset:1024 lds
  s_add_u32 m0, s81, 135168
  v_readlane_b32 s84, v9, 24
  s_waitcnt lgkmcnt(2)
  v_mfma_f32_32x32x16_bf16 v[64:79], v[40:43], a[84:87], v[64:79]
  ds_read_b64_tr_b16 v[32:33], v27 offset:32768
  ds_read_b64_tr_b16 v[34:35], v27 offset:33792
  buffer_load_dwordx4 a[140:143], v15, s[36:39], s91 offen sc1
  v_readlane_b32 s90, v3, 46
  s_waitcnt lgkmcnt(2)
  v_mfma_f32_32x32x16_bf16 v[80:95], v[44:47], a[84:87], v[80:95]
  ds_read_b64_tr_b16 v[36:37], v28 offset:32768
  ds_read_b64_tr_b16 v[38:39], v28 offset:33792
  buffer_load_dwordx4 a[144:147], v15, s[36:39], s88 offen sc1
  v_readlane_b32 s91, v3, 47
  s_waitcnt lgkmcnt(2)
  v_mfma_f32_32x32x16_bf16 v[64:79], v[32:35], a[88:91], v[64:79]
  ds_read_b64_tr_b16 v[40:41], v27 offset:34816
  ds_read_b64_tr_b16 v[42:43], v27 offset:35840
  buffer_load_dwordx4 v10, s[44:47], s87 offen lds
  s_waitcnt lgkmcnt(2)
  v_mfma_f32_32x32x16_bf16 v[80:95], v[36:39], a[88:91], v[80:95]
  ds_read_b64_tr_b16 v[44:45], v28 offset:34816
  ds_read_b64_tr_b16 v[46:47], v28 offset:35840
  buffer_load_dwordx4 v11, s[44:47], s87 offen offset:1024 lds
  s_add_u32 m0, s81, 143360
  v_readlane_b32 s85, v9, 25
  s_waitcnt lgkmcnt(2)
  v_mfma_f32_32x32x16_bf16 v[64:79], v[40:43], a[92:95], v[64:79]
  s_waitcnt vmcnt(14) lgkmcnt(0)
  s_barrier
  ds_read_b64_tr_b16 v[32:33], v27 offset:40960
  buffer_load_dwordx4 a[148:151], v15, s[36:39], s89 offen sc1
  v_readlane_b32 s88, v3, 48
  v_mfma_f32_32x32x16_bf16 v[80:95], v[44:47], a[92:95], v[80:95]
  ds_read_b64_tr_b16 v[34:35], v27 offset:41984
  ds_read_b64_tr_b16 v[36:37], v28 offset:40960
  ds_read_b64_tr_b16 v[38:39], v28 offset:41984
  buffer_load_dwordx4 a[152:155], v15, s[36:39], s90 offen sc1
  v_readlane_b32 s89, v3, 49
  s_waitcnt lgkmcnt(2)
  v_mfma_f32_32x32x16_bf16 v[64:79], v[32:35], a[96:99], v[64:79]
  ds_read_b64_tr_b16 v[40:41], v27 offset:43008
  ds_read_b64_tr_b16 v[42:43], v27 offset:44032
  buffer_load_dwordx4 v10, s[44:47], s84 offen lds
  s_waitcnt lgkmcnt(2)
  v_mfma_f32_32x32x16_bf16 v[80:95], v[36:39], a[96:99], v[80:95]
  ds_read_b64_tr_b16 v[44:45], v28 offset:43008
  ds_read_b64_tr_b16 v[46:47], v28 offset:44032
  buffer_load_dwordx4 v11, s[44:47], s84 offen offset:1024 lds
  s_add_u32 m0, s81, 151552
  v_readlane_b32 s86, v9, 26
  s_waitcnt lgkmcnt(2)
  v_mfma_f32_32x32x16_bf16 v[64:79], v[40:43], a[100:103], v[64:79]
  ds_read_b64_tr_b16 v[32:33], v27 offset:49152
  ds_read_b64_tr_b16 v[34:35], v27 offset:50176
  buffer_load_dwordx4 a[156:159], v15, s[36:39], s91 offen sc1
  v_readlane_b32 s90, v3, 50
  s_waitcnt lgkmcnt(2)
  v_mfma_f32_32x32x16_bf16 v[80:95], v[44:47], a[100:103], v[80:95]
  ds_read_b64_tr_b16 v[36:37], v28 offset:49152
  ds_read_b64_tr_b16 v[38:39], v28 offset:50176
  buffer_load_dwordx4 a[64:67], v15, s[36:39], s88 offen sc1
  v_readlane_b32 s91, v3, 51
  s_waitcnt lgkmcnt(2)
  v_mfma_f32_32x32x16_bf16 v[64:79], v[32:35], a[104:107], v[64:79]
  ds_read_b64_tr_b16 v[40:41], v27 offset:51200
  ds_read_b64_tr_b16 v[42:43], v27 offset:52224
  buffer_load_dwordx4 v10, s[44:47], s85 offen lds
  s_waitcnt lgkmcnt(2)
  v_mfma_f32_32x32x16_bf16 v[80:95], v[36:39], a[104:107], v[80:95]
  ds_read_b64_tr_b16 v[44:45], v28 offset:51200
  ds_read_b64_tr_b16 v[46:47], v28 offset:52224
  buffer_load_dwordx4 v11, s[44:47], s85 offen offset:1024 lds
  s_add_u32 m0, s81, 0
  v_readlane_b32 s87, v9, 27
  s_waitcnt lgkmcnt(2)
  v_mfma_f32_32x32x16_bf16 v[64:79], v[40:43], a[108:111], v[64:79]
  ds_read_b64_tr_b16 v[32:33], v27 offset:57344
  ds_read_b64_tr_b16 v[34:35], v27 offset:58368
  buffer_load_dwordx4 a[68:71], v15, s[36:39], s89 offen sc1
  v_readlane_b32 s88, v3, 52
  s_waitcnt lgkmcnt(2)
  v_mfma_f32_32x32x16_bf16 v[80:95], v[44:47], a[108:111], v[80:95]
  ds_read_b64_tr_b16 v[36:37], v28 offset:57344
  ds_read_b64_tr_b16 v[38:39], v28 offset:58368
  buffer_load_dwordx4 a[72:75], v15, s[36:39], s90 offen sc1
  v_readlane_b32 s89, v3, 53
  s_waitcnt lgkmcnt(2)
  v_mfma_f32_32x32x16_bf16 v[64:79], v[32:35], a[112:115], v[64:79]
  ds_read_b64_tr_b16 v[40:41], v27 offset:59392
  ds_read_b64_tr_b16 v[42:43], v27 offset:60416
  buffer_load_dwordx4 v10, s[44:47], s86 offen lds
  s_waitcnt lgkmcnt(2)
  v_mfma_f32_32x32x16_bf16 v[80:95], v[36:39], a[112:115], v[80:95]
  ds_read_b64_tr_b16 v[44:45], v28 offset:59392
  ds_read_b64_tr_b16 v[46:47], v28 offset:60416
  buffer_load_dwordx4 v11, s[44:47], s86 offen offset:1024 lds
  s_add_u32 m0, s81, 8192
  v_readlane_b32 s84, v9, 28
  s_waitcnt lgkmcnt(2)
  v_mfma_f32_32x32x16_bf16 v[64:79], v[40:43], a[116:119], v[64:79]
  ds_read_b64_tr_b16 v[32:33], v148 offset:36864
  ds_read_b64_tr_b16 v[34:35], v148 offset:37888
  buffer_load_dwordx4 a[76:79], v15, s[36:39], s91 offen sc1
  v_readlane_b32 s90, v3, 54
  s_waitcnt lgkmcnt(2)
  v_mfma_f32_32x32x16_bf16 v[80:95], v[44:47], a[116:119], v[80:95]
  ds_read_b64_tr_b16 v[36:37], v149 offset:36864
  ds_read_b64_tr_b16 v[38:39], v149 offset:37888
  buffer_load_dwordx4 a[80:83], v15, s[36:39], s88 offen sc1
  v_readlane_b32 s91, v3, 55
  s_waitcnt lgkmcnt(2)
  v_mfma_f32_32x32x16_bf16 v[64:79], v[32:35], a[120:123], v[64:79]
  ds_read_b64_tr_b16 v[40:41], v148 offset:38912
  ds_read_b64_tr_b16 v[42:43], v148 offset:39936
  buffer_load_dwordx4 v10, s[44:47], s87 offen lds
  s_waitcnt lgkmcnt(2)
  v_mfma_f32_32x32x16_bf16 v[80:95], v[36:39], a[120:123], v[80:95]
  ds_read_b64_tr_b16 v[44:45], v149 offset:38912
  ds_read_b64_tr_b16 v[46:47], v149 offset:39936
  buffer_load_dwordx4 v11, s[44:47], s87 offen offset:1024 lds
  s_add_u32 m0, s81, 16384
  v_readlane_b32 s85, v9, 29
  s_waitcnt vmcnt(27) lgkmcnt(2)
  v_mfma_f32_32x32x16_bf16 v[64:79], v[40:43], a[124:127], v[64:79]
  s_waitcnt vmcnt(16) lgkmcnt(0)
  s_barrier
  ds_read_b64_tr_b16 v[32:33], v148 offset:45056
  buffer_load_dwordx4 a[84:87], v15, s[36:39], s89 offen sc1
  v_readlane_b32 s88, v3, 56
  v_mfma_f32_32x32x16_bf16 v[80:95], v[44:47], a[124:127], v[80:95]
  ds_read_b64_tr_b16 v[34:35], v148 offset:46080
  ds_read_b64_tr_b16 v[36:37], v149 offset:45056
  ds_read_b64_tr_b16 v[38:39], v149 offset:46080
  buffer_load_dwordx4 a[88:91], v15, s[36:39], s90 offen sc1
  s_waitcnt lgkmcnt(2)
  v_mfma_f32_32x32x16_bf16 v[96:111], v[32:35], a[128:131], 0
  ds_read_b64_tr_b16 v[40:41], v148 offset:47104
  ds_read_b64_tr_b16 v[42:43], v148 offset:48128
  buffer_load_dwordx4 v10, s[44:47], s84 offen lds
  s_cmp_lt_u32 s52, 2
  s_mov_b32 s82, 11264
  s_cselect_b32 s82, 13376, s82
  s_waitcnt lgkmcnt(2)
  v_mfma_f32_32x32x16_bf16 v[112:127], v[36:39], a[128:131], 0
  ds_read_b64_tr_b16 v[44:45], v149 offset:47104
  ds_read_b64_tr_b16 v[46:47], v149 offset:48128
  buffer_load_dwordx4 v11, s[44:47], s84 offen offset:1024 lds
  s_add_u32 m0, s81, 24576
  v_readlane_b32 s86, v9, 30
  s_waitcnt lgkmcnt(2)
  v_mfma_f32_32x32x16_bf16 v[96:111], v[40:43], a[132:135], v[96:111]
  ds_read_b64_tr_b16 v[32:33], v148 offset:53248
  ds_read_b64_tr_b16 v[34:35], v148 offset:54272
  buffer_load_dword v25, v23, s[36:39], s82 offen sc1
  v_readlane_b32 s89, v3, 57
  s_waitcnt lgkmcnt(2)
  v_mfma_f32_32x32x16_bf16 v[112:127], v[44:47], a[132:135], v[112:127]
  ds_read_b64_tr_b16 v[36:37], v149 offset:53248
  ds_read_b64_tr_b16 v[38:39], v149 offset:54272
  buffer_load_dwordx4 a[92:95], v15, s[36:39], s91 offen sc1
  s_waitcnt vmcnt(1)
  v_cmp_ne_u32 vcc, s56, v25
  s_nop 0
  s_cbranch_vccnz L_slow87
L_back87:
  s_waitcnt lgkmcnt(2)
  v_mfma_f32_32x32x16_bf16 v[96:111], v[32:35], a[136:139], v[96:111]
  ds_read_b64_tr_b16 v[40:41], v148 offset:55296
  ds_read_b64_tr_b16 v[42:43], v148 offset:56320
  v_readlane_b32 s90, v3, 58
  buffer_load_dwordx4 a[96:99], v15, s[36:39], s88 offen sc1
  v_readlane_b32 s91, v3, 59
  s_waitcnt lgkmcnt(2)
  v_mfma_f32_32x32x16_bf16 v[112:127], v[36:39], a[136:139], v[112:127]
  ds_read_b64_tr_b16 v[44:45], v149 offset:55296
  ds_read_b64_tr_b16 v[46:47], v149 offset:56320
  buffer_load_dwordx4 a[100:103], v15, s[36:39], s89 offen sc1
  v_readlane_b32 s88, v3, 60
  ds_write_b128 v146, v[80:83] offset:49152
  s_waitcnt lgkmcnt(3)
  v_mfma_f32_32x32x16_bf16 v[96:111], v[40:43], a[140:143], v[96:111]
  ds_read_b64_tr_b16 v[32:33], v148 offset:61440
  ds_read_b64_tr_b16 v[34:35], v148 offset:62464
  ds_write_b128 v146, v[84:87] offset:50176
  ds_write_b128 v146, v[88:91] offset:51200
  s_waitcnt lgkmcnt(5)
  v_mfma_f32_32x32x16_bf16 v[112:127], v[44:47], a[140:143], v[112:127]
  ds_read_b64_tr_b16 v[36:37], v149 offset:61440
  ds_read_b64_tr_b16 v[38:39], v149 offset:62464
  ds_write_b128 v146, v[92:95] offset:52224
  buffer_load_dwordx4 v10, s[44:47], s85 offen lds
  s_waitcnt lgkmcnt(5)
  v_mfma_f32_32x32x16_bf16 v[96:111], v[32:35], a[144:147], v[96:111]
  ds_read_b64_tr_b16 v[40:41], v148 offset:63488
  ds_read_b64_tr_b16 v[42:43], v148 offset:64512
  buffer_load_dwordx4 a[104:107], v15, s[36:39], s90 offen sc1
  v_readlane_b32 s89, v3, 61
  buffer_load_dwordx4 a[108:111], v15, s[36:39], s91 offen sc1
  s_waitcnt lgkmcnt(3)
  v_mfma_f32_32x32x16_bf16 v[112:127], v[36:39], a[144:147], v[112:127]
  ds_read_b64_tr_b16 v[44:45], v149 offset:63488
  ds_read_b64_tr_b16 v[46:47], v149 offset:64512
  v_readlane_b32 s90, v3, 62
  buffer_load_dwordx4 a[112:115], v15, s[36:39], s88 offen sc1
  v_readlane_b32 s91, v3, 63
  s_waitcnt lgkmcnt(2)
  v_mfma_f32_32x32x16_bf16 v[96:111], v[40:43], a[148:151], v[96:111]
  ds_read_b64_tr_b16 v[32:33], v150 offset:4096
  ds_read_b64_tr_b16 v[34:35], v150 offset:5120
  buffer_load_dwordx4 v11, s[44:47], s85 offen offset:1024 lds
  s_add_u32 m0, s81, 65536
  v_readlane_b32 s87, v9, 31
  s_waitcnt lgkmcnt(2)
  v_mfma_f32_32x32x16_bf16 v[112:127], v[44:47], a[148:151], v[112:127]
  ds_read_b64_tr_b16 v[36:37], v151 offset:4096
  ds_read_b64_tr_b16 v[38:39], v151 offset:5120
  buffer_load_dwordx4 v10, s[44:47], s86 offen lds
  s_waitcnt lgkmcnt(2)
  v_mfma_f32_32x32x16_bf16 v[96:111], v[32:35], a[152:155], v[96:111]
  ds_read_b64_tr_b16 v[40:41], v150 offset:6144
  ds_read_b64_tr_b16 v[42:43], v150 offset:7168
  buffer_load_dwordx4 v11, s[44:47], s86 offen offset:1024 lds
  s_add_u32 m0, s81, 73728
  v_readlane_b32 s84, v9, 32
  s_waitcnt lgkmcnt(2)
  v_mfma_f32_32x32x16_bf16 v[112:127], v[36:39], a[152:155], v[112:127]
  ds_read_b64_tr_b16 v[44:45], v151 offset:6144
  ds_read_b64_tr_b16 v[46:47], v151 offset:7168
  buffer_load_dwordx4 v10, s[44:47], s87 offen lds
  s_waitcnt lgkmcnt(2)
  v_mfma_f32_32x32x16_bf16 v[96:111], v[40:43], a[156:159], v[96:111]
  s_waitcnt lgkmcnt(0)
  s_barrier
  ds_read_b64_tr_b16 v[32:33], v150 offset:12288
  buffer_load_dwordx4 a[116:119], v15, s[36:39], s89 offen sc1
  v_readlane_b32 s88, v4, 0
  v_mfma_f32_32x32x16_bf16 v[112:127], v[44:47], a[156:159], v[112:127]
  ds_read_b64_tr_b16 v[34:35], v150 offset:13312
  ds_read_b64_tr_b16 v[36:37], v151 offset:12288
  ds_read_b64_tr_b16 v[38:39], v151 offset:13312
  buffer_load_dwordx4 a[120:123], v15, s[36:39], s90 offen sc1
  v_readlane_b32 s89, v4, 1
  s_waitcnt lgkmcnt(2)
  v_mfma_f32_32x32x16_bf16 v[96:111], v[32:35], a[64:67], v[96:111]
  ds_read_b64_tr_b16 v[40:41], v150 offset:14336
  ds_read_b64_tr_b16 v[42:43], v150 offset:15360
  buffer_load_dwordx4 v11, s[44:47], s87 offen offset:1024 lds
  s_add_u32 m0, s81, 81920
  v_readlane_b32 s85, v9, 33
  s_waitcnt lgkmcnt(2)
  v_mfma_f32_32x32x16_bf16 v[112:127], v[36:39], a[64:67], v[112:127]
  ds_read_b64_tr_b16 v[44:45], v151 offset:14336
  ds_read_b64_tr_b16 v[46:47], v151 offset:15360
  buffer_load_dwordx4 v10, s[44:47], s84 offen lds
  s_waitcnt lgkmcnt(2)
  v_mfma_f32_32x32x16_bf16 v[96:111], v[40:43], a[68:71], v[96:111]
  ds_read_b64_tr_b16 v[32:33], v150 offset:20480
  ds_read_b64_tr_b16 v[34:35], v150 offset:21504
  buffer_load_dwordx4 a[124:127], v15, s[36:39], s91 offen sc1
  v_readlane_b32 s90, v4, 2
  s_waitcnt lgkmcnt(2)
  v_mfma_f32_32x32x16_bf16 v[112:127], v[44:47], a[68:71], v[112:127]
  ds_read_b64_tr_b16 v[36:37], v151 offset:20480
  ds_read_b64_tr_b16 v[38:39], v151 offset:21504
  buffer_load_dwordx4 a[128:131], v15, s[36:39], s88 offen sc1
  v_readlane_b32 s91, v4, 3
  s_waitcnt lgkmcnt(2)
  v_mfma_f32_32x32x16_bf16 v[96:111], v[32:35], a[72:75], v[96:111]
  ds_read_b64_tr_b16 v[40:41], v150 offset:22528
  ds_read_b64_tr_b16 v[42:43], v150 offset:23552
  buffer_load_dwordx4 v11, s[44:47], s84 offen offset:1024 lds
  s_add_u32 m0, s81, 90112
  v_readlane_b32 s86, v9, 34
  s_waitcnt lgkmcnt(2)
  v_mfma_f32_32x32x16_bf16 v[112:127], v[36:39], a[72:75], v[112:127]
  ds_read_b64_tr_b16 v[44:45], v151 offset:22528
  ds_read_b64_tr_b16 v[46:47], v151 offset:23552
  buffer_load_dwordx4 v10, s[44:47], s85 offen lds
  s_waitcnt lgkmcnt(2)
  v_mfma_f32_32x32x16_bf16 v[96:111], v[40:43], a[76:79], v[96:111]
  ds_read_b64_tr_b16 v[32:33], v27 offset:0
  ds_read_b64_tr_b16 v[34:35], v27 offset:1024
  buffer_load_dwordx4 a[132:135], v15, s[36:39], s89 offen sc1
  v_readlane_b32 s88, v4, 4
  s_waitcnt lgkmcnt(2)
  v_mfma_f32_32x32x16_bf16 v[112:127], v[44:47], a[76:79], v[112:127]
  ds_read_b64_tr_b16 v[36:37], v28 offset:0
  ds_read_b64_tr_b16 v[38:39], v28 offset:1024
  buffer_load_dwordx4 a[136:139], v15, s[36:39], s90 offen sc1
  v_readlane_b32 s89, v4, 5
  s_waitcnt lgkmcnt(2)
  v_mfma_f32_32x32x16_bf16 v[96:111], v[32:35], a[80:83], v[96:111]
  ds_read_b64_tr_b16 v[40:41], v27 offset:2048
  ds_read_b64_tr_b16 v[42:43], v27 offset:3072
  buffer_load_dwordx4 v11, s[44:47], s85 offen offset:1024 lds
  s_add_u32 m0, s81, 32768
  v_readlane_b32 s87, v9, 35
  s_waitcnt lgkmcnt(2)
  v_mfma_f32_32x32x16_bf16 v[112:127], v[36:39], a[80:83], v[112:127]
  ds_read_b64_tr_b16 v[44:45], v28 offset:2048
  ds_read_b64_tr_b16 v[46:47], v28 offset:3072
  buffer_load_dwordx4 v10, s[44:47], s86 offen lds
  s_waitcnt lgkmcnt(2)
  v_mfma_f32_32x32x16_bf16 v[96:111], v[40:43], a[84:87], v[96:111]
  ds_read_b64_tr_b16 v[32:33], v27 offset:8192
  ds_read_b64_tr_b16 v[34:35], v27 offset:9216
  buffer_load_dwordx4 a[140:143], v15, s[36:39], s91 offen sc1
  v_readlane_b32 s90, v4, 6
  s_waitcnt lgkmcnt(2)
  v_mfma_f32_32x32x16_bf16 v[112:127], v[44:47], a[84:87], v[112:127]
  ds_read_b64_tr_b16 v[36:37], v28 offset:8192
  ds_read_b64_tr_b16 v[38:39], v28 offset:9216
  buffer_load_dwordx4 a[144:147], v15, s[36:39], s88 offen sc1
  v_readlane_b32 s91, v4, 7
  s_waitcnt lgkmcnt(2)
  v_mfma_f32_32x32x16_bf16 v[96:111], v[32:35], a[88:91], v[96:111]
  ds_read_b64_tr_b16 v[40:41], v27 offset:10240
  ds_read_b64_tr_b16 v[42:43], v27 offset:11264
  buffer_load_dwordx4 v11, s[44:47], s86 offen offset:1024 lds
  s_add_u32 m0, s81, 40960
  s_waitcnt lgkmcnt(2)
  v_mfma_f32_32x32x16_bf16 v[112:127], v[36:39], a[88:91], v[112:127]
  ds_read_b64_tr_b16 v[44:45], v28 offset:10240
  ds_read_b64_tr_b16 v[46:47], v28 offset:11264
  buffer_load_dwordx4 v10, s[44:47], s87 offen lds
  s_waitcnt vmcnt(26) lgkmcnt(2)
  v_mfma_f32_32x32x16_bf16 v[96:111], v[40:43], a[92:95], v[96:111]
  s_waitcnt vmcnt(13) lgkmcnt(0)
  s_barrier
  ds_read_b64_tr_b16 v[32:33], v27 offset:16384
  buffer_load_dwordx4 a[148:151], v15, s[36:39], s89 offen sc1
  v_mfma_f32_32x32x16_bf16 v[112:127], v[44:47], a[92:95], v[112:127]
  ds_read_b64_tr_b16 v[34:35], v27 offset:17408
  ds_read_b64_tr_b16 v[36:37], v28 offset:16384
  ds_read_b64_tr_b16 v[38:39], v28 offset:17408
  buffer_load_dwordx4 a[152:155], v15, s[36:39], s90 offen sc1
  s_waitcnt lgkmcnt(2)
  v_mfma_f32_32x32x16_bf16 v[96:111], v[32:35], a[96:99], v[96:111]
  ds_read_b64_tr_b16 v[40:41], v27 offset:18432
  ds_read_b64_tr_b16 v[42:43], v27 offset:19456
  ds_read_b128 v[80:83], v147 offset:49152
  ds_read_b128 v[84:87], v147 offset:50176
  ds_read_b128 v[88:91], v147 offset:51200
  ds_read_b128 v[92:95], v147 offset:52224
  s_waitcnt lgkmcnt(6)
  v_mfma_f32_32x32x16_bf16 v[112:127], v[36:39], a[96:99], v[112:127]
  ds_read_b64_tr_b16 v[44:45], v28 offset:18432
  ds_read_b64_tr_b16 v[46:47], v28 offset:19456
  buffer_load_dwordx4 v11, s[44:47], s87 offen offset:1024 lds
  buffer_load_dwordx4 a[156:159], v15, s[36:39], s91 offen sc1
  s_waitcnt lgkmcnt(6)
  v_mfma_f32_32x32x16_bf16 v[96:111], v[40:43], a[100:103], v[96:111]
  ds_read_b64_tr_b16 v[32:33], v27 offset:24576
  ds_read_b64_tr_b16 v[34:35], v27 offset:25600
  s_waitcnt lgkmcnt(2)
  v_mfma_f32_32x32x16_bf16 v[112:127], v[44:47], a[100:103], v[112:127]
  ds_read_b64_tr_b16 v[36:37], v28 offset:24576
  ds_read_b64_tr_b16 v[38:39], v28 offset:25600
  s_waitcnt lgkmcnt(2)
  v_mfma_f32_32x32x16_bf16 v[96:111], v[32:35], a[104:107], v[96:111]
  ds_read_b64_tr_b16 v[40:41], v27 offset:26624
  ds_read_b64_tr_b16 v[42:43], v27 offset:27648
  s_waitcnt lgkmcnt(2)
  v_mfma_f32_32x32x16_bf16 v[112:127], v[36:39], a[104:107], v[112:127]
  ds_read_b64_tr_b16 v[44:45], v28 offset:26624
  ds_read_b64_tr_b16 v[46:47], v28 offset:27648
  s_waitcnt lgkmcnt(2)
  v_mfma_f32_32x32x16_bf16 v[96:111], v[40:43], a[108:111], v[96:111]
  ds_read_b64_tr_b16 v[32:33], v148 offset:0
  ds_read_b64_tr_b16 v[34:35], v148 offset:1024
  s_waitcnt lgkmcnt(2)
  v_mfma_f32_32x32x16_bf16 v[112:127], v[44:47], a[108:111], v[112:127]
  ds_read_b64_tr_b16 v[36:37], v149 offset:0
  ds_read_b64_tr_b16 v[38:39], v149 offset:1024
  s_waitcnt lgkmcnt(2)
  v_mfma_f32_32x32x16_bf16 v[96:111], v[32:35], a[112:115], v[96:111]
  ds_read_b64_tr_b16 v[40:41], v148 offset:2048
  ds_read_b64_tr_b16 v[42:43], v148 offset:3072
  v_add_f32 v64, v64, v80
  v_add_f32 v65, v65, v81
  v_add_f32 v66, v66, v82
  v_add_f32 v67, v67, v83
  v_add_f32 v68, v68, v84
  s_waitcnt lgkmcnt(2)
  v_mfma_f32_32x32x16_bf16 v[112:127], v[36:39], a[112:115], v[112:127]
  ds_read_b64_tr_b16 v[44:45], v149 offset:2048
  ds_read_b64_tr_b16 v[46:47], v149 offset:3072
  v_add_f32 v69, v69, v85
  v_add_f32 v70, v70, v86
  v_add_f32 v71, v71, v87
  v_add_f32 v72, v72, v88
  v_add_f32 v73, v73, v89
  s_waitcnt lgkmcnt(2)
  v_mfma_f32_32x32x16_bf16 v[96:111], v[40:43], a[116:119], v[96:111]
  ds_read_b64_tr_b16 v[32:33], v148 offset:8192
  ds_read_b64_tr_b16 v[34:35], v148 offset:9216
  v_add_f32 v74, v74, v90
  v_add_f32 v75, v75, v91
  v_add_f32 v76, v76, v92
  v_add_f32 v77, v77, v93
  v_add_f32 v78, v78, v94
  s_waitcnt lgkmcnt(2)
  v_mfma_f32_32x32x16_bf16 v[112:127], v[44:47], a[116:119], v[112:127]
  ds_read_b64_tr_b16 v[36:37], v149 offset:8192
  ds_read_b64_tr_b16 v[38:39], v149 offset:9216
  v_add_f32 v79, v79, v95
  s_waitcnt lgkmcnt(2)
  v_mfma_f32_32x32x16_bf16 v[96:111], v[32:35], a[120:123], v[96:111]
  ds_read_b64_tr_b16 v[40:41], v148 offset:10240
  ds_read_b64_tr_b16 v[42:43], v148 offset:11264
  s_waitcnt lgkmcnt(2)
  v_mfma_f32_32x32x16_bf16 v[112:127], v[36:39], a[120:123], v[112:127]
  ds_read_b64_tr_b16 v[44:45], v149 offset:10240
  ds_read_b64_tr_b16 v[46:47], v149 offset:11264
  s_waitcnt vmcnt(15) lgkmcnt(2)
  v_mfma_f32_32x32x16_bf16 v[96:111], v[40:43], a[124:127], v[96:111]
  s_waitcnt vmcnt(1) lgkmcnt(0)
  s_barrier
  ds_read_b64_tr_b16 v[32:33], v148 offset:16384
  v_mfma_f32_32x32x16_bf16 v[112:127], v[44:47], a[124:127], v[112:127]
  ds_read_b64_tr_b16 v[34:35], v148 offset:17408
  ds_read_b64_tr_b16 v[36:37], v149 offset:16384
  ds_read_b64_tr_b16 v[38:39], v149 offset:17408
  s_waitcnt lgkmcnt(2)
  v_mfma_f32_32x32x16_bf16 v[96:111], v[32:35], a[128:131], v[96:111]
  ds_read_b64_tr_b16 v[40:41], v148 offset:18432
  ds_read_b64_tr_b16 v[42:43], v148 offset:19456
  s_waitcnt lgkmcnt(2)
  v_mfma_f32_32x32x16_bf16 v[112:127], v[36:39], a[128:131], v[112:127]
  ds_read_b64_tr_b16 v[44:45], v149 offset:18432
  ds_read_b64_tr_b16 v[46:47], v149 offset:19456
  s_waitcnt lgkmcnt(2)
  v_mfma_f32_32x32x16_bf16 v[96:111], v[40:43], a[132:135], v[96:111]
  ds_read_b64_tr_b16 v[32:33], v148 offset:24576
  ds_read_b64_tr_b16 v[34:35], v148 offset:25600
  s_waitcnt lgkmcnt(2)
  v_mfma_f32_32x32x16_bf16 v[112:127], v[44:47], a[132:135], v[112:127]
  ds_read_b64_tr_b16 v[36:37], v149 offset:24576
  ds_read_b64_tr_b16 v[38:39], v149 offset:25600
  s_waitcnt lgkmcnt(2)
  v_mfma_f32_32x32x16_bf16 v[96:111], v[32:35], a[136:139], v[96:111]
  ds_read_b64_tr_b16 v[40:41], v148 offset:26624
  ds_read_b64_tr_b16 v[42:43], v148 offset:27648
  s_waitcnt lgkmcnt(2)
  v_mfma_f32_32x32x16_bf16 v[112:127], v[36:39], a[136:139], v[112:127]
  ds_read_b64_tr_b16 v[44:45], v149 offset:26624
  ds_read_b64_tr_b16 v[46:47], v149 offset:27648
  s_waitcnt lgkmcnt(2)
  v_mfma_f32_32x32x16_bf16 v[96:111], v[40:43], a[140:143], v[96:111]
  ds_read_b64_tr_b16 v[32:33], v27 offset:32768
  ds_read_b64_tr_b16 v[34:35], v27 offset:33792
  s_waitcnt lgkmcnt(2)
  v_mfma_f32_32x32x16_bf16 v[112:127], v[44:47], a[140:143], v[112:127]
  ds_read_b64_tr_b16 v[36:37], v28 offset:32768
  ds_read_b64_tr_b16 v[38:39], v28 offset:33792
  s_waitcnt lgkmcnt(2)
  v_mfma_f32_32x32x16_bf16 v[96:111], v[32:35], a[144:147], v[96:111]
  ds_read_b64_tr_b16 v[40:41], v27 offset:34816
  ds_read_b64_tr_b16 v[42:43], v27 offset:35840
  s_waitcnt lgkmcnt(2)
  v_mfma_f32_32x32x16_bf16 v[112:127], v[36:39], a[144:147], v[112:127]
  ds_read_b64_tr_b16 v[44:45], v28 offset:34816
  ds_read_b64_tr_b16 v[46:47], v28 offset:35840
  s_waitcnt lgkmcnt(2)
  v_mfma_f32_32x32x16_bf16 v[96:111], v[40:43], a[148:151], v[96:111]
  ds_read_b64_tr_b16 v[32:33], v27 offset:40960
  ds_read_b64_tr_b16 v[34:35], v27 offset:41984
  s_waitcnt lgkmcnt(2)
  v_mfma_f32_32x32x16_bf16 v[112:127], v[44:47], a[148:151], v[112:127]
  ds_read_b64_tr_b16 v[36:37], v28 offset:40960
  ds_read_b64_tr_b16 v[38:39], v28 offset:41984
  s_waitcnt lgkmcnt(2)
  v_mfma_f32_32x32x16_bf16 v[96:111], v[32:35], a[152:155], v[96:111]
  ds_read_b64_tr_b16 v[40:41], v27 offset:43008
  ds_read_b64_tr_b16 v[42:43], v27 offset:44032
  s_waitcnt lgkmcnt(2)
  v_mfma_f32_32x32x16_bf16 v[112:127], v[36:39], a[152:155], v[112:127]
  ds_read_b64_tr_b16 v[44:45], v28 offset:43008
  ds_read_b64_tr_b16 v[46:47], v28 offset:44032
  s_waitcnt vmcnt(0) lgkmcnt(2)
  v_mfma_f32_32x32x16_bf16 v[96:111], v[40:43], a[156:159], v[96:111]
  s_waitcnt lgkmcnt(0)
  v_mfma_f32_32x32x16_bf16 v[112:127], v[44:47], a[156:159], v[112:127]
  s_nop 11
  ds_write_b128 v146, v[112:115] offset:0
  ds_write_b128 v146, v[116:119] offset:1024
  ds_write_b128 v146, v[120:123] offset:2048
  ds_write_b128 v146, v[124:127] offset:3072
  s_cmp_lt_u32 s52, 2
  s_waitcnt lgkmcnt(0)
  s_barrier
  ds_read_b128 v[112:115], v147 offset:0
  ds_read_b128 v[116:119], v147 offset:1024
  ds_read_b128 v[120:123], v147 offset:2048
  ds_read_b128 v[124:127], v147 offset:3072
  s_cbranch_scc0 L_finB88
  s_waitcnt lgkmcnt(3)
  v_add_f32 v64, v64, v112
  v_add_f32 v65, v65, v113
  v_add_f32 v66, v66, v114
  v_add_f32 v67, v67, v115
  s_waitcnt lgkmcnt(2)
  v_add_f32 v68, v68, v116
  v_add_f32 v69, v69, v117
  v_add_f32 v70, v70, v118
  v_add_f32 v71, v71, v119
  s_waitcnt lgkmcnt(1)
  v_add_f32 v72, v72, v120
  v_add_f32 v73, v73, v121
  v_add_f32 v74, v74, v122
  v_add_f32 v75, v75, v123
  s_waitcnt lgkmcnt(0)
  v_add_f32 v76, v76, v124
  v_add_f32 v77, v77, v125
  v_add_f32 v78, v78, v126
  v_add_f32 v79, v79, v127
  v_mul_f32 v80, 0xbfb8aa3b, v64
  v_mul_f32 v81, 0xbfb8aa3b, v65
  v_mul_f32 v82, 0xbfb8aa3b, v66
  v_mul_f32 v83, 0xbfb8aa3b, v67
  v_mul_f32 v84, 0xbfb8aa3b, v68
  v_mul_f32 v85, 0xbfb8aa3b, v69
  v_mul_f32 v86, 0xbfb8aa3b, v70
  v_mul_f32 v87, 0xbfb8aa3b, v71
  v_mul_f32 v88, 0xbfb8aa3b, v72
  v_mul_f32 v89, 0xbfb8aa3b, v73
  v_mul_f32 v90, 0xbfb8aa3b, v74
  v_mul_f32 v91, 0xbfb8aa3b, v75
  v_mul_f32 v92, 0xbfb8aa3b, v76
  v_mul_f32 v93, 0xbfb8aa3b, v77
  v_mul_f32 v94, 0xbfb8aa3b, v78
  v_mul_f32 v95, 0xbfb8aa3b, v79
  v_exp_f32 v80, v80
  v_exp_f32 v81, v81
  v_exp_f32 v82, v82
  v_exp_f32 v83, v83
  v_exp_f32 v84, v84
  v_exp_f32 v85, v85
  v_exp_f32 v86, v86
  v_exp_f32 v87, v87
  v_exp_f32 v88, v88
  v_exp_f32 v89, v89
  v_exp_f32 v90, v90
  v_exp_f32 v91, v91
  v_exp_f32 v92, v92
  v_exp_f32 v93, v93
  v_exp_f32 v94, v94
  v_exp_f32 v95, v95
  v_mul_f32 v64, v64, v96
  v_mul_f32 v65, v65, v97
  v_mul_f32 v66, v66, v98
  v_mul_f32 v67, v67, v99
  v_mul_f32 v68, v68, v100
  v_mul_f32 v69, v69, v101
  v_mul_f32 v70, v70, v102
  v_mul_f32 v71, v71, v103
  v_mul_f32 v72, v72, v104
  v_mul_f32 v73, v73, v105
  v_mul_f32 v74, v74, v106
  v_mul_f32 v75, v75, v107
  v_mul_f32 v76, v76, v108
  v_mul_f32 v77, v77, v109
  v_mul_f32 v78, v78, v110
  v_mul_f32 v79, v79, v111
  v_add_f32 v80, 1.0, v80
  v_add_f32 v81, 1.0, v81
  v_add_f32 v82, 1.0, v82
  v_add_f32 v83, 1.0, v83
  v_add_f32 v84, 1.0, v84
  v_add_f32 v85, 1.0, v85
  v_add_f32 v86, 1.0, v86
  v_add_f32 v87, 1.0, v87
  v_add_f32 v88, 1.0, v88
  v_add_f32 v89, 1.0, v89
  v_add_f32 v90, 1.0, v90
  v_add_f32 v91, 1.0, v91
  v_add_f32 v92, 1.0, v92
  v_add_f32 v93, 1.0, v93
  v_add_f32 v94, 1.0, v94
  v_add_f32 v95, 1.0, v95
  v_rcp_f32 v80, v80
  v_rcp_f32 v81, v81
  v_rcp_f32 v82, v82
  v_rcp_f32 v83, v83
  v_rcp_f32 v84, v84
  v_rcp_f32 v85, v85
  v_rcp_f32 v86, v86
  v_rcp_f32 v87, v87
  v_fma_f32 v64, v64, v80, v48
  v_fma_f32 v65, v65, v81, v49
  v_fma_f32 v66, v66, v82, v50
  v_fma_f32 v67, v67, v83, v51
  v_fma_f32 v68, v68, v84, v52
  v_fma_f32 v69, v69, v85, v53
  v_fma_f32 v70, v70, v86, v54
  v_fma_f32 v71, v71, v87, v55
  v_cvt_pk_bf16_f32 v112, v64, v65
  v_cvt_pk_bf16_f32 v113, v66, v67
  v_cvt_pk_bf16_f32 v114, v68, v69
  v_cvt_pk_bf16_f32 v115, v70, v71
  s_nop 0
  v_permlane32_swap_b32 v112, v114
  v_permlane32_swap_b32 v113, v115
  buffer_store_dwordx4 v[112:115], v144, s[48:51], 0 offen offset:0
  v_rcp_f32 v88, v88
  v_rcp_f32 v89, v89
  v_rcp_f32 v90, v90
  v_rcp_f32 v91, v91
  v_rcp_f32 v92, v92
  v_rcp_f32 v93, v93
  v_rcp_f32 v94, v94
  v_rcp_f32 v95, v95
  v_fma_f32 v72, v72, v88, v136
  v_fma_f32 v73, v73, v89, v137
  v_fma_f32 v74, v74, v90, v138
  v_fma_f32 v75, v75, v91, v139
  v_fma_f32 v76, v76, v92, v140
  v_fma_f32 v77, v77, v93, v141
  v_fma_f32 v78, v78, v94, v142
  v_fma_f32 v79, v79, v95, v143
  v_cvt_pk_bf16_f32 v116, v72, v73
  v_cvt_pk_bf16_f32 v117, v74, v75
  v_cvt_pk_bf16_f32 v118, v76, v77
  v_cvt_pk_bf16_f32 v119, v78, v79
  s_nop 0
  v_permlane32_swap_b32 v116, v118
  v_permlane32_swap_b32 v117, v119
  buffer_store_dwordx4 v[116:119], v144, s[48:51], 0 offen offset:32
  s_cmp_eq_u32 s2, 0
  s_cbranch_scc0 L_fin89
  v_cmp_eq_u32 vcc, 0, v0
  v_mov_b32 v1, 1073741824
  s_nop 0
  v_cndmask_b32 v1, v1, 0, vcc
  buffer_store_dword v13, v1, s[36:39], 0 offen sc1
L_fin89:
  s_endpgm
L_finB88:
  v_add_f32 v64, v64, v96
  v_add_f32 v65, v65, v97
  v_add_f32 v66, v66, v98
  v_add_f32 v67, v67, v99
  v_add_f32 v68, v68, v100
  v_add_f32 v69, v69, v101
  v_add_f32 v70, v70, v102
  v_add_f32 v71, v71, v103
  v_add_f32 v72, v72, v104
  v_add_f32 v73, v73, v105
  v_add_f32 v74, v74, v106
  v_add_f32 v75, v75, v107
  v_add_f32 v76, v76, v108
  v_add_f32 v77, v77, v109
  v_add_f32 v78, v78, v110
  v_add_f32 v79, v79, v111
  v_mul_f32 v80, 0xbfb8aa3b, v64
  v_mul_f32 v81, 0xbfb8aa3b, v65
  v_mul_f32 v82, 0xbfb8aa3b, v66
  v_mul_f32 v83, 0xbfb8aa3b, v67
  v_mul_f32 v84, 0xbfb8aa3b, v68
  v_mul_f32 v85, 0xbfb8aa3b, v69
  v_mul_f32 v86, 0xbfb8aa3b, v70
  v_mul_f32 v87, 0xbfb8aa3b, v71
  v_mul_f32 v88, 0xbfb8aa3b, v72
  v_mul_f32 v89, 0xbfb8aa3b, v73
  v_mul_f32 v90, 0xbfb8aa3b, v74
  v_mul_f32 v91, 0xbfb8aa3b, v75
  v_mul_f32 v92, 0xbfb8aa3b, v76
  v_mul_f32 v93, 0xbfb8aa3b, v77
  v_mul_f32 v94, 0xbfb8aa3b, v78
  v_mul_f32 v95, 0xbfb8aa3b, v79
  v_exp_f32 v80, v80
  v_exp_f32 v81, v81
  v_exp_f32 v82, v82
  v_exp_f32 v83, v83
  v_exp_f32 v84, v84
  v_exp_f32 v85, v85
  v_exp_f32 v86, v86
  v_exp_f32 v87, v87
  v_exp_f32 v88, v88
  v_exp_f32 v89, v89
  v_exp_f32 v90, v90
  v_exp_f32 v91, v91
  v_exp_f32 v92, v92
  v_exp_f32 v93, v93
  v_exp_f32 v94, v94
  v_exp_f32 v95, v95
  s_waitcnt lgkmcnt(3)
  v_mul_f32 v64, v64, v112
  v_mul_f32 v65, v65, v113
  v_mul_f32 v66, v66, v114
  v_mul_f32 v67, v67, v115
  s_waitcnt lgkmcnt(2)
  v_mul_f32 v68, v68, v116
  v_mul_f32 v69, v69, v117
  v_mul_f32 v70, v70, v118
  v_mul_f32 v71, v71, v119
  s_waitcnt lgkmcnt(1)
  v_mul_f32 v72, v72, v120
  v_mul_f32 v73, v73, v121
  v_mul_f32 v74, v74, v122
  v_mul_f32 v75, v75, v123
  s_waitcnt lgkmcnt(0)
  v_mul_f32 v76, v76, v124
  v_mul_f32 v77, v77, v125
  v_mul_f32 v78, v78, v126
  v_mul_f32 v79, v79, v127
  v_add_f32 v80, 1.0, v80
  v_add_f32 v81, 1.0, v81
  v_add_f32 v82, 1.0, v82
  v_add_f32 v83, 1.0, v83
  v_add_f32 v84, 1.0, v84
  v_add_f32 v85, 1.0, v85
  v_add_f32 v86, 1.0, v86
  v_add_f32 v87, 1.0, v87
  v_add_f32 v88, 1.0, v88
  v_add_f32 v89, 1.0, v89
  v_add_f32 v90, 1.0, v90
  v_add_f32 v91, 1.0, v91
  v_add_f32 v92, 1.0, v92
  v_add_f32 v93, 1.0, v93
  v_add_f32 v94, 1.0, v94
  v_add_f32 v95, 1.0, v95
  v_rcp_f32 v80, v80
  v_rcp_f32 v81, v81
  v_rcp_f32 v82, v82
  v_rcp_f32 v83, v83
  v_rcp_f32 v84, v84
  v_rcp_f32 v85, v85
  v_rcp_f32 v86, v86
  v_rcp_f32 v87, v87
  v_fma_f32 v64, v64, v80, v48
  v_fma_f32 v65, v65, v81, v49
  v_fma_f32 v66, v66, v82, v50
  v_fma_f32 v67, v67, v83, v51
  v_fma_f32 v68, v68, v84, v52
  v_fma_f32 v69, v69, v85, v53
  v_fma_f32 v70, v70, v86, v54
  v_fma_f32 v71, v71, v87, v55
  v_cvt_pk_bf16_f32 v96, v64, v65
  v_cvt_pk_bf16_f32 v97, v66, v67
  v_cvt_pk_bf16_f32 v98, v68, v69
  v_cvt_pk_bf16_f32 v99, v70, v71
  s_nop 0
  v_permlane32_swap_b32 v96, v98
  v_permlane32_swap_b32 v97, v99
  buffer_store_dwordx4 v[96:99], v144, s[48:51], 0 offen offset:0
  v_rcp_f32 v88, v88
  v_rcp_f32 v89, v89
  v_rcp_f32 v90, v90
  v_rcp_f32 v91, v91
  v_rcp_f32 v92, v92
  v_rcp_f32 v93, v93
  v_rcp_f32 v94, v94
  v_rcp_f32 v95, v95
  v_fma_f32 v72, v72, v88, v136
  v_fma_f32 v73, v73, v89, v137
  v_fma_f32 v74, v74, v90, v138
  v_fma_f32 v75, v75, v91, v139
  v_fma_f32 v76, v76, v92, v140
  v_fma_f32 v77, v77, v93, v141
  v_fma_f32 v78, v78, v94, v142
  v_fma_f32 v79, v79, v95, v143
  v_cvt_pk_bf16_f32 v100, v72, v73
  v_cvt_pk_bf16_f32 v101, v74, v75
  v_cvt_pk_bf16_f32 v102, v76, v77
  v_cvt_pk_bf16_f32 v103, v78, v79
  s_nop 0
  v_permlane32_swap_b32 v100, v102
  v_permlane32_swap_b32 v101, v103
  buffer_store_dwordx4 v[100:103], v144, s[48:51], 0 offen offset:32
  s_cmp_eq_u32 s2, 0
  s_cbranch_scc0 L_fin90
  v_cmp_eq_u32 vcc, 0, v0
  v_mov_b32 v1, 1073741824
  s_nop 0
  v_cndmask_b32 v1, v1, 0, vcc
  buffer_store_dword v13, v1, s[36:39], 0 offen sc1
L_fin90:
  s_endpgm
L_slow2:
  s_mov_b32 s83, 0x40000
L_spin2:
  buffer_load_dword v91, v90, s[36:39], 0 offen sc1
  s_waitcnt vmcnt(0)
  v_cmp_ne_u32 vcc, s56, v91
  s_cbranch_vccz L_back2
  s_sub_u32 s83, s83, 1
  s_cmp_lg_u32 s83, 0
  s_cbranch_scc1 L_spin2
  s_branch L_back2
L_slow3:
  s_mov_b32 s83, 0x40000
L_spin3:
  buffer_load_dword v42, v63, s[36:39], 0 offen sc1
  s_waitcnt vmcnt(0)
  v_cmp_ne_u32 vcc, s56, v42
  s_cbranch_vccz L_back3
  s_sub_u32 s83, s83, 1
  s_cmp_lg_u32 s83, 0
  s_cbranch_scc1 L_spin3
  s_branch L_back3
L_slow4:
  s_mov_b32 s83, 0x40000
L_spin4:
  buffer_load_dword v62, v61, s[36:39], s82 offen sc1
  s_waitcnt vmcnt(0)
  v_cmp_ne_u32 vcc, s56, v62
  s_cbranch_vccz L_back4
  s_sub_u32 s83, s83, 1
  s_cmp_lg_u32 s83, 0
  s_cbranch_scc1 L_spin4
  s_branch L_back4
L_slow5:
  s_mov_b32 s83, 0x40000
L_spin5:
  buffer_load_dword v62, v61, s[36:39], s82 offen sc1
  s_waitcnt vmcnt(0)
  v_cmp_ne_u32 vcc, s56, v62
  s_cbranch_vccz L_back5
  s_sub_u32 s83, s83, 1
  s_cmp_lg_u32 s83, 0
  s_cbranch_scc1 L_spin5
  s_branch L_back5
L_slow6:
  s_mov_b32 s83, 0x40000
L_spin6:
  buffer_load_dword v62, v61, s[36:39], s82 offen sc1
  s_waitcnt vmcnt(0)
  v_cmp_ne_u32 vcc, s56, v62
  s_cbranch_vccz L_back6
  s_sub_u32 s83, s83, 1
  s_cmp_lg_u32 s83, 0
  s_cbranch_scc1 L_spin6
  s_branch L_back6
L_slow7:
  s_mov_b32 s83, 0x40000
L_spin7:
  buffer_load_dword v62, v61, s[36:39], s82 offen sc1
  s_waitcnt vmcnt(0)
  v_cmp_ne_u32 vcc, s56, v62
  s_cbranch_vccz L_back7
  s_sub_u32 s83, s83, 1
  s_cmp_lg_u32 s83, 0
  s_cbranch_scc1 L_spin7
  s_branch L_back7
L_slow8:
  s_mov_b32 s83, 0x40000
L_spin8:
  buffer_load_dword v62, v61, s[36:39], s82 offen sc1
  s_waitcnt vmcnt(0)
  v_cmp_ne_u32 vcc, s56, v62
  s_cbranch_vccz L_back8
  s_sub_u32 s83, s83, 1
  s_cmp_lg_u32 s83, 0
  s_cbranch_scc1 L_spin8
  s_branch L_back8
L_slow13:
  s_mov_b32 s83, 0x40000
L_spin13:
  buffer_load_dword v193, v192, s[36:39], 0 offen sc1
  s_waitcnt vmcnt(0)
  v_cmp_ne_u32 vcc, s56, v193
  s_cbranch_vccz L_back13
  s_sub_u32 s83, s83, 1
  s_cmp_lg_u32 s83, 0
  s_cbranch_scc1 L_spin13
  s_branch L_back13
L_slow14:
  s_mov_b32 s83, 0x40000
L_spin14:
  buffer_load_dword v215, v214, s[36:39], 0 offen sc1
  s_waitcnt vmcnt(0)
  v_subrev_u32 v215, s56, v215
  v_cmp_lt_u32 vcc, 1, v215
  s_cbranch_vccz L_back14
  s_sub_u32 s83, s83, 1
  s_cmp_lg_u32 s83, 0
  s_cbranch_scc1 L_spin14
  s_branch L_back14
L_zero_halo15:
  v_mov_b32 v48, 0
  v_mov_b32 v49, 0
  v_mov_b32 v50, 0
  v_mov_b32 v51, 0
  s_add_u32 s58, s99, 32768
  v_lshl_add_u32 v52, v2, 4, s58
  s_add_u32 s58, s68, 65536
  v_lshl_add_u32 v53, v2, 4, s58
  ds_write_b128 v52, v[48:51] offset:0
  ds_write_b128 v53, v[48:51] offset:0
  ds_write_b128 v52, v[48:51] offset:1024
  ds_write_b128 v53, v[48:51] offset:1040
  ds_write_b128 v52, v[48:51] offset:2048
  ds_write_b128 v53, v[48:51] offset:2080
  ds_write_b128 v52, v[48:51] offset:3072
  ds_write_b128 v53, v[48:51] offset:3120
  s_waitcnt vmcnt(0) lgkmcnt(0)
  s_branch L_halo_done15
L_slow16:
  s_mov_b32 s83, 0x40000
L_spin16:
  buffer_load_dword v25, v23, s[36:39], s82 offen sc1
  s_waitcnt vmcnt(0)
  v_cmp_ne_u32 vcc, s56, v25
  s_cbranch_vccz L_back16
  s_sub_u32 s83, s83, 1
  s_cmp_lg_u32 s83, 0
  s_cbranch_scc1 L_spin16
  s_branch L_back16
L_slow17:
  s_mov_b32 s83, 0x40000
L_spin17:
  buffer_load_dword v215, v214, s[36:39], 0 offen sc1
  s_waitcnt vmcnt(0)
  v_subrev_u32 v215, s56, v215
  v_cmp_lt_u32 vcc, 1, v215
  s_cbranch_vccz L_back17
  s_sub_u32 s83, s83, 1
  s_cmp_lg_u32 s83, 0
  s_cbranch_scc1 L_spin17
  s_branch L_back17
L_zero_halo18:
  v_mov_b32 v48, 0
  v_mov_b32 v49, 0
  v_mov_b32 v50, 0
  v_mov_b32 v51, 0
  s_add_u32 s58, s99, 32768
  v_lshl_add_u32 v52, v2, 4, s58
  s_add_u32 s58, s68, 65536
  v_lshl_add_u32 v53, v2, 4, s58
  ds_write_b128 v52, v[48:51] offset:0
  ds_write_b128 v53, v[48:51] offset:0
  ds_write_b128 v52, v[48:51] offset:1024
  ds_write_b128 v53, v[48:51] offset:1040
  ds_write_b128 v52, v[48:51] offset:2048
  ds_write_b128 v53, v[48:51] offset:2080
  ds_write_b128 v52, v[48:51] offset:3072
  ds_write_b128 v53, v[48:51] offset:3120
  s_waitcnt vmcnt(0) lgkmcnt(0)
  s_branch L_halo_done18
L_slow83:
  s_mov_b32 s83, 0x40000
L_spin83:
  buffer_load_dword v25, v23, s[36:39], s82 offen sc1
  s_waitcnt vmcnt(0)
  v_cmp_ne_u32 vcc, s56, v25
  s_cbranch_vccz L_back83
  s_sub_u32 s83, s83, 1
  s_cmp_lg_u32 s83, 0
  s_cbranch_scc1 L_spin83
  s_branch L_back83
L_exactA:
  s_nop 15
  s_waitcnt vmcnt(0)
  s_barrier
  s_add_u32 s71, s56, s98
  v_mov_b32 v48, s71
  s_mov_b32 s71, 7168
  buffer_store_dword v48, v14, s[36:39], s71 offen sc1
  buffer_load_dword v215, v214, s[36:39], 0 offen sc1
  s_waitcnt vmcnt(0)
  v_subrev_u32 v215, s56, v215
  v_cmp_lt_u32 vcc, 1, v215
  s_nop 0
  s_cbranch_vccnz L_slow17
L_back17:
  s_cmp_eq_u32 s53, 0
  s_cbranch_scc1 L_zero_halo18
  s_add_u32 m0, s99, 32768
  s_nop 0
  buffer_load_dwordx4 v216, s[36:39], 0 offen offset:0 sc1 lds
  buffer_load_dwordx4 v216, s[36:39], 0 offen offset:1024 sc1 lds
  buffer_load_dwordx4 v216, s[36:39], 0 offen offset:2048 sc1 lds
  buffer_load_dwordx4 v216, s[36:39], 0 offen offset:3072 sc1 lds
  s_add_u32 m0, s68, 65536
  s_nop 0
  buffer_load_dwordx4 v217, s[36:39], 0 offen offset:0 sc1 lds
  s_add_u32 m0, s68, 65552
  s_nop 0
  buffer_load_dwordx4 v217, s[36:39], 0 offen offset:1024 sc1 lds
  s_add_u32 m0, s68, 65568
  s_nop 0
  buffer_load_dwordx4 v217, s[36:39], 0 offen offset:2048 sc1 lds
  s_add_u32 m0, s68, 65584
  s_nop 0
  buffer_load_dwordx4 v217, s[36:39], 0 offen offset:3072 sc1 lds
L_halo_done18:
  s_waitcnt vmcnt(0) lgkmcnt(0)
  s_barrier
L_exactB:
  s_nop 15
  s_waitcnt vmcnt(0) lgkmcnt(0)
  ds_read_b128 a[0:3], v202 offset:0
  ds_read_b128 a[4:7], v202 offset:1024
  ds_read_b128 a[8:11], v202 offset:2048
  ds_read_b128 a[12:15], v202 offset:3072
  ds_read_b128 a[16:19], v202 offset:4096
  ds_read_b128 a[20:23], v202 offset:5120
  ds_read_b128 a[24:27], v202 offset:6144
  ds_read_b128 a[28:31], v202 offset:7168
  ds_read_b128 a[32:35], v202 offset:8192
  s_waitcnt lgkmcnt(8)
  v_mfma_f32_32x32x16_bf16 v[64:79], a[0:3], v[32:35], v[240:255]
  s_waitcnt lgkmcnt(7)
  v_mfma_f32_32x32x16_bf16 v[80:95], a[4:7], v[32:35], 0
  v_mov_b32 v48, 0xf149f2ca
  s_add_u32 s58, s52, 0
  s_lshr_b32 s58, s58, 3
  s_or_b32 s58, s58, s53
  s_cbranch_scc0 L_mx19
  s_nop 4
  v_max3_f32 v48, v48, v64, v65
  v_max3_f32 v48, v48, v66, v67
  v_max3_f32 v48, v48, v68, v69
  v_max3_f32 v48, v48, v70, v71
  v_max3_f32 v48, v48, v72, v73
  v_max3_f32 v48, v48, v74, v75
  v_max3_f32 v48, v48, v76, v77
  v_max3_f32 v48, v48, v78, v79
L_mx19:
  s_waitcnt lgkmcnt(6)
  v_mfma_f32_32x32x16_bf16 v[64:79], a[8:11], v[32:35], 0
  s_add_u32 s58, s52, 1
  s_lshr_b32 s58, s58, 3
  s_or_b32 s58, s58, s53
  s_cbranch_scc0 L_mx20
  v_max3_f32 v48, v48, v80, v81
  v_max3_f32 v48, v48, v82, v83
  v_max3_f32 v48, v48, v84, v85
  v_max3_f32 v48, v48, v86, v87
  v_max3_f32 v48, v48, v88, v89
  v_max3_f32 v48, v48, v90, v91
  v_max3_f32 v48, v48, v92, v93
  v_max3_f32 v48, v48, v94, v95
L_mx20:
  s_waitcnt lgkmcnt(5)
  v_mfma_f32_32x32x16_bf16 v[80:95], a[12:15], v[32:35], 0
  s_add_u32 s58, s52, 2
  s_lshr_b32 s58, s58, 3
  s_or_b32 s58, s58, s53
  s_cbranch_scc0 L_mx21
  v_max3_f32 v48, v48, v64, v65
  v_max3_f32 v48, v48, v66, v67
  v_max3_f32 v48, v48, v68, v69
  v_max3_f32 v48, v48, v70, v71
  v_max3_f32 v48, v48, v72, v73
  v_max3_f32 v48, v48, v74, v75
  v_max3_f32 v48, v48, v76, v77
  v_max3_f32 v48, v48, v78, v79
L_mx21:
  s_waitcnt lgkmcnt(4)
  v_mfma_f32_32x32x16_bf16 v[64:79], a[16:19], v[32:35], 0
  s_add_u32 s58, s52, 3
  s_lshr_b32 s58, s58, 3
  s_or_b32 s58, s58, s53
  s_cbranch_scc0 L_mx22
  v_max3_f32 v48, v48, v80, v81
  v_max3_f32 v48, v48, v82, v83
  v_max3_f32 v48, v48, v84, v85
  v_max3_f32 v48, v48, v86, v87
  v_max3_f32 v48, v48, v88, v89
  v_max3_f32 v48, v48, v90, v91
  v_max3_f32 v48, v48, v92, v93
  v_max3_f32 v48, v48, v94, v95
L_mx22:
  s_waitcnt lgkmcnt(3)
  v_mfma_f32_32x32x16_bf16 v[80:95], a[20:23], v[32:35], 0
  s_add_u32 s58, s52, 4
  s_lshr_b32 s58, s58, 3
  s_or_b32 s58, s58, s53
  s_cbranch_scc0 L_mx23
  v_max3_f32 v48, v48, v64, v65
  v_max3_f32 v48, v48, v66, v67
  v_max3_f32 v48, v48, v68, v69
  v_max3_f32 v48, v48, v70, v71
  v_max3_f32 v48, v48, v72, v73
  v_max3_f32 v48, v48, v74, v75
  v_max3_f32 v48, v48, v76, v77
  v_max3_f32 v48, v48, v78, v79
L_mx23:
  s_waitcnt lgkmcnt(2)
  v_mfma_f32_32x32x16_bf16 v[64:79], a[24:27], v[32:35], 0
  s_add_u32 s58, s52, 5
  s_lshr_b32 s58, s58, 3
  s_or_b32 s58, s58, s53
  s_cbranch_scc0 L_mx24
  v_max3_f32 v48, v48, v80, v81
  v_max3_f32 v48, v48, v82, v83
  v_max3_f32 v48, v48, v84, v85
  v_max3_f32 v48, v48, v86, v87
  v_max3_f32 v48, v48, v88, v89
  v_max3_f32 v48, v48, v90, v91
  v_max3_f32 v48, v48, v92, v93
  v_max3_f32 v48, v48, v94, v95
L_mx24:
  s_waitcnt lgkmcnt(1)
  v_mfma_f32_32x32x16_bf16 v[80:95], a[28:31], v[32:35], 0
  s_add_u32 s58, s52, 6
  s_lshr_b32 s58, s58, 3
  s_or_b32 s58, s58, s53
  s_cbranch_scc0 L_mx25
  v_max3_f32 v48, v48, v64, v65
  v_max3_f32 v48, v48, v66, v67
  v_max3_f32 v48, v48, v68, v69
  v_max3_f32 v48, v48, v70, v71
  v_max3_f32 v48, v48, v72, v73
  v_max3_f32 v48, v48, v74, v75
  v_max3_f32 v48, v48, v76, v77
  v_max3_f32 v48, v48, v78, v79
L_mx25:
  s_waitcnt lgkmcnt(0)
  v_mfma_f32_32x32x16_bf16 v[64:79], a[32:35], v[32:35], v[224:239]
  s_add_u32 s58, s52, 7
  s_lshr_b32 s58, s58, 3
  s_or_b32 s58, s58, s53
  s_cbranch_scc0 L_mx26
  v_max3_f32 v48, v48, v80, v81
  v_max3_f32 v48, v48, v82, v83
  v_max3_f32 v48, v48, v84, v85
  v_max3_f32 v48, v48, v86, v87
  v_max3_f32 v48, v48, v88, v89
  v_max3_f32 v48, v48, v90, v91
  v_max3_f32 v48, v48, v92, v93
  v_max3_f32 v48, v48, v94, v95
L_mx26:
  v_max3_f32 v48, v48, v64, v65
  v_max3_f32 v48, v48, v66, v67
  v_max3_f32 v48, v48, v68, v69
  v_max3_f32 v48, v48, v70, v71
  v_max3_f32 v48, v48, v72, v73
  v_max3_f32 v48, v48, v74, v75
  v_max3_f32 v48, v48, v76, v77
  v_max3_f32 v48, v48, v78, v79
  v_mov_b32 v49, v48
  s_nop 1
  v_permlane32_swap_b32 v48, v49
  v_max_f32 v48, v48, v49
  v_sub_f32 v160, 0, v48
  v_sub_f32 v161, 0, v48
  v_sub_f32 v162, 0, v48
  v_sub_f32 v163, 0, v48
  v_sub_f32 v164, 0, v48
  v_sub_f32 v165, 0, v48
  v_sub_f32 v166, 0, v48
  v_sub_f32 v167, 0, v48
  v_sub_f32 v168, 0, v48
  v_sub_f32 v169, 0, v48
  v_sub_f32 v170, 0, v48
  v_sub_f32 v171, 0, v48
  v_sub_f32 v172, 0, v48
  v_sub_f32 v173, 0, v48
  v_sub_f32 v174, 0, v48
  v_sub_f32 v175, 0, v48
  ds_read_b128 a[40:43], v210 offset:16640
  ds_read_b128 a[44:47], v210 offset:17680
  v_sub_f32 v176, v224, v48
  v_sub_f32 v177, v225, v48
  v_sub_f32 v178, v226, v48
  v_sub_f32 v179, v227, v48
  v_sub_f32 v180, v228, v48
  v_sub_f32 v181, v229, v48
  v_sub_f32 v182, v230, v48
  v_sub_f32 v183, v231, v48
  v_sub_f32 v184, v232, v48
  v_sub_f32 v185, v233, v48
  v_sub_f32 v186, v234, v48
  v_sub_f32 v187, v235, v48
  v_sub_f32 v188, v236, v48
  v_sub_f32 v189, v237, v48
  v_sub_f32 v190, v238, v48
  v_sub_f32 v191, v239, v48
  s_nop 1
  v_mfma_f32_32x32x16_bf16 v[64:79], a[32:35], v[32:35], v[176:191]
  s_nop 11
  v_exp_f32 v64, v64
  v_exp_f32 v65, v65
  v_exp_f32 v66, v66
  v_exp_f32 v67, v67
  v_exp_f32 v68, v68
  v_exp_f32 v69, v69
  v_exp_f32 v70, v70
  v_exp_f32 v71, v71
  v_exp_f32 v72, v72
  v_exp_f32 v73, v73
  v_exp_f32 v74, v74
  v_exp_f32 v75, v75
  v_exp_f32 v76, v76
  v_exp_f32 v77, v77
  v_exp_f32 v78, v78
  v_exp_f32 v79, v79
  v_cvt_pk_bf16_f32 v64, v64, v65
  v_cvt_pk_bf16_f32 v65, v66, v67
  v_cvt_pk_bf16_f32 v66, v68, v69
  v_cvt_pk_bf16_f32 v67, v70, v71
  v_cvt_pk_bf16_f32 v68, v72, v73
  v_cvt_pk_bf16_f32 v69, v74, v75
  v_cvt_pk_bf16_f32 v70, v76, v77
  v_cvt_pk_bf16_f32 v71, v78, v79
  s_waitcnt lgkmcnt(1)
  v_mfma_f32_32x32x16_bf16 v[96:111], a[40:43], v[64:67], 0
  s_waitcnt lgkmcnt(0)
  v_mfma_f32_32x32x16_bf16 v[96:111], a[44:47], v[68:71], v[96:111]
  s_add_u32 s58, s52, 7
  s_lshr_b32 s58, s58, 3
  s_or_b32 s58, s58, s53
  s_cbranch_scc0 L_mx27
  ds_read_b128 a[48:51], v210 offset:14560
  ds_read_b128 a[52:55], v210 offset:15600
  v_mfma_f32_32x32x16_bf16 v[80:95], a[28:31], v[32:35], v[160:175]
  s_nop 11
  v_exp_f32 v80, v80
  v_exp_f32 v81, v81
  v_exp_f32 v82, v82
  v_exp_f32 v83, v83
  v_exp_f32 v84, v84
  v_exp_f32 v85, v85
  v_exp_f32 v86, v86
  v_exp_f32 v87, v87
  v_exp_f32 v88, v88
  v_exp_f32 v89, v89
  v_exp_f32 v90, v90
  v_exp_f32 v91, v91
  v_exp_f32 v92, v92
  v_exp_f32 v93, v93
  v_exp_f32 v94, v94
  v_exp_f32 v95, v95
  v_cvt_pk_bf16_f32 v80, v80, v81
  v_cvt_pk_bf16_f32 v81, v82, v83
  v_cvt_pk_bf16_f32 v82, v84, v85
  v_cvt_pk_bf16_f32 v83, v86, v87
  v_cvt_pk_bf16_f32 v84, v88, v89
  v_cvt_pk_bf16_f32 v85, v90, v91
  v_cvt_pk_bf16_f32 v86, v92, v93
  v_cvt_pk_bf16_f32 v87, v94, v95
  s_waitcnt lgkmcnt(1)
  v_mfma_f32_32x32x16_bf16 v[96:111], a[48:51], v[80:83], v[96:111]
  s_waitcnt lgkmcnt(0)
  v_mfma_f32_32x32x16_bf16 v[96:111], a[52:55], v[84:87], v[96:111]
L_mx27:
  s_nop 15
  s_add_u32 s58, s52, 6
  s_lshr_b32 s58, s58, 3
  s_or_b32 s58, s58, s53
  s_cbranch_scc0 L_mx28
  ds_read_b128 a[40:43], v210 offset:12480
  ds_read_b128 a[44:47], v210 offset:13520
  v_mfma_f32_32x32x16_bf16 v[64:79], a[24:27], v[32:35], v[160:175]
  s_nop 11
  v_exp_f32 v64, v64
  v_exp_f32 v65, v65
  v_exp_f32 v66, v66
  v_exp_f32 v67, v67
  v_exp_f32 v68, v68
  v_exp_f32 v69, v69
  v_exp_f32 v70, v70
  v_exp_f32 v71, v71
  v_exp_f32 v72, v72
  v_exp_f32 v73, v73
  v_exp_f32 v74, v74
  v_exp_f32 v75, v75
  v_exp_f32 v76, v76
  v_exp_f32 v77, v77
  v_exp_f32 v78, v78
  v_exp_f32 v79, v79
  v_cvt_pk_bf16_f32 v64, v64, v65
  v_cvt_pk_bf16_f32 v65, v66, v67
  v_cvt_pk_bf16_f32 v66, v68, v69
  v_cvt_pk_bf16_f32 v67, v70, v71
  v_cvt_pk_bf16_f32 v68, v72, v73
  v_cvt_pk_bf16_f32 v69, v74, v75
  v_cvt_pk_bf16_f32 v70, v76, v77
  v_cvt_pk_bf16_f32 v71, v78, v79
  s_waitcnt lgkmcnt(1)
  v_mfma_f32_32x32x16_bf16 v[96:111], a[40:43], v[64:67], v[96:111]
  s_waitcnt lgkmcnt(0)
  v_mfma_f32_32x32x16_bf16 v[96:111], a[44:47], v[68:71], v[96:111]
L_mx28:
  s_nop 15
  s_add_u32 s58, s52, 5
  s_lshr_b32 s58, s58, 3
  s_or_b32 s58, s58, s53
  s_cbranch_scc0 L_mx29
  ds_read_b128 a[48:51], v210 offset:10400
  ds_read_b128 a[52:55], v210 offset:11440
  v_mfma_f32_32x32x16_bf16 v[80:95], a[20:23], v[32:35], v[160:175]
  s_nop 11
  v_exp_f32 v80, v80
  v_exp_f32 v81, v81
  v_exp_f32 v82, v82
  v_exp_f32 v83, v83
  v_exp_f32 v84, v84
  v_exp_f32 v85, v85
  v_exp_f32 v86, v86
  v_exp_f32 v87, v87
  v_exp_f32 v88, v88
  v_exp_f32 v89, v89
  v_exp_f32 v90, v90
  v_exp_f32 v91, v91
  v_exp_f32 v92, v92
  v_exp_f32 v93, v93
  v_exp_f32 v94, v94
  v_exp_f32 v95, v95
  v_cvt_pk_bf16_f32 v80, v80, v81
  v_cvt_pk_bf16_f32 v81, v82, v83
  v_cvt_pk_bf16_f32 v82, v84, v85
  v_cvt_pk_bf16_f32 v83, v86, v87
  v_cvt_pk_bf16_f32 v84, v88, v89
  v_cvt_pk_bf16_f32 v85, v90, v91
  v_cvt_pk_bf16_f32 v86, v92, v93
  v_cvt_pk_bf16_f32 v87, v94, v95
  s_waitcnt lgkmcnt(1)
  v_mfma_f32_32x32x16_bf16 v[96:111], a[48:51], v[80:83], v[96:111]
  s_waitcnt lgkmcnt(0)
  v_mfma_f32_32x32x16_bf16 v[96:111], a[52:55], v[84:87], v[96:111]
L_mx29:
  s_nop 15
  s_add_u32 s58, s52, 4
  s_lshr_b32 s58, s58, 3
  s_or_b32 s58, s58, s53
  s_cbranch_scc0 L_mx30
  ds_read_b128 a[40:43], v210 offset:8320
  ds_read_b128 a[44:47], v210 offset:9360
  v_mfma_f32_32x32x16_bf16 v[64:79], a[16:19], v[32:35], v[160:175]
  s_nop 11
  v_exp_f32 v64, v64
  v_exp_f32 v65, v65
  v_exp_f32 v66, v66
  v_exp_f32 v67, v67
  v_exp_f32 v68, v68
  v_exp_f32 v69, v69
  v_exp_f32 v70, v70
  v_exp_f32 v71, v71
  v_exp_f32 v72, v72
  v_exp_f32 v73, v73
  v_exp_f32 v74, v74
  v_exp_f32 v75, v75
  v_exp_f32 v76, v76
  v_exp_f32 v77, v77
  v_exp_f32 v78, v78
  v_exp_f32 v79, v79
  v_cvt_pk_bf16_f32 v64, v64, v65
  v_cvt_pk_bf16_f32 v65, v66, v67
  v_cvt_pk_bf16_f32 v66, v68, v69
  v_cvt_pk_bf16_f32 v67, v70, v71
  v_cvt_pk_bf16_f32 v68, v72, v73
  v_cvt_pk_bf16_f32 v69, v74, v75
  v_cvt_pk_bf16_f32 v70, v76, v77
  v_cvt_pk_bf16_f32 v71, v78, v79
  s_waitcnt lgkmcnt(1)
  v_mfma_f32_32x32x16_bf16 v[96:111], a[40:43], v[64:67], v[96:111]
  s_waitcnt lgkmcnt(0)
  v_mfma_f32_32x32x16_bf16 v[96:111], a[44:47], v[68:71], v[96:111]
L_mx30:
  s_nop 15
  s_add_u32 s58, s52, 3
  s_lshr_b32 s58, s58, 3
  s_or_b32 s58, s58, s53
  s_cbranch_scc0 L_mx31
  ds_read_b128 a[48:51], v210 offset:6240
  ds_read_b128 a[52:55], v210 offset:7280
  v_mfma_f32_32x32x16_bf16 v[80:95], a[12:15], v[32:35], v[160:175]
  s_nop 11
  v_exp_f32 v80, v80
  v_exp_f32 v81, v81
  v_exp_f32 v82, v82
  v_exp_f32 v83, v83
  v_exp_f32 v84, v84
  v_exp_f32 v85, v85
  v_exp_f32 v86, v86
  v_exp_f32 v87, v87
  v_exp_f32 v88, v88
  v_exp_f32 v89, v89
  v_exp_f32 v90, v90
  v_exp_f32 v91, v91
  v_exp_f32 v92, v92
  v_exp_f32 v93, v93
  v_exp_f32 v94, v94
  v_exp_f32 v95, v95
  v_cvt_pk_bf16_f32 v80, v80, v81
  v_cvt_pk_bf16_f32 v81, v82, v83
  v_cvt_pk_bf16_f32 v82, v84, v85
  v_cvt_pk_bf16_f32 v83, v86, v87
  v_cvt_pk_bf16_f32 v84, v88, v89
  v_cvt_pk_bf16_f32 v85, v90, v91
  v_cvt_pk_bf16_f32 v86, v92, v93
  v_cvt_pk_bf16_f32 v87, v94, v95
  s_waitcnt lgkmcnt(1)
  v_mfma_f32_32x32x16_bf16 v[96:111], a[48:51], v[80:83], v[96:111]
  s_waitcnt lgkmcnt(0)
  v_mfma_f32_32x32x16_bf16 v[96:111], a[52:55], v[84:87], v[96:111]
L_mx31:
  s_nop 15
  s_add_u32 s58, s52, 2
  s_lshr_b32 s58, s58, 3
  s_or_b32 s58, s58, s53
  s_cbranch_scc0 L_mx32
  ds_read_b128 a[40:43], v210 offset:4160
  ds_read_b128 a[44:47], v210 offset:5200
  v_mfma_f32_32x32x16_bf16 v[64:79], a[8:11], v[32:35], v[160:175]
  s_nop 11
  v_exp_f32 v64, v64
  v_exp_f32 v65, v65
  v_exp_f32 v66, v66
  v_exp_f32 v67, v67
  v_exp_f32 v68, v68
  v_exp_f32 v69, v69
  v_exp_f32 v70, v70
  v_exp_f32 v71, v71
  v_exp_f32 v72, v72
  v_exp_f32 v73, v73
  v_exp_f32 v74, v74
  v_exp_f32 v75, v75
  v_exp_f32 v76, v76
  v_exp_f32 v77, v77
  v_exp_f32 v78, v78
  v_exp_f32 v79, v79
  v_cvt_pk_bf16_f32 v64, v64, v65
  v_cvt_pk_bf16_f32 v65, v66, v67
  v_cvt_pk_bf16_f32 v66, v68, v69
  v_cvt_pk_bf16_f32 v67, v70, v71
  v_cvt_pk_bf16_f32 v68, v72, v73
  v_cvt_pk_bf16_f32 v69, v74, v75
  v_cvt_pk_bf16_f32 v70, v76, v77
  v_cvt_pk_bf16_f32 v71, v78, v79
  s_waitcnt lgkmcnt(1)
  v_mfma_f32_32x32x16_bf16 v[96:111], a[40:43], v[64:67], v[96:111]
  s_waitcnt lgkmcnt(0)
  v_mfma_f32_32x32x16_bf16 v[96:111], a[44:47], v[68:71], v[96:111]
L_mx32:
  s_nop 15
  s_add_u32 s58, s52, 1
  s_lshr_b32 s58, s58, 3
  s_or_b32 s58, s58, s53
  s_cbranch_scc0 L_mx33
  ds_read_b128 a[48:51], v210 offset:2080
  ds_read_b128 a[52:55], v210 offset:3120
  v_mfma_f32_32x32x16_bf16 v[80:95], a[4:7], v[32:35], v[160:175]
  s_nop 11
  v_exp_f32 v80, v80
  v_exp_f32 v81, v81
  v_exp_f32 v82, v82
  v_exp_f32 v83, v83
  v_exp_f32 v84, v84
  v_exp_f32 v85, v85
  v_exp_f32 v86, v86
  v_exp_f32 v87, v87
  v_exp_f32 v88, v88
  v_exp_f32 v89, v89
  v_exp_f32 v90, v90
  v_exp_f32 v91, v91
  v_exp_f32 v92, v92
  v_exp_f32 v93, v93
  v_exp_f32 v94, v94
  v_exp_f32 v95, v95
  v_cvt_pk_bf16_f32 v80, v80, v81
  v_cvt_pk_bf16_f32 v81, v82, v83
  v_cvt_pk_bf16_f32 v82, v84, v85
  v_cvt_pk_bf16_f32 v83, v86, v87
  v_cvt_pk_bf16_f32 v84, v88, v89
  v_cvt_pk_bf16_f32 v85, v90, v91
  v_cvt_pk_bf16_f32 v86, v92, v93
  v_cvt_pk_bf16_f32 v87, v94, v95
  s_waitcnt lgkmcnt(1)
  v_mfma_f32_32x32x16_bf16 v[96:111], a[48:51], v[80:83], v[96:111]
  s_waitcnt lgkmcnt(0)
  v_mfma_f32_32x32x16_bf16 v[96:111], a[52:55], v[84:87], v[96:111]
L_mx33:
  s_nop 15
  s_add_u32 s58, s52, 0
  s_lshr_b32 s58, s58, 3
  s_or_b32 s58, s58, s53
  s_cbranch_scc0 L_mx34
  ds_read_b128 a[40:43], v210 offset:0
  ds_read_b128 a[44:47], v210 offset:1040
  v_sub_f32 v176, v240, v48
  v_sub_f32 v177, v241, v48
  v_sub_f32 v178, v242, v48
  v_sub_f32 v179, v243, v48
  v_sub_f32 v180, v244, v48
  v_sub_f32 v181, v245, v48
  v_sub_f32 v182, v246, v48
  v_sub_f32 v183, v247, v48
  v_sub_f32 v184, v248, v48
  v_sub_f32 v185, v249, v48
  v_sub_f32 v186, v250, v48
  v_sub_f32 v187, v251, v48
  v_sub_f32 v188, v252, v48
  v_sub_f32 v189, v253, v48
  v_sub_f32 v190, v254, v48
  v_sub_f32 v191, v255, v48
  s_nop 1
  v_mfma_f32_32x32x16_bf16 v[64:79], a[0:3], v[32:35], v[176:191]
  s_nop 11
  v_exp_f32 v64, v64
  v_exp_f32 v65, v65
  v_exp_f32 v66, v66
  v_exp_f32 v67, v67
  v_exp_f32 v68, v68
  v_exp_f32 v69, v69
  v_exp_f32 v70, v70
  v_exp_f32 v71, v71
  v_exp_f32 v72, v72
  v_exp_f32 v73, v73
  v_exp_f32 v74, v74
  v_exp_f32 v75, v75
  v_exp_f32 v76, v76
  v_exp_f32 v77, v77
  v_exp_f32 v78, v78
  v_exp_f32 v79, v79
  v_cvt_pk_bf16_f32 v64, v64, v65
  v_cvt_pk_bf16_f32 v65, v66, v67
  v_cvt_pk_bf16_f32 v66, v68, v69
  v_cvt_pk_bf16_f32 v67, v70, v71
  v_cvt_pk_bf16_f32 v68, v72, v73
  v_cvt_pk_bf16_f32 v69, v74, v75
  v_cvt_pk_bf16_f32 v70, v76, v77
  v_cvt_pk_bf16_f32 v71, v78, v79
  s_waitcnt lgkmcnt(1)
  v_mfma_f32_32x32x16_bf16 v[96:111], a[40:43], v[64:67], v[96:111]
  s_waitcnt lgkmcnt(0)
  v_mfma_f32_32x32x16_bf16 v[96:111], a[44:47], v[68:71], v[96:111]
L_mx34:
  s_nop 15
  v_rcp_f32 v104, v104
  s_nop 0
  v_mul_f32 v96, v96, v104
  v_mul_f32 v97, v97, v104
  v_mul_f32 v98, v98, v104
  v_mul_f32 v99, v99, v104
  v_mul_f32 v100, v100, v104
  v_mul_f32 v101, v101, v104
  v_mul_f32 v102, v102, v104
  v_mul_f32 v103, v103, v104
  v_cvt_pk_bf16_f32 v96, v96, v97
  v_cvt_pk_bf16_f32 v97, v98, v99
  v_cvt_pk_bf16_f32 v98, v100, v101
  v_cvt_pk_bf16_f32 v99, v102, v103
  buffer_store_dwordx4 v[96:99], v218, s[36:39], 0 offen offset:0 sc1
  ds_read_b128 a[0:3], v202 offset:16384
  ds_read_b128 a[4:7], v202 offset:17408
  ds_read_b128 a[8:11], v202 offset:18432
  ds_read_b128 a[12:15], v202 offset:19456
  ds_read_b128 a[16:19], v202 offset:20480
  ds_read_b128 a[20:23], v202 offset:21504
  ds_read_b128 a[24:27], v202 offset:22528
  ds_read_b128 a[28:31], v202 offset:23552
  ds_read_b128 a[32:35], v202 offset:24576
  s_waitcnt lgkmcnt(8)
  v_mfma_f32_32x32x16_bf16 v[64:79], a[0:3], v[36:39], v[240:255]
  s_waitcnt lgkmcnt(7)
  v_mfma_f32_32x32x16_bf16 v[80:95], a[4:7], v[36:39], 0
  v_mov_b32 v48, 0xf149f2ca
  s_add_u32 s58, s52, 0
  s_lshr_b32 s58, s58, 3
  s_or_b32 s58, s58, s53
  s_cbranch_scc0 L_mx35
  s_nop 4
  v_max3_f32 v48, v48, v64, v65
  v_max3_f32 v48, v48, v66, v67
  v_max3_f32 v48, v48, v68, v69
  v_max3_f32 v48, v48, v70, v71
  v_max3_f32 v48, v48, v72, v73
  v_max3_f32 v48, v48, v74, v75
  v_max3_f32 v48, v48, v76, v77
  v_max3_f32 v48, v48, v78, v79
L_mx35:
  s_waitcnt lgkmcnt(6)
  v_mfma_f32_32x32x16_bf16 v[64:79], a[8:11], v[36:39], 0
  s_add_u32 s58, s52, 1
  s_lshr_b32 s58, s58, 3
  s_or_b32 s58, s58, s53
  s_cbranch_scc0 L_mx36
  v_max3_f32 v48, v48, v80, v81
  v_max3_f32 v48, v48, v82, v83
  v_max3_f32 v48, v48, v84, v85
  v_max3_f32 v48, v48, v86, v87
  v_max3_f32 v48, v48, v88, v89
  v_max3_f32 v48, v48, v90, v91
  v_max3_f32 v48, v48, v92, v93
  v_max3_f32 v48, v48, v94, v95
L_mx36:
  s_waitcnt lgkmcnt(5)
  v_mfma_f32_32x32x16_bf16 v[80:95], a[12:15], v[36:39], 0
  s_add_u32 s58, s52, 2
  s_lshr_b32 s58, s58, 3
  s_or_b32 s58, s58, s53
  s_cbranch_scc0 L_mx37
  v_max3_f32 v48, v48, v64, v65
  v_max3_f32 v48, v48, v66, v67
  v_max3_f32 v48, v48, v68, v69
  v_max3_f32 v48, v48, v70, v71
  v_max3_f32 v48, v48, v72, v73
  v_max3_f32 v48, v48, v74, v75
  v_max3_f32 v48, v48, v76, v77
  v_max3_f32 v48, v48, v78, v79
L_mx37:
  s_waitcnt lgkmcnt(4)
  v_mfma_f32_32x32x16_bf16 v[64:79], a[16:19], v[36:39], 0
  s_add_u32 s58, s52, 3
  s_lshr_b32 s58, s58, 3
  s_or_b32 s58, s58, s53
  s_cbranch_scc0 L_mx38
  v_max3_f32 v48, v48, v80, v81
  v_max3_f32 v48, v48, v82, v83
  v_max3_f32 v48, v48, v84, v85
  v_max3_f32 v48, v48, v86, v87
  v_max3_f32 v48, v48, v88, v89
  v_max3_f32 v48, v48, v90, v91
  v_max3_f32 v48, v48, v92, v93
  v_max3_f32 v48, v48, v94, v95
L_mx38:
  s_waitcnt lgkmcnt(3)
  v_mfma_f32_32x32x16_bf16 v[80:95], a[20:23], v[36:39], 0
  s_add_u32 s58, s52, 4
  s_lshr_b32 s58, s58, 3
  s_or_b32 s58, s58, s53
  s_cbranch_scc0 L_mx39
  v_max3_f32 v48, v48, v64, v65
  v_max3_f32 v48, v48, v66, v67
  v_max3_f32 v48, v48, v68, v69
  v_max3_f32 v48, v48, v70, v71
  v_max3_f32 v48, v48, v72, v73
  v_max3_f32 v48, v48, v74, v75
  v_max3_f32 v48, v48, v76, v77
  v_max3_f32 v48, v48, v78, v79
L_mx39:
  s_waitcnt lgkmcnt(2)
  v_mfma_f32_32x32x16_bf16 v[64:79], a[24:27], v[36:39], 0
  s_add_u32 s58, s52, 5
  s_lshr_b32 s58, s58, 3
  s_or_b32 s58, s58, s53
  s_cbranch_scc0 L_mx40
  v_max3_f32 v48, v48, v80, v81
  v_max3_f32 v48, v48, v82, v83
  v_max3_f32 v48, v48, v84, v85
  v_max3_f32 v48, v48, v86, v87
  v_max3_f32 v48, v48, v88, v89
  v_max3_f32 v48, v48, v90, v91
  v_max3_f32 v48, v48, v92, v93
  v_max3_f32 v48, v48, v94, v95
L_mx40:
  s_waitcnt lgkmcnt(1)
  v_mfma_f32_32x32x16_bf16 v[80:95], a[28:31], v[36:39], 0
  s_add_u32 s58, s52, 6
  s_lshr_b32 s58, s58, 3
  s_or_b32 s58, s58, s53
  s_cbranch_scc0 L_mx41
  v_max3_f32 v48, v48, v64, v65
  v_max3_f32 v48, v48, v66, v67
  v_max3_f32 v48, v48, v68, v69
  v_max3_f32 v48, v48, v70, v71
  v_max3_f32 v48, v48, v72, v73
  v_max3_f32 v48, v48, v74, v75
  v_max3_f32 v48, v48, v76, v77
  v_max3_f32 v48, v48, v78, v79
L_mx41:
  s_waitcnt lgkmcnt(0)
  v_mfma_f32_32x32x16_bf16 v[64:79], a[32:35], v[36:39], v[224:239]
  s_add_u32 s58, s52, 7
  s_lshr_b32 s58, s58, 3
  s_or_b32 s58, s58, s53
  s_cbranch_scc0 L_mx42
  v_max3_f32 v48, v48, v80, v81
  v_max3_f32 v48, v48, v82, v83
  v_max3_f32 v48, v48, v84, v85
  v_max3_f32 v48, v48, v86, v87
  v_max3_f32 v48, v48, v88, v89
  v_max3_f32 v48, v48, v90, v91
  v_max3_f32 v48, v48, v92, v93
  v_max3_f32 v48, v48, v94, v95
L_mx42:
  v_max3_f32 v48, v48, v64, v65
  v_max3_f32 v48, v48, v66, v67
  v_max3_f32 v48, v48, v68, v69
  v_max3_f32 v48, v48, v70, v71
  v_max3_f32 v48, v48, v72, v73
  v_max3_f32 v48, v48, v74, v75
  v_max3_f32 v48, v48, v76, v77
  v_max3_f32 v48, v48, v78, v79
  v_mov_b32 v49, v48
  s_nop 1
  v_permlane32_swap_b32 v48, v49
  v_max_f32 v48, v48, v49
  v_sub_f32 v160, 0, v48
  v_sub_f32 v161, 0, v48
  v_sub_f32 v162, 0, v48
  v_sub_f32 v163, 0, v48
  v_sub_f32 v164, 0, v48
  v_sub_f32 v165, 0, v48
  v_sub_f32 v166, 0, v48
  v_sub_f32 v167, 0, v48
  v_sub_f32 v168, 0, v48
  v_sub_f32 v169, 0, v48
  v_sub_f32 v170, 0, v48
  v_sub_f32 v171, 0, v48
  v_sub_f32 v172, 0, v48
  v_sub_f32 v173, 0, v48
  v_sub_f32 v174, 0, v48
  v_sub_f32 v175, 0, v48
  ds_read_b128 a[40:43], v212 offset:16640
  ds_read_b128 a[44:47], v212 offset:17680
  v_sub_f32 v176, v224, v48
  v_sub_f32 v177, v225, v48
  v_sub_f32 v178, v226, v48
  v_sub_f32 v179, v227, v48
  v_sub_f32 v180, v228, v48
  v_sub_f32 v181, v229, v48
  v_sub_f32 v182, v230, v48
  v_sub_f32 v183, v231, v48
  v_sub_f32 v184, v232, v48
  v_sub_f32 v185, v233, v48
  v_sub_f32 v186, v234, v48
  v_sub_f32 v187, v235, v48
  v_sub_f32 v188, v236, v48
  v_sub_f32 v189, v237, v48
  v_sub_f32 v190, v238, v48
  v_sub_f32 v191, v239, v48
  s_nop 1
  v_mfma_f32_32x32x16_bf16 v[64:79], a[32:35], v[36:39], v[176:191]
  s_nop 11
  v_exp_f32 v64, v64
  v_exp_f32 v65, v65
  v_exp_f32 v66, v66
  v_exp_f32 v67, v67
  v_exp_f32 v68, v68
  v_exp_f32 v69, v69
  v_exp_f32 v70, v70
  v_exp_f32 v71, v71
  v_exp_f32 v72, v72
  v_exp_f32 v73, v73
  v_exp_f32 v74, v74
  v_exp_f32 v75, v75
  v_exp_f32 v76, v76
  v_exp_f32 v77, v77
  v_exp_f32 v78, v78
  v_exp_f32 v79, v79
  v_cvt_pk_bf16_f32 v64, v64, v65
  v_cvt_pk_bf16_f32 v65, v66, v67
  v_cvt_pk_bf16_f32 v66, v68, v69
  v_cvt_pk_bf16_f32 v67, v70, v71
  v_cvt_pk_bf16_f32 v68, v72, v73
  v_cvt_pk_bf16_f32 v69, v74, v75
  v_cvt_pk_bf16_f32 v70, v76, v77
  v_cvt_pk_bf16_f32 v71, v78, v79
  s_waitcnt lgkmcnt(1)
  v_mfma_f32_32x32x16_bf16 v[112:127], a[40:43], v[64:67], 0
  s_waitcnt lgkmcnt(0)
  v_mfma_f32_32x32x16_bf16 v[112:127], a[44:47], v[68:71], v[112:127]
  s_add_u32 s58, s52, 7
  s_lshr_b32 s58, s58, 3
  s_or_b32 s58, s58, s53
  s_cbranch_scc0 L_mx43
  ds_read_b128 a[48:51], v212 offset:14560
  ds_read_b128 a[52:55], v212 offset:15600
  v_mfma_f32_32x32x16_bf16 v[80:95], a[28:31], v[36:39], v[160:175]
  s_nop 11
  v_exp_f32 v80, v80
  v_exp_f32 v81, v81
  v_exp_f32 v82, v82
  v_exp_f32 v83, v83
  v_exp_f32 v84, v84
  v_exp_f32 v85, v85
  v_exp_f32 v86, v86
  v_exp_f32 v87, v87
  v_exp_f32 v88, v88
  v_exp_f32 v89, v89
  v_exp_f32 v90, v90
  v_exp_f32 v91, v91
  v_exp_f32 v92, v92
  v_exp_f32 v93, v93
  v_exp_f32 v94, v94
  v_exp_f32 v95, v95
  v_cvt_pk_bf16_f32 v80, v80, v81
  v_cvt_pk_bf16_f32 v81, v82, v83
  v_cvt_pk_bf16_f32 v82, v84, v85
  v_cvt_pk_bf16_f32 v83, v86, v87
  v_cvt_pk_bf16_f32 v84, v88, v89
  v_cvt_pk_bf16_f32 v85, v90, v91
  v_cvt_pk_bf16_f32 v86, v92, v93
  v_cvt_pk_bf16_f32 v87, v94, v95
  s_waitcnt lgkmcnt(1)
  v_mfma_f32_32x32x16_bf16 v[112:127], a[48:51], v[80:83], v[112:127]
  s_waitcnt lgkmcnt(0)
  v_mfma_f32_32x32x16_bf16 v[112:127], a[52:55], v[84:87], v[112:127]
L_mx43:
  s_nop 15
  s_add_u32 s58, s52, 6
  s_lshr_b32 s58, s58, 3
  s_or_b32 s58, s58, s53
  s_cbranch_scc0 L_mx44
  ds_read_b128 a[40:43], v212 offset:12480
  ds_read_b128 a[44:47], v212 offset:13520
  v_mfma_f32_32x32x16_bf16 v[64:79], a[24:27], v[36:39], v[160:175]
  s_nop 11
  v_exp_f32 v64, v64
  v_exp_f32 v65, v65
  v_exp_f32 v66, v66
  v_exp_f32 v67, v67
  v_exp_f32 v68, v68
  v_exp_f32 v69, v69
  v_exp_f32 v70, v70
  v_exp_f32 v71, v71
  v_exp_f32 v72, v72
  v_exp_f32 v73, v73
  v_exp_f32 v74, v74
  v_exp_f32 v75, v75
  v_exp_f32 v76, v76
  v_exp_f32 v77, v77
  v_exp_f32 v78, v78
  v_exp_f32 v79, v79
  v_cvt_pk_bf16_f32 v64, v64, v65
  v_cvt_pk_bf16_f32 v65, v66, v67
  v_cvt_pk_bf16_f32 v66, v68, v69
  v_cvt_pk_bf16_f32 v67, v70, v71
  v_cvt_pk_bf16_f32 v68, v72, v73
  v_cvt_pk_bf16_f32 v69, v74, v75
  v_cvt_pk_bf16_f32 v70, v76, v77
  v_cvt_pk_bf16_f32 v71, v78, v79
  s_waitcnt lgkmcnt(1)
  v_mfma_f32_32x32x16_bf16 v[112:127], a[40:43], v[64:67], v[112:127]
  s_waitcnt lgkmcnt(0)
  v_mfma_f32_32x32x16_bf16 v[112:127], a[44:47], v[68:71], v[112:127]
L_mx44:
  s_nop 15
  s_add_u32 s58, s52, 5
  s_lshr_b32 s58, s58, 3
  s_or_b32 s58, s58, s53
  s_cbranch_scc0 L_mx45
  ds_read_b128 a[48:51], v212 offset:10400
  ds_read_b128 a[52:55], v212 offset:11440
  v_mfma_f32_32x32x16_bf16 v[80:95], a[20:23], v[36:39], v[160:175]
  s_nop 11
  v_exp_f32 v80, v80
  v_exp_f32 v81, v81
  v_exp_f32 v82, v82
  v_exp_f32 v83, v83
  v_exp_f32 v84, v84
  v_exp_f32 v85, v85
  v_exp_f32 v86, v86
  v_exp_f32 v87, v87
  v_exp_f32 v88, v88
  v_exp_f32 v89, v89
  v_exp_f32 v90, v90
  v_exp_f32 v91, v91
  v_exp_f32 v92, v92
  v_exp_f32 v93, v93
  v_exp_f32 v94, v94
  v_exp_f32 v95, v95
  v_cvt_pk_bf16_f32 v80, v80, v81
  v_cvt_pk_bf16_f32 v81, v82, v83
  v_cvt_pk_bf16_f32 v82, v84, v85
  v_cvt_pk_bf16_f32 v83, v86, v87
  v_cvt_pk_bf16_f32 v84, v88, v89
  v_cvt_pk_bf16_f32 v85, v90, v91
  v_cvt_pk_bf16_f32 v86, v92, v93
  v_cvt_pk_bf16_f32 v87, v94, v95
  s_waitcnt lgkmcnt(1)
  v_mfma_f32_32x32x16_bf16 v[112:127], a[48:51], v[80:83], v[112:127]
  s_waitcnt lgkmcnt(0)
  v_mfma_f32_32x32x16_bf16 v[112:127], a[52:55], v[84:87], v[112:127]
L_mx45:
  s_nop 15
  s_add_u32 s58, s52, 4
  s_lshr_b32 s58, s58, 3
  s_or_b32 s58, s58, s53
  s_cbranch_scc0 L_mx46
  ds_read_b128 a[40:43], v212 offset:8320
  ds_read_b128 a[44:47], v212 offset:9360
  v_mfma_f32_32x32x16_bf16 v[64:79], a[16:19], v[36:39], v[160:175]
  s_nop 11
  v_exp_f32 v64, v64
  v_exp_f32 v65, v65
  v_exp_f32 v66, v66
  v_exp_f32 v67, v67
  v_exp_f32 v68, v68
  v_exp_f32 v69, v69
  v_exp_f32 v70, v70
  v_exp_f32 v71, v71
  v_exp_f32 v72, v72
  v_exp_f32 v73, v73
  v_exp_f32 v74, v74
  v_exp_f32 v75, v75
  v_exp_f32 v76, v76
  v_exp_f32 v77, v77
  v_exp_f32 v78, v78
  v_exp_f32 v79, v79
  v_cvt_pk_bf16_f32 v64, v64, v65
  v_cvt_pk_bf16_f32 v65, v66, v67
  v_cvt_pk_bf16_f32 v66, v68, v69
  v_cvt_pk_bf16_f32 v67, v70, v71
  v_cvt_pk_bf16_f32 v68, v72, v73
  v_cvt_pk_bf16_f32 v69, v74, v75
  v_cvt_pk_bf16_f32 v70, v76, v77
  v_cvt_pk_bf16_f32 v71, v78, v79
  s_waitcnt lgkmcnt(1)
  v_mfma_f32_32x32x16_bf16 v[112:127], a[40:43], v[64:67], v[112:127]
  s_waitcnt lgkmcnt(0)
  v_mfma_f32_32x32x16_bf16 v[112:127], a[44:47], v[68:71], v[112:127]
L_mx46:
  s_nop 15
  s_add_u32 s58, s52, 3
  s_lshr_b32 s58, s58, 3
  s_or_b32 s58, s58, s53
  s_cbranch_scc0 L_mx47
  ds_read_b128 a[48:51], v212 offset:6240
  ds_read_b128 a[52:55], v212 offset:7280
  v_mfma_f32_32x32x16_bf16 v[80:95], a[12:15], v[36:39], v[160:175]
  s_nop 11
  v_exp_f32 v80, v80
  v_exp_f32 v81, v81
  v_exp_f32 v82, v82
  v_exp_f32 v83, v83
  v_exp_f32 v84, v84
  v_exp_f32 v85, v85
  v_exp_f32 v86, v86
  v_exp_f32 v87, v87
  v_exp_f32 v88, v88
  v_exp_f32 v89, v89
  v_exp_f32 v90, v90
  v_exp_f32 v91, v91
  v_exp_f32 v92, v92
  v_exp_f32 v93, v93
  v_exp_f32 v94, v94
  v_exp_f32 v95, v95
  v_cvt_pk_bf16_f32 v80, v80, v81
  v_cvt_pk_bf16_f32 v81, v82, v83
  v_cvt_pk_bf16_f32 v82, v84, v85
  v_cvt_pk_bf16_f32 v83, v86, v87
  v_cvt_pk_bf16_f32 v84, v88, v89
  v_cvt_pk_bf16_f32 v85, v90, v91
  v_cvt_pk_bf16_f32 v86, v92, v93
  v_cvt_pk_bf16_f32 v87, v94, v95
  s_waitcnt lgkmcnt(1)
  v_mfma_f32_32x32x16_bf16 v[112:127], a[48:51], v[80:83], v[112:127]
  s_waitcnt lgkmcnt(0)
  v_mfma_f32_32x32x16_bf16 v[112:127], a[52:55], v[84:87], v[112:127]
L_mx47:
  s_nop 15
  s_add_u32 s58, s52, 2
  s_lshr_b32 s58, s58, 3
  s_or_b32 s58, s58, s53
  s_cbranch_scc0 L_mx48
  ds_read_b128 a[40:43], v212 offset:4160
  ds_read_b128 a[44:47], v212 offset:5200
  v_mfma_f32_32x32x16_bf16 v[64:79], a[8:11], v[36:39], v[160:175]
  s_nop 11
  v_exp_f32 v64, v64
  v_exp_f32 v65, v65
  v_exp_f32 v66, v66
  v_exp_f32 v67, v67
  v_exp_f32 v68, v68
  v_exp_f32 v69, v69
  v_exp_f32 v70, v70
  v_exp_f32 v71, v71
  v_exp_f32 v72, v72
  v_exp_f32 v73, v73
  v_exp_f32 v74, v74
  v_exp_f32 v75, v75
  v_exp_f32 v76, v76
  v_exp_f32 v77, v77
  v_exp_f32 v78, v78
  v_exp_f32 v79, v79
  v_cvt_pk_bf16_f32 v64, v64, v65
  v_cvt_pk_bf16_f32 v65, v66, v67
  v_cvt_pk_bf16_f32 v66, v68, v69
  v_cvt_pk_bf16_f32 v67, v70, v71
  v_cvt_pk_bf16_f32 v68, v72, v73
  v_cvt_pk_bf16_f32 v69, v74, v75
  v_cvt_pk_bf16_f32 v70, v76, v77
  v_cvt_pk_bf16_f32 v71, v78, v79
  s_waitcnt lgkmcnt(1)
  v_mfma_f32_32x32x16_bf16 v[112:127], a[40:43], v[64:67], v[112:127]
  s_waitcnt lgkmcnt(0)
  v_mfma_f32_32x32x16_bf16 v[112:127], a[44:47], v[68:71], v[112:127]
L_mx48:
  s_nop 15
  s_add_u32 s58, s52, 1
  s_lshr_b32 s58, s58, 3
  s_or_b32 s58, s58, s53
  s_cbranch_scc0 L_mx49
  ds_read_b128 a[48:51], v212 offset:2080
  ds_read_b128 a[52:55], v212 offset:3120
  v_mfma_f32_32x32x16_bf16 v[80:95], a[4:7], v[36:39], v[160:175]
  s_nop 11
  v_exp_f32 v80, v80
  v_exp_f32 v81, v81
  v_exp_f32 v82, v82
  v_exp_f32 v83, v83
  v_exp_f32 v84, v84
  v_exp_f32 v85, v85
  v_exp_f32 v86, v86
  v_exp_f32 v87, v87
  v_exp_f32 v88, v88
  v_exp_f32 v89, v89
  v_exp_f32 v90, v90
  v_exp_f32 v91, v91
  v_exp_f32 v92, v92
  v_exp_f32 v93, v93
  v_exp_f32 v94, v94
  v_exp_f32 v95, v95
  v_cvt_pk_bf16_f32 v80, v80, v81
  v_cvt_pk_bf16_f32 v81, v82, v83
  v_cvt_pk_bf16_f32 v82, v84, v85
  v_cvt_pk_bf16_f32 v83, v86, v87
  v_cvt_pk_bf16_f32 v84, v88, v89
  v_cvt_pk_bf16_f32 v85, v90, v91
  v_cvt_pk_bf16_f32 v86, v92, v93
  v_cvt_pk_bf16_f32 v87, v94, v95
  s_waitcnt lgkmcnt(1)
  v_mfma_f32_32x32x16_bf16 v[112:127], a[48:51], v[80:83], v[112:127]
  s_waitcnt lgkmcnt(0)
  v_mfma_f32_32x32x16_bf16 v[112:127], a[52:55], v[84:87], v[112:127]
L_mx49:
  s_nop 15
  s_add_u32 s58, s52, 0
  s_lshr_b32 s58, s58, 3
  s_or_b32 s58, s58, s53
  s_cbranch_scc0 L_mx50
  ds_read_b128 a[40:43], v212 offset:0
  ds_read_b128 a[44:47], v212 offset:1040
  v_sub_f32 v176, v240, v48
  v_sub_f32 v177, v241, v48
  v_sub_f32 v178, v242, v48
  v_sub_f32 v179, v243, v48
  v_sub_f32 v180, v244, v48
  v_sub_f32 v181, v245, v48
  v_sub_f32 v182, v246, v48
  v_sub_f32 v183, v247, v48
  v_sub_f32 v184, v248, v48
  v_sub_f32 v185, v249, v48
  v_sub_f32 v186, v250, v48
  v_sub_f32 v187, v251, v48
  v_sub_f32 v188, v252, v48
  v_sub_f32 v189, v253, v48
  v_sub_f32 v190, v254, v48
  v_sub_f32 v191, v255, v48
  s_nop 1
  v_mfma_f32_32x32x16_bf16 v[64:79], a[0:3], v[36:39], v[176:191]
  s_nop 11
  v_exp_f32 v64, v64
  v_exp_f32 v65, v65
  v_exp_f32 v66, v66
  v_exp_f32 v67, v67
  v_exp_f32 v68, v68
  v_exp_f32 v69, v69
  v_exp_f32 v70, v70
  v_exp_f32 v71, v71
  v_exp_f32 v72, v72
  v_exp_f32 v73, v73
  v_exp_f32 v74, v74
  v_exp_f32 v75, v75
  v_exp_f32 v76, v76
  v_exp_f32 v77, v77
  v_exp_f32 v78, v78
  v_exp_f32 v79, v79
  v_cvt_pk_bf16_f32 v64, v64, v65
  v_cvt_pk_bf16_f32 v65, v66, v67
  v_cvt_pk_bf16_f32 v66, v68, v69
  v_cvt_pk_bf16_f32 v67, v70, v71
  v_cvt_pk_bf16_f32 v68, v72, v73
  v_cvt_pk_bf16_f32 v69, v74, v75
  v_cvt_pk_bf16_f32 v70, v76, v77
  v_cvt_pk_bf16_f32 v71, v78, v79
  s_waitcnt lgkmcnt(1)
  v_mfma_f32_32x32x16_bf16 v[112:127], a[40:43], v[64:67], v[112:127]
  s_waitcnt lgkmcnt(0)
  v_mfma_f32_32x32x16_bf16 v[112:127], a[44:47], v[68:71], v[112:127]
L_mx50:
  s_nop 15
  v_rcp_f32 v112, v112
  s_nop 0
  v_mul_f32 v120, v120, v112
  v_mul_f32 v121, v121, v112
  v_mul_f32 v122, v122, v112
  v_mul_f32 v123, v123, v112
  v_mul_f32 v124, v124, v112
  v_mul_f32 v125, v125, v112
  v_mul_f32 v126, v126, v112
  v_mul_f32 v127, v127, v112
  v_cvt_pk_bf16_f32 v120, v120, v121
  v_cvt_pk_bf16_f32 v121, v122, v123
  v_cvt_pk_bf16_f32 v122, v124, v125
  v_cvt_pk_bf16_f32 v123, v126, v127
  buffer_store_dwordx4 v[120:123], v218, s[36:39], 0 offen offset:1024 sc1
  ds_read_b128 a[0:3], v203 offset:0
  ds_read_b128 a[4:7], v203 offset:1024
  ds_read_b128 a[8:11], v203 offset:2048
  ds_read_b128 a[12:15], v203 offset:3072
  ds_read_b128 a[16:19], v203 offset:4096
  ds_read_b128 a[20:23], v203 offset:5120
  ds_read_b128 a[24:27], v203 offset:6144
  ds_read_b128 a[28:31], v203 offset:7168
  ds_read_b128 a[32:35], v203 offset:8192
  s_waitcnt lgkmcnt(8)
  v_mfma_f32_32x32x16_bf16 v[64:79], a[0:3], v[40:43], v[240:255]
  s_waitcnt lgkmcnt(7)
  v_mfma_f32_32x32x16_bf16 v[80:95], a[4:7], v[40:43], 0
  v_mov_b32 v48, 0xf149f2ca
  s_sub_u32 s58, 7, s52
  s_lshr_b32 s58, s58, 3
  s_or_b32 s58, s58, s53
  s_cbranch_scc0 L_mx51
  s_nop 4
  v_max3_f32 v48, v48, v64, v65
  v_max3_f32 v48, v48, v66, v67
  v_max3_f32 v48, v48, v68, v69
  v_max3_f32 v48, v48, v70, v71
  v_max3_f32 v48, v48, v72, v73
  v_max3_f32 v48, v48, v74, v75
  v_max3_f32 v48, v48, v76, v77
  v_max3_f32 v48, v48, v78, v79
L_mx51:
  s_waitcnt lgkmcnt(6)
  v_mfma_f32_32x32x16_bf16 v[64:79], a[8:11], v[40:43], 0
  s_sub_u32 s58, 8, s52
  s_lshr_b32 s58, s58, 3
  s_or_b32 s58, s58, s53
  s_cbranch_scc0 L_mx52
  v_max3_f32 v48, v48, v80, v81
  v_max3_f32 v48, v48, v82, v83
  v_max3_f32 v48, v48, v84, v85
  v_max3_f32 v48, v48, v86, v87
  v_max3_f32 v48, v48, v88, v89
  v_max3_f32 v48, v48, v90, v91
  v_max3_f32 v48, v48, v92, v93
  v_max3_f32 v48, v48, v94, v95
L_mx52:
  s_waitcnt lgkmcnt(5)
  v_mfma_f32_32x32x16_bf16 v[80:95], a[12:15], v[40:43], 0
  s_sub_u32 s58, 9, s52
  s_lshr_b32 s58, s58, 3
  s_or_b32 s58, s58, s53
  s_cbranch_scc0 L_mx53
  v_max3_f32 v48, v48, v64, v65
  v_max3_f32 v48, v48, v66, v67
  v_max3_f32 v48, v48, v68, v69
  v_max3_f32 v48, v48, v70, v71
  v_max3_f32 v48, v48, v72, v73
  v_max3_f32 v48, v48, v74, v75
  v_max3_f32 v48, v48, v76, v77
  v_max3_f32 v48, v48, v78, v79
L_mx53:
  s_waitcnt lgkmcnt(4)
  v_mfma_f32_32x32x16_bf16 v[64:79], a[16:19], v[40:43], 0
  s_sub_u32 s58, 10, s52
  s_lshr_b32 s58, s58, 3
  s_or_b32 s58, s58, s53
  s_cbranch_scc0 L_mx54
  v_max3_f32 v48, v48, v80, v81
  v_max3_f32 v48, v48, v82, v83
  v_max3_f32 v48, v48, v84, v85
  v_max3_f32 v48, v48, v86, v87
  v_max3_f32 v48, v48, v88, v89
  v_max3_f32 v48, v48, v90, v91
  v_max3_f32 v48, v48, v92, v93
  v_max3_f32 v48, v48, v94, v95
L_mx54:
  s_waitcnt lgkmcnt(3)
  v_mfma_f32_32x32x16_bf16 v[80:95], a[20:23], v[40:43], 0
  s_sub_u32 s58, 11, s52
  s_lshr_b32 s58, s58, 3
  s_or_b32 s58, s58, s53
  s_cbranch_scc0 L_mx55
  v_max3_f32 v48, v48, v64, v65
  v_max3_f32 v48, v48, v66, v67
  v_max3_f32 v48, v48, v68, v69
  v_max3_f32 v48, v48, v70, v71
  v_max3_f32 v48, v48, v72, v73
  v_max3_f32 v48, v48, v74, v75
  v_max3_f32 v48, v48, v76, v77
  v_max3_f32 v48, v48, v78, v79
L_mx55:
  s_waitcnt lgkmcnt(2)
  v_mfma_f32_32x32x16_bf16 v[64:79], a[24:27], v[40:43], 0
  s_sub_u32 s58, 12, s52
  s_lshr_b32 s58, s58, 3
  s_or_b32 s58, s58, s53
  s_cbranch_scc0 L_mx56
  v_max3_f32 v48, v48, v80, v81
  v_max3_f32 v48, v48, v82, v83
  v_max3_f32 v48, v48, v84, v85
  v_max3_f32 v48, v48, v86, v87
  v_max3_f32 v48, v48, v88, v89
  v_max3_f32 v48, v48, v90, v91
  v_max3_f32 v48, v48, v92, v93
  v_max3_f32 v48, v48, v94, v95
L_mx56:
  s_waitcnt lgkmcnt(1)
  v_mfma_f32_32x32x16_bf16 v[80:95], a[28:31], v[40:43], 0
  s_sub_u32 s58, 13, s52
  s_lshr_b32 s58, s58, 3
  s_or_b32 s58, s58, s53
  s_cbranch_scc0 L_mx57
  v_max3_f32 v48, v48, v64, v65
  v_max3_f32 v48, v48, v66, v67
  v_max3_f32 v48, v48, v68, v69
  v_max3_f32 v48, v48, v70, v71
  v_max3_f32 v48, v48, v72, v73
  v_max3_f32 v48, v48, v74, v75
  v_max3_f32 v48, v48, v76, v77
  v_max3_f32 v48, v48, v78, v79
L_mx57:
  s_waitcnt lgkmcnt(0)
  v_mfma_f32_32x32x16_bf16 v[64:79], a[32:35], v[40:43], v[224:239]
  s_sub_u32 s58, 14, s52
  s_lshr_b32 s58, s58, 3
  s_or_b32 s58, s58, s53
  s_cbranch_scc0 L_mx58
  v_max3_f32 v48, v48, v80, v81
  v_max3_f32 v48, v48, v82, v83
  v_max3_f32 v48, v48, v84, v85
  v_max3_f32 v48, v48, v86, v87
  v_max3_f32 v48, v48, v88, v89
  v_max3_f32 v48, v48, v90, v91
  v_max3_f32 v48, v48, v92, v93
  v_max3_f32 v48, v48, v94, v95
L_mx58:
  v_max3_f32 v48, v48, v64, v65
  v_max3_f32 v48, v48, v66, v67
  v_max3_f32 v48, v48, v68, v69
  v_max3_f32 v48, v48, v70, v71
  v_max3_f32 v48, v48, v72, v73
  v_max3_f32 v48, v48, v74, v75
  v_max3_f32 v48, v48, v76, v77
  v_max3_f32 v48, v48, v78, v79
  v_mov_b32 v49, v48
  s_nop 1
  v_permlane32_swap_b32 v48, v49
  v_max_f32 v48, v48, v49
  v_sub_f32 v160, 0, v48
  v_sub_f32 v161, 0, v48
  v_sub_f32 v162, 0, v48
  v_sub_f32 v163, 0, v48
  v_sub_f32 v164, 0, v48
  v_sub_f32 v165, 0, v48
  v_sub_f32 v166, 0, v48
  v_sub_f32 v167, 0, v48
  v_sub_f32 v168, 0, v48
  v_sub_f32 v169, 0, v48
  v_sub_f32 v170, 0, v48
  v_sub_f32 v171, 0, v48
  v_sub_f32 v172, 0, v48
  v_sub_f32 v173, 0, v48
  v_sub_f32 v174, 0, v48
  v_sub_f32 v175, 0, v48
  ds_read_b128 a[40:43], v211 offset:16640
  ds_read_b128 a[44:47], v211 offset:17680
  v_sub_f32 v176, v224, v48
  v_sub_f32 v177, v225, v48
  v_sub_f32 v178, v226, v48
  v_sub_f32 v179, v227, v48
  v_sub_f32 v180, v228, v48
  v_sub_f32 v181, v229, v48
  v_sub_f32 v182, v230, v48
  v_sub_f32 v183, v231, v48
  v_sub_f32 v184, v232, v48
  v_sub_f32 v185, v233, v48
  v_sub_f32 v186, v234, v48
  v_sub_f32 v187, v235, v48
  v_sub_f32 v188, v236, v48
  v_sub_f32 v189, v237, v48
  v_sub_f32 v190, v238, v48
  v_sub_f32 v191, v239, v48
  s_nop 1
  v_mfma_f32_32x32x16_bf16 v[64:79], a[32:35], v[40:43], v[176:191]
  s_nop 11
  v_exp_f32 v64, v64
  v_exp_f32 v65, v65
  v_exp_f32 v66, v66
  v_exp_f32 v67, v67
  v_exp_f32 v68, v68
  v_exp_f32 v69, v69
  v_exp_f32 v70, v70
  v_exp_f32 v71, v71
  v_exp_f32 v72, v72
  v_exp_f32 v73, v73
  v_exp_f32 v74, v74
  v_exp_f32 v75, v75
  v_exp_f32 v76, v76
  v_exp_f32 v77, v77
  v_exp_f32 v78, v78
  v_exp_f32 v79, v79
  v_cvt_pk_bf16_f32 v64, v64, v65
  v_cvt_pk_bf16_f32 v65, v66, v67
  v_cvt_pk_bf16_f32 v66, v68, v69
  v_cvt_pk_bf16_f32 v67, v70, v71
  v_cvt_pk_bf16_f32 v68, v72, v73
  v_cvt_pk_bf16_f32 v69, v74, v75
  v_cvt_pk_bf16_f32 v70, v76, v77
  v_cvt_pk_bf16_f32 v71, v78, v79
  s_waitcnt lgkmcnt(1)
  v_mfma_f32_32x32x16_bf16 v[128:143], a[40:43], v[64:67], 0
  s_waitcnt lgkmcnt(0)
  v_mfma_f32_32x32x16_bf16 v[128:143], a[44:47], v[68:71], v[128:143]
  s_sub_u32 s58, 14, s52
  s_lshr_b32 s58, s58, 3
  s_or_b32 s58, s58, s53
  s_cbranch_scc0 L_mx59
  ds_read_b128 a[48:51], v211 offset:14560
  ds_read_b128 a[52:55], v211 offset:15600
  v_mfma_f32_32x32x16_bf16 v[80:95], a[28:31], v[40:43], v[160:175]
  s_nop 11
  v_exp_f32 v80, v80
  v_exp_f32 v81, v81
  v_exp_f32 v82, v82
  v_exp_f32 v83, v83
  v_exp_f32 v84, v84
  v_exp_f32 v85, v85
  v_exp_f32 v86, v86
  v_exp_f32 v87, v87
  v_exp_f32 v88, v88
  v_exp_f32 v89, v89
  v_exp_f32 v90, v90
  v_exp_f32 v91, v91
  v_exp_f32 v92, v92
  v_exp_f32 v93, v93
  v_exp_f32 v94, v94
  v_exp_f32 v95, v95
  v_cvt_pk_bf16_f32 v80, v80, v81
  v_cvt_pk_bf16_f32 v81, v82, v83
  v_cvt_pk_bf16_f32 v82, v84, v85
  v_cvt_pk_bf16_f32 v83, v86, v87
  v_cvt_pk_bf16_f32 v84, v88, v89
  v_cvt_pk_bf16_f32 v85, v90, v91
  v_cvt_pk_bf16_f32 v86, v92, v93
  v_cvt_pk_bf16_f32 v87, v94, v95
  s_waitcnt lgkmcnt(1)
  v_mfma_f32_32x32x16_bf16 v[128:143], a[48:51], v[80:83], v[128:143]
  s_waitcnt lgkmcnt(0)
  v_mfma_f32_32x32x16_bf16 v[128:143], a[52:55], v[84:87], v[128:143]
L_mx59:
  s_nop 15
  s_sub_u32 s58, 13, s52
  s_lshr_b32 s58, s58, 3
  s_or_b32 s58, s58, s53
  s_cbranch_scc0 L_mx60
  ds_read_b128 a[40:43], v211 offset:12480
  ds_read_b128 a[44:47], v211 offset:13520
  v_mfma_f32_32x32x16_bf16 v[64:79], a[24:27], v[40:43], v[160:175]
  s_nop 11
  v_exp_f32 v64, v64
  v_exp_f32 v65, v65
  v_exp_f32 v66, v66
  v_exp_f32 v67, v67
  v_exp_f32 v68, v68
  v_exp_f32 v69, v69
  v_exp_f32 v70, v70
  v_exp_f32 v71, v71
  v_exp_f32 v72, v72
  v_exp_f32 v73, v73
  v_exp_f32 v74, v74
  v_exp_f32 v75, v75
  v_exp_f32 v76, v76
  v_exp_f32 v77, v77
  v_exp_f32 v78, v78
  v_exp_f32 v79, v79
  v_cvt_pk_bf16_f32 v64, v64, v65
  v_cvt_pk_bf16_f32 v65, v66, v67
  v_cvt_pk_bf16_f32 v66, v68, v69
  v_cvt_pk_bf16_f32 v67, v70, v71
  v_cvt_pk_bf16_f32 v68, v72, v73
  v_cvt_pk_bf16_f32 v69, v74, v75
  v_cvt_pk_bf16_f32 v70, v76, v77
  v_cvt_pk_bf16_f32 v71, v78, v79
  s_waitcnt lgkmcnt(1)
  v_mfma_f32_32x32x16_bf16 v[128:143], a[40:43], v[64:67], v[128:143]
  s_waitcnt lgkmcnt(0)
  v_mfma_f32_32x32x16_bf16 v[128:143], a[44:47], v[68:71], v[128:143]
L_mx60:
  s_nop 15
  s_sub_u32 s58, 12, s52
  s_lshr_b32 s58, s58, 3
  s_or_b32 s58, s58, s53
  s_cbranch_scc0 L_mx61
  ds_read_b128 a[48:51], v211 offset:10400
  ds_read_b128 a[52:55], v211 offset:11440
  v_mfma_f32_32x32x16_bf16 v[80:95], a[20:23], v[40:43], v[160:175]
  s_nop 11
  v_exp_f32 v80, v80
  v_exp_f32 v81, v81
  v_exp_f32 v82, v82
  v_exp_f32 v83, v83
  v_exp_f32 v84, v84
  v_exp_f32 v85, v85
  v_exp_f32 v86, v86
  v_exp_f32 v87, v87
  v_exp_f32 v88, v88
  v_exp_f32 v89, v89
  v_exp_f32 v90, v90
  v_exp_f32 v91, v91
  v_exp_f32 v92, v92
  v_exp_f32 v93, v93
  v_exp_f32 v94, v94
  v_exp_f32 v95, v95
  v_cvt_pk_bf16_f32 v80, v80, v81
  v_cvt_pk_bf16_f32 v81, v82, v83
  v_cvt_pk_bf16_f32 v82, v84, v85
  v_cvt_pk_bf16_f32 v83, v86, v87
  v_cvt_pk_bf16_f32 v84, v88, v89
  v_cvt_pk_bf16_f32 v85, v90, v91
  v_cvt_pk_bf16_f32 v86, v92, v93
  v_cvt_pk_bf16_f32 v87, v94, v95
  s_waitcnt lgkmcnt(1)
  v_mfma_f32_32x32x16_bf16 v[128:143], a[48:51], v[80:83], v[128:143]
  s_waitcnt lgkmcnt(0)
  v_mfma_f32_32x32x16_bf16 v[128:143], a[52:55], v[84:87], v[128:143]
L_mx61:
  s_nop 15
  s_sub_u32 s58, 11, s52
  s_lshr_b32 s58, s58, 3
  s_or_b32 s58, s58, s53
  s_cbranch_scc0 L_mx62
  ds_read_b128 a[40:43], v211 offset:8320
  ds_read_b128 a[44:47], v211 offset:9360
  v_mfma_f32_32x32x16_bf16 v[64:79], a[16:19], v[40:43], v[160:175]
  s_nop 11
  v_exp_f32 v64, v64
  v_exp_f32 v65, v65
  v_exp_f32 v66, v66
  v_exp_f32 v67, v67
  v_exp_f32 v68, v68
  v_exp_f32 v69, v69
  v_exp_f32 v70, v70
  v_exp_f32 v71, v71
  v_exp_f32 v72, v72
  v_exp_f32 v73, v73
  v_exp_f32 v74, v74
  v_exp_f32 v75, v75
  v_exp_f32 v76, v76
  v_exp_f32 v77, v77
  v_exp_f32 v78, v78
  v_exp_f32 v79, v79
  v_cvt_pk_bf16_f32 v64, v64, v65
  v_cvt_pk_bf16_f32 v65, v66, v67
  v_cvt_pk_bf16_f32 v66, v68, v69
  v_cvt_pk_bf16_f32 v67, v70, v71
  v_cvt_pk_bf16_f32 v68, v72, v73
  v_cvt_pk_bf16_f32 v69, v74, v75
  v_cvt_pk_bf16_f32 v70, v76, v77
  v_cvt_pk_bf16_f32 v71, v78, v79
  s_waitcnt lgkmcnt(1)
  v_mfma_f32_32x32x16_bf16 v[128:143], a[40:43], v[64:67], v[128:143]
  s_waitcnt lgkmcnt(0)
  v_mfma_f32_32x32x16_bf16 v[128:143], a[44:47], v[68:71], v[128:143]
L_mx62:
  s_nop 15
  s_sub_u32 s58, 10, s52
  s_lshr_b32 s58, s58, 3
  s_or_b32 s58, s58, s53
  s_cbranch_scc0 L_mx63
  ds_read_b128 a[48:51], v211 offset:6240
  ds_read_b128 a[52:55], v211 offset:7280
  v_mfma_f32_32x32x16_bf16 v[80:95], a[12:15], v[40:43], v[160:175]
  s_nop 11
  v_exp_f32 v80, v80
  v_exp_f32 v81, v81
  v_exp_f32 v82, v82
  v_exp_f32 v83, v83
  v_exp_f32 v84, v84
  v_exp_f32 v85, v85
  v_exp_f32 v86, v86
  v_exp_f32 v87, v87
  v_exp_f32 v88, v88
  v_exp_f32 v89, v89
  v_exp_f32 v90, v90
  v_exp_f32 v91, v91
  v_exp_f32 v92, v92
  v_exp_f32 v93, v93
  v_exp_f32 v94, v94
  v_exp_f32 v95, v95
  v_cvt_pk_bf16_f32 v80, v80, v81
  v_cvt_pk_bf16_f32 v81, v82, v83
  v_cvt_pk_bf16_f32 v82, v84, v85
  v_cvt_pk_bf16_f32 v83, v86, v87
  v_cvt_pk_bf16_f32 v84, v88, v89
  v_cvt_pk_bf16_f32 v85, v90, v91
  v_cvt_pk_bf16_f32 v86, v92, v93
  v_cvt_pk_bf16_f32 v87, v94, v95
  s_waitcnt lgkmcnt(1)
  v_mfma_f32_32x32x16_bf16 v[128:143], a[48:51], v[80:83], v[128:143]
  s_waitcnt lgkmcnt(0)
  v_mfma_f32_32x32x16_bf16 v[128:143], a[52:55], v[84:87], v[128:143]
L_mx63:
  s_nop 15
  s_sub_u32 s58, 9, s52
  s_lshr_b32 s58, s58, 3
  s_or_b32 s58, s58, s53
  s_cbranch_scc0 L_mx64
  ds_read_b128 a[40:43], v211 offset:4160
  ds_read_b128 a[44:47], v211 offset:5200
  v_mfma_f32_32x32x16_bf16 v[64:79], a[8:11], v[40:43], v[160:175]
  s_nop 11
  v_exp_f32 v64, v64
  v_exp_f32 v65, v65
  v_exp_f32 v66, v66
  v_exp_f32 v67, v67
  v_exp_f32 v68, v68
  v_exp_f32 v69, v69
  v_exp_f32 v70, v70
  v_exp_f32 v71, v71
  v_exp_f32 v72, v72
  v_exp_f32 v73, v73
  v_exp_f32 v74, v74
  v_exp_f32 v75, v75
  v_exp_f32 v76, v76
  v_exp_f32 v77, v77
  v_exp_f32 v78, v78
  v_exp_f32 v79, v79
  v_cvt_pk_bf16_f32 v64, v64, v65
  v_cvt_pk_bf16_f32 v65, v66, v67
  v_cvt_pk_bf16_f32 v66, v68, v69
  v_cvt_pk_bf16_f32 v67, v70, v71
  v_cvt_pk_bf16_f32 v68, v72, v73
  v_cvt_pk_bf16_f32 v69, v74, v75
  v_cvt_pk_bf16_f32 v70, v76, v77
  v_cvt_pk_bf16_f32 v71, v78, v79
  s_waitcnt lgkmcnt(1)
  v_mfma_f32_32x32x16_bf16 v[128:143], a[40:43], v[64:67], v[128:143]
  s_waitcnt lgkmcnt(0)
  v_mfma_f32_32x32x16_bf16 v[128:143], a[44:47], v[68:71], v[128:143]
L_mx64:
  s_nop 15
  s_sub_u32 s58, 8, s52
  s_lshr_b32 s58, s58, 3
  s_or_b32 s58, s58, s53
  s_cbranch_scc0 L_mx65
  ds_read_b128 a[48:51], v211 offset:2080
  ds_read_b128 a[52:55], v211 offset:3120
  v_mfma_f32_32x32x16_bf16 v[80:95], a[4:7], v[40:43], v[160:175]
  s_nop 11
  v_exp_f32 v80, v80
  v_exp_f32 v81, v81
  v_exp_f32 v82, v82
  v_exp_f32 v83, v83
  v_exp_f32 v84, v84
  v_exp_f32 v85, v85
  v_exp_f32 v86, v86
  v_exp_f32 v87, v87
  v_exp_f32 v88, v88
  v_exp_f32 v89, v89
  v_exp_f32 v90, v90
  v_exp_f32 v91, v91
  v_exp_f32 v92, v92
  v_exp_f32 v93, v93
  v_exp_f32 v94, v94
  v_exp_f32 v95, v95
  v_cvt_pk_bf16_f32 v80, v80, v81
  v_cvt_pk_bf16_f32 v81, v82, v83
  v_cvt_pk_bf16_f32 v82, v84, v85
  v_cvt_pk_bf16_f32 v83, v86, v87
  v_cvt_pk_bf16_f32 v84, v88, v89
  v_cvt_pk_bf16_f32 v85, v90, v91
  v_cvt_pk_bf16_f32 v86, v92, v93
  v_cvt_pk_bf16_f32 v87, v94, v95
  s_waitcnt lgkmcnt(1)
  v_mfma_f32_32x32x16_bf16 v[128:143], a[48:51], v[80:83], v[128:143]
  s_waitcnt lgkmcnt(0)
  v_mfma_f32_32x32x16_bf16 v[128:143], a[52:55], v[84:87], v[128:143]
L_mx65:
  s_nop 15
  s_sub_u32 s58, 7, s52
  s_lshr_b32 s58, s58, 3
  s_or_b32 s58, s58, s53
  s_cbranch_scc0 L_mx66
  ds_read_b128 a[40:43], v211 offset:0
  ds_read_b128 a[44:47], v211 offset:1040
  v_sub_f32 v176, v240, v48
  v_sub_f32 v177, v241, v48
  v_sub_f32 v178, v242, v48
  v_sub_f32 v179, v243, v48
  v_sub_f32 v180, v244, v48
  v_sub_f32 v181, v245, v48
  v_sub_f32 v182, v246, v48
  v_sub_f32 v183, v247, v48
  v_sub_f32 v184, v248, v48
  v_sub_f32 v185, v249, v48
  v_sub_f32 v186, v250, v48
  v_sub_f32 v187, v251, v48
  v_sub_f32 v188, v252, v48
  v_sub_f32 v189, v253, v48
  v_sub_f32 v190, v254, v48
  v_sub_f32 v191, v255, v48
  s_nop 1
  v_mfma_f32_32x32x16_bf16 v[64:79], a[0:3], v[40:43], v[176:191]
  s_nop 11
  v_exp_f32 v64, v64
  v_exp_f32 v65, v65
  v_exp_f32 v66, v66
  v_exp_f32 v67, v67
  v_exp_f32 v68, v68
  v_exp_f32 v69, v69
  v_exp_f32 v70, v70
  v_exp_f32 v71, v71
  v_exp_f32 v72, v72
  v_exp_f32 v73, v73
  v_exp_f32 v74, v74
  v_exp_f32 v75, v75
  v_exp_f32 v76, v76
  v_exp_f32 v77, v77
  v_exp_f32 v78, v78
  v_exp_f32 v79, v79
  v_cvt_pk_bf16_f32 v64, v64, v65
  v_cvt_pk_bf16_f32 v65, v66, v67
  v_cvt_pk_bf16_f32 v66, v68, v69
  v_cvt_pk_bf16_f32 v67, v70, v71
  v_cvt_pk_bf16_f32 v68, v72, v73
  v_cvt_pk_bf16_f32 v69, v74, v75
  v_cvt_pk_bf16_f32 v70, v76, v77
  v_cvt_pk_bf16_f32 v71, v78, v79
  s_waitcnt lgkmcnt(1)
  v_mfma_f32_32x32x16_bf16 v[128:143], a[40:43], v[64:67], v[128:143]
  s_waitcnt lgkmcnt(0)
  v_mfma_f32_32x32x16_bf16 v[128:143], a[44:47], v[68:71], v[128:143]
L_mx66:
  s_nop 15
  v_rcp_f32 v136, v136
  s_nop 0
  v_mul_f32 v128, v128, v136
  v_mul_f32 v129, v129, v136
  v_mul_f32 v130, v130, v136
  v_mul_f32 v131, v131, v136
  v_mul_f32 v132, v132, v136
  v_mul_f32 v133, v133, v136
  v_mul_f32 v134, v134, v136
  v_mul_f32 v135, v135, v136
  v_cvt_pk_bf16_f32 v128, v128, v129
  v_cvt_pk_bf16_f32 v129, v130, v131
  v_cvt_pk_bf16_f32 v130, v132, v133
  v_cvt_pk_bf16_f32 v131, v134, v135
  buffer_store_dwordx4 v[128:131], v219, s[36:39], 0 offen offset:0 sc1
  ds_read_b128 a[0:3], v203 offset:16384
  ds_read_b128 a[4:7], v203 offset:17408
  ds_read_b128 a[8:11], v203 offset:18432
  ds_read_b128 a[12:15], v203 offset:19456
  ds_read_b128 a[16:19], v203 offset:20480
  ds_read_b128 a[20:23], v203 offset:21504
  ds_read_b128 a[24:27], v203 offset:22528
  ds_read_b128 a[28:31], v203 offset:23552
  ds_read_b128 a[32:35], v203 offset:24576
  s_waitcnt lgkmcnt(8)
  v_mfma_f32_32x32x16_bf16 v[64:79], a[0:3], v[44:47], v[240:255]
  s_waitcnt lgkmcnt(7)
  v_mfma_f32_32x32x16_bf16 v[80:95], a[4:7], v[44:47], 0
  v_mov_b32 v48, 0xf149f2ca
  s_sub_u32 s58, 7, s52
  s_lshr_b32 s58, s58, 3
  s_or_b32 s58, s58, s53
  s_cbranch_scc0 L_mx67
  s_nop 4
  v_max3_f32 v48, v48, v64, v65
  v_max3_f32 v48, v48, v66, v67
  v_max3_f32 v48, v48, v68, v69
  v_max3_f32 v48, v48, v70, v71
  v_max3_f32 v48, v48, v72, v73
  v_max3_f32 v48, v48, v74, v75
  v_max3_f32 v48, v48, v76, v77
  v_max3_f32 v48, v48, v78, v79
L_mx67:
  s_waitcnt lgkmcnt(6)
  v_mfma_f32_32x32x16_bf16 v[64:79], a[8:11], v[44:47], 0
  s_sub_u32 s58, 8, s52
  s_lshr_b32 s58, s58, 3
  s_or_b32 s58, s58, s53
  s_cbranch_scc0 L_mx68
  v_max3_f32 v48, v48, v80, v81
  v_max3_f32 v48, v48, v82, v83
  v_max3_f32 v48, v48, v84, v85
  v_max3_f32 v48, v48, v86, v87
  v_max3_f32 v48, v48, v88, v89
  v_max3_f32 v48, v48, v90, v91
  v_max3_f32 v48, v48, v92, v93
  v_max3_f32 v48, v48, v94, v95
L_mx68:
  s_waitcnt lgkmcnt(5)
  v_mfma_f32_32x32x16_bf16 v[80:95], a[12:15], v[44:47], 0
  s_sub_u32 s58, 9, s52
  s_lshr_b32 s58, s58, 3
  s_or_b32 s58, s58, s53
  s_cbranch_scc0 L_mx69
  v_max3_f32 v48, v48, v64, v65
  v_max3_f32 v48, v48, v66, v67
  v_max3_f32 v48, v48, v68, v69
  v_max3_f32 v48, v48, v70, v71
  v_max3_f32 v48, v48, v72, v73
  v_max3_f32 v48, v48, v74, v75
  v_max3_f32 v48, v48, v76, v77
  v_max3_f32 v48, v48, v78, v79
L_mx69:
  s_waitcnt lgkmcnt(4)
  v_mfma_f32_32x32x16_bf16 v[64:79], a[16:19], v[44:47], 0
  s_sub_u32 s58, 10, s52
  s_lshr_b32 s58, s58, 3
  s_or_b32 s58, s58, s53
  s_cbranch_scc0 L_mx70
  v_max3_f32 v48, v48, v80, v81
  v_max3_f32 v48, v48, v82, v83
  v_max3_f32 v48, v48, v84, v85
  v_max3_f32 v48, v48, v86, v87
  v_max3_f32 v48, v48, v88, v89
  v_max3_f32 v48, v48, v90, v91
  v_max3_f32 v48, v48, v92, v93
  v_max3_f32 v48, v48, v94, v95
L_mx70:
  s_waitcnt lgkmcnt(3)
  v_mfma_f32_32x32x16_bf16 v[80:95], a[20:23], v[44:47], 0
  s_sub_u32 s58, 11, s52
  s_lshr_b32 s58, s58, 3
  s_or_b32 s58, s58, s53
  s_cbranch_scc0 L_mx71
  v_max3_f32 v48, v48, v64, v65
  v_max3_f32 v48, v48, v66, v67
  v_max3_f32 v48, v48, v68, v69
  v_max3_f32 v48, v48, v70, v71
  v_max3_f32 v48, v48, v72, v73
  v_max3_f32 v48, v48, v74, v75
  v_max3_f32 v48, v48, v76, v77
  v_max3_f32 v48, v48, v78, v79
L_mx71:
  s_waitcnt lgkmcnt(2)
  v_mfma_f32_32x32x16_bf16 v[64:79], a[24:27], v[44:47], 0
  s_sub_u32 s58, 12, s52
  s_lshr_b32 s58, s58, 3
  s_or_b32 s58, s58, s53
  s_cbranch_scc0 L_mx72
  v_max3_f32 v48, v48, v80, v81
  v_max3_f32 v48, v48, v82, v83
  v_max3_f32 v48, v48, v84, v85
  v_max3_f32 v48, v48, v86, v87
  v_max3_f32 v48, v48, v88, v89
  v_max3_f32 v48, v48, v90, v91
  v_max3_f32 v48, v48, v92, v93
  v_max3_f32 v48, v48, v94, v95
L_mx72:
  s_waitcnt lgkmcnt(1)
  v_mfma_f32_32x32x16_bf16 v[80:95], a[28:31], v[44:47], 0
  s_sub_u32 s58, 13, s52
  s_lshr_b32 s58, s58, 3
  s_or_b32 s58, s58, s53
  s_cbranch_scc0 L_mx73
  v_max3_f32 v48, v48, v64, v65
  v_max3_f32 v48, v48, v66, v67
  v_max3_f32 v48, v48, v68, v69
  v_max3_f32 v48, v48, v70, v71
  v_max3_f32 v48, v48, v72, v73
  v_max3_f32 v48, v48, v74, v75
  v_max3_f32 v48, v48, v76, v77
  v_max3_f32 v48, v48, v78, v79
L_mx73:
  s_waitcnt lgkmcnt(0)
  v_mfma_f32_32x32x16_bf16 v[64:79], a[32:35], v[44:47], v[224:239]
  s_sub_u32 s58, 14, s52
  s_lshr_b32 s58, s58, 3
  s_or_b32 s58, s58, s53
  s_cbranch_scc0 L_mx74
  v_max3_f32 v48, v48, v80, v81
  v_max3_f32 v48, v48, v82, v83
  v_max3_f32 v48, v48, v84, v85
  v_max3_f32 v48, v48, v86, v87
  v_max3_f32 v48, v48, v88, v89
  v_max3_f32 v48, v48, v90, v91
  v_max3_f32 v48, v48, v92, v93
  v_max3_f32 v48, v48, v94, v95
L_mx74:
  v_max3_f32 v48, v48, v64, v65
  v_max3_f32 v48, v48, v66, v67
  v_max3_f32 v48, v48, v68, v69
  v_max3_f32 v48, v48, v70, v71
  v_max3_f32 v48, v48, v72, v73
  v_max3_f32 v48, v48, v74, v75
  v_max3_f32 v48, v48, v76, v77
  v_max3_f32 v48, v48, v78, v79
  v_mov_b32 v49, v48
  s_nop 1
  v_permlane32_swap_b32 v48, v49
  v_max_f32 v48, v48, v49
  v_sub_f32 v160, 0, v48
  v_sub_f32 v161, 0, v48
  v_sub_f32 v162, 0, v48
  v_sub_f32 v163, 0, v48
  v_sub_f32 v164, 0, v48
  v_sub_f32 v165, 0, v48
  v_sub_f32 v166, 0, v48
  v_sub_f32 v167, 0, v48
  v_sub_f32 v168, 0, v48
  v_sub_f32 v169, 0, v48
  v_sub_f32 v170, 0, v48
  v_sub_f32 v171, 0, v48
  v_sub_f32 v172, 0, v48
  v_sub_f32 v173, 0, v48
  v_sub_f32 v174, 0, v48
  v_sub_f32 v175, 0, v48
  ds_read_b128 a[40:43], v213 offset:16640
  ds_read_b128 a[44:47], v213 offset:17680
  v_sub_f32 v176, v224, v48
  v_sub_f32 v177, v225, v48
  v_sub_f32 v178, v226, v48
  v_sub_f32 v179, v227, v48
  v_sub_f32 v180, v228, v48
  v_sub_f32 v181, v229, v48
  v_sub_f32 v182, v230, v48
  v_sub_f32 v183, v231, v48
  v_sub_f32 v184, v232, v48
  v_sub_f32 v185, v233, v48
  v_sub_f32 v186, v234, v48
  v_sub_f32 v187, v235, v48
  v_sub_f32 v188, v236, v48
  v_sub_f32 v189, v237, v48
  v_sub_f32 v190, v238, v48
  v_sub_f32 v191, v239, v48
  s_nop 1
  v_mfma_f32_32x32x16_bf16 v[64:79], a[32:35], v[44:47], v[176:191]
  s_nop 11
  v_exp_f32 v64, v64
  v_exp_f32 v65, v65
  v_exp_f32 v66, v66
  v_exp_f32 v67, v67
  v_exp_f32 v68, v68
  v_exp_f32 v69, v69
  v_exp_f32 v70, v70
  v_exp_f32 v71, v71
  v_exp_f32 v72, v72
  v_exp_f32 v73, v73
  v_exp_f32 v74, v74
  v_exp_f32 v75, v75
  v_exp_f32 v76, v76
  v_exp_f32 v77, v77
  v_exp_f32 v78, v78
  v_exp_f32 v79, v79
  v_cvt_pk_bf16_f32 v64, v64, v65
  v_cvt_pk_bf16_f32 v65, v66, v67
  v_cvt_pk_bf16_f32 v66, v68, v69
  v_cvt_pk_bf16_f32 v67, v70, v71
  v_cvt_pk_bf16_f32 v68, v72, v73
  v_cvt_pk_bf16_f32 v69, v74, v75
  v_cvt_pk_bf16_f32 v70, v76, v77
  v_cvt_pk_bf16_f32 v71, v78, v79
  s_waitcnt lgkmcnt(1)
  v_mfma_f32_32x32x16_bf16 v[144:159], a[40:43], v[64:67], 0
  s_waitcnt lgkmcnt(0)
  v_mfma_f32_32x32x16_bf16 v[144:159], a[44:47], v[68:71], v[144:159]
  s_sub_u32 s58, 14, s52
  s_lshr_b32 s58, s58, 3
  s_or_b32 s58, s58, s53
  s_cbranch_scc0 L_mx75
  ds_read_b128 a[48:51], v213 offset:14560
  ds_read_b128 a[52:55], v213 offset:15600
  v_mfma_f32_32x32x16_bf16 v[80:95], a[28:31], v[44:47], v[160:175]
  s_nop 11
  v_exp_f32 v80, v80
  v_exp_f32 v81, v81
  v_exp_f32 v82, v82
  v_exp_f32 v83, v83
  v_exp_f32 v84, v84
  v_exp_f32 v85, v85
  v_exp_f32 v86, v86
  v_exp_f32 v87, v87
  v_exp_f32 v88, v88
  v_exp_f32 v89, v89
  v_exp_f32 v90, v90
  v_exp_f32 v91, v91
  v_exp_f32 v92, v92
  v_exp_f32 v93, v93
  v_exp_f32 v94, v94
  v_exp_f32 v95, v95
  v_cvt_pk_bf16_f32 v80, v80, v81
  v_cvt_pk_bf16_f32 v81, v82, v83
  v_cvt_pk_bf16_f32 v82, v84, v85
  v_cvt_pk_bf16_f32 v83, v86, v87
  v_cvt_pk_bf16_f32 v84, v88, v89
  v_cvt_pk_bf16_f32 v85, v90, v91
  v_cvt_pk_bf16_f32 v86, v92, v93
  v_cvt_pk_bf16_f32 v87, v94, v95
  s_waitcnt lgkmcnt(1)
  v_mfma_f32_32x32x16_bf16 v[144:159], a[48:51], v[80:83], v[144:159]
  s_waitcnt lgkmcnt(0)
  v_mfma_f32_32x32x16_bf16 v[144:159], a[52:55], v[84:87], v[144:159]
L_mx75:
  s_nop 15
  s_sub_u32 s58, 13, s52
  s_lshr_b32 s58, s58, 3
  s_or_b32 s58, s58, s53
  s_cbranch_scc0 L_mx76
  ds_read_b128 a[40:43], v213 offset:12480
  ds_read_b128 a[44:47], v213 offset:13520
  v_mfma_f32_32x32x16_bf16 v[64:79], a[24:27], v[44:47], v[160:175]
  s_nop 11
  v_exp_f32 v64, v64
  v_exp_f32 v65, v65
  v_exp_f32 v66, v66
  v_exp_f32 v67, v67
  v_exp_f32 v68, v68
  v_exp_f32 v69, v69
  v_exp_f32 v70, v70
  v_exp_f32 v71, v71
  v_exp_f32 v72, v72
  v_exp_f32 v73, v73
  v_exp_f32 v74, v74
  v_exp_f32 v75, v75
  v_exp_f32 v76, v76
  v_exp_f32 v77, v77
  v_exp_f32 v78, v78
  v_exp_f32 v79, v79
  v_cvt_pk_bf16_f32 v64, v64, v65
  v_cvt_pk_bf16_f32 v65, v66, v67
  v_cvt_pk_bf16_f32 v66, v68, v69
  v_cvt_pk_bf16_f32 v67, v70, v71
  v_cvt_pk_bf16_f32 v68, v72, v73
  v_cvt_pk_bf16_f32 v69, v74, v75
  v_cvt_pk_bf16_f32 v70, v76, v77
  v_cvt_pk_bf16_f32 v71, v78, v79
  s_waitcnt lgkmcnt(1)
  v_mfma_f32_32x32x16_bf16 v[144:159], a[40:43], v[64:67], v[144:159]
  s_waitcnt lgkmcnt(0)
  v_mfma_f32_32x32x16_bf16 v[144:159], a[44:47], v[68:71], v[144:159]
L_mx76:
  s_nop 15
  s_sub_u32 s58, 12, s52
  s_lshr_b32 s58, s58, 3
  s_or_b32 s58, s58, s53
  s_cbranch_scc0 L_mx77
  ds_read_b128 a[48:51], v213 offset:10400
  ds_read_b128 a[52:55], v213 offset:11440
  v_mfma_f32_32x32x16_bf16 v[80:95], a[20:23], v[44:47], v[160:175]
  s_nop 11
  v_exp_f32 v80, v80
  v_exp_f32 v81, v81
  v_exp_f32 v82, v82
  v_exp_f32 v83, v83
  v_exp_f32 v84, v84
  v_exp_f32 v85, v85
  v_exp_f32 v86, v86
  v_exp_f32 v87, v87
  v_exp_f32 v88, v88
  v_exp_f32 v89, v89
  v_exp_f32 v90, v90
  v_exp_f32 v91, v91
  v_exp_f32 v92, v92
  v_exp_f32 v93, v93
  v_exp_f32 v94, v94
  v_exp_f32 v95, v95
  v_cvt_pk_bf16_f32 v80, v80, v81
  v_cvt_pk_bf16_f32 v81, v82, v83
  v_cvt_pk_bf16_f32 v82, v84, v85
  v_cvt_pk_bf16_f32 v83, v86, v87
  v_cvt_pk_bf16_f32 v84, v88, v89
  v_cvt_pk_bf16_f32 v85, v90, v91
  v_cvt_pk_bf16_f32 v86, v92, v93
  v_cvt_pk_bf16_f32 v87, v94, v95
  s_waitcnt lgkmcnt(1)
  v_mfma_f32_32x32x16_bf16 v[144:159], a[48:51], v[80:83], v[144:159]
  s_waitcnt lgkmcnt(0)
  v_mfma_f32_32x32x16_bf16 v[144:159], a[52:55], v[84:87], v[144:159]
L_mx77:
  s_nop 15
  s_sub_u32 s58, 11, s52
  s_lshr_b32 s58, s58, 3
  s_or_b32 s58, s58, s53
  s_cbranch_scc0 L_mx78
  ds_read_b128 a[40:43], v213 offset:8320
  ds_read_b128 a[44:47], v213 offset:9360
  v_mfma_f32_32x32x16_bf16 v[64:79], a[16:19], v[44:47], v[160:175]
  s_nop 11
  v_exp_f32 v64, v64
  v_exp_f32 v65, v65
  v_exp_f32 v66, v66
  v_exp_f32 v67, v67
  v_exp_f32 v68, v68
  v_exp_f32 v69, v69
  v_exp_f32 v70, v70
  v_exp_f32 v71, v71
  v_exp_f32 v72, v72
  v_exp_f32 v73, v73
  v_exp_f32 v74, v74
  v_exp_f32 v75, v75
  v_exp_f32 v76, v76
  v_exp_f32 v77, v77
  v_exp_f32 v78, v78
  v_exp_f32 v79, v79
  v_cvt_pk_bf16_f32 v64, v64, v65
  v_cvt_pk_bf16_f32 v65, v66, v67
  v_cvt_pk_bf16_f32 v66, v68, v69
  v_cvt_pk_bf16_f32 v67, v70, v71
  v_cvt_pk_bf16_f32 v68, v72, v73
  v_cvt_pk_bf16_f32 v69, v74, v75
  v_cvt_pk_bf16_f32 v70, v76, v77
  v_cvt_pk_bf16_f32 v71, v78, v79
  s_waitcnt lgkmcnt(1)
  v_mfma_f32_32x32x16_bf16 v[144:159], a[40:43], v[64:67], v[144:159]
  s_waitcnt lgkmcnt(0)
  v_mfma_f32_32x32x16_bf16 v[144:159], a[44:47], v[68:71], v[144:159]
L_mx78:
  s_nop 15
  s_sub_u32 s58, 10, s52
  s_lshr_b32 s58, s58, 3
  s_or_b32 s58, s58, s53
  s_cbranch_scc0 L_mx79
  ds_read_b128 a[48:51], v213 offset:6240
  ds_read_b128 a[52:55], v213 offset:7280
  v_mfma_f32_32x32x16_bf16 v[80:95], a[12:15], v[44:47], v[160:175]
  s_nop 11
  v_exp_f32 v80, v80
  v_exp_f32 v81, v81
  v_exp_f32 v82, v82
  v_exp_f32 v83, v83
  v_exp_f32 v84, v84
  v_exp_f32 v85, v85
  v_exp_f32 v86, v86
  v_exp_f32 v87, v87
  v_exp_f32 v88, v88
  v_exp_f32 v89, v89
  v_exp_f32 v90, v90
  v_exp_f32 v91, v91
  v_exp_f32 v92, v92
  v_exp_f32 v93, v93
  v_exp_f32 v94, v94
  v_exp_f32 v95, v95
  v_cvt_pk_bf16_f32 v80, v80, v81
  v_cvt_pk_bf16_f32 v81, v82, v83
  v_cvt_pk_bf16_f32 v82, v84, v85
  v_cvt_pk_bf16_f32 v83, v86, v87
  v_cvt_pk_bf16_f32 v84, v88, v89
  v_cvt_pk_bf16_f32 v85, v90, v91
  v_cvt_pk_bf16_f32 v86, v92, v93
  v_cvt_pk_bf16_f32 v87, v94, v95
  s_waitcnt lgkmcnt(1)
  v_mfma_f32_32x32x16_bf16 v[144:159], a[48:51], v[80:83], v[144:159]
  s_waitcnt lgkmcnt(0)
  v_mfma_f32_32x32x16_bf16 v[144:159], a[52:55], v[84:87], v[144:159]
L_mx79:
  s_nop 15
  s_sub_u32 s58, 9, s52
  s_lshr_b32 s58, s58, 3
  s_or_b32 s58, s58, s53
  s_cbranch_scc0 L_mx80
  ds_read_b128 a[40:43], v213 offset:4160
  ds_read_b128 a[44:47], v213 offset:5200
  v_mfma_f32_32x32x16_bf16 v[64:79], a[8:11], v[44:47], v[160:175]
  s_nop 11
  v_exp_f32 v64, v64
  v_exp_f32 v65, v65
  v_exp_f32 v66, v66
  v_exp_f32 v67, v67
  v_exp_f32 v68, v68
  v_exp_f32 v69, v69
  v_exp_f32 v70, v70
  v_exp_f32 v71, v71
  v_exp_f32 v72, v72
  v_exp_f32 v73, v73
  v_exp_f32 v74, v74
  v_exp_f32 v75, v75
  v_exp_f32 v76, v76
  v_exp_f32 v77, v77
  v_exp_f32 v78, v78
  v_exp_f32 v79, v79
  v_cvt_pk_bf16_f32 v64, v64, v65
  v_cvt_pk_bf16_f32 v65, v66, v67
  v_cvt_pk_bf16_f32 v66, v68, v69
  v_cvt_pk_bf16_f32 v67, v70, v71
  v_cvt_pk_bf16_f32 v68, v72, v73
  v_cvt_pk_bf16_f32 v69, v74, v75
  v_cvt_pk_bf16_f32 v70, v76, v77
  v_cvt_pk_bf16_f32 v71, v78, v79
  s_waitcnt lgkmcnt(1)
  v_mfma_f32_32x32x16_bf16 v[144:159], a[40:43], v[64:67], v[144:159]
  s_waitcnt lgkmcnt(0)
  v_mfma_f32_32x32x16_bf16 v[144:159], a[44:47], v[68:71], v[144:159]
L_mx80:
  s_nop 15
  s_sub_u32 s58, 8, s52
  s_lshr_b32 s58, s58, 3
  s_or_b32 s58, s58, s53
  s_cbranch_scc0 L_mx81
  ds_read_b128 a[48:51], v213 offset:2080
  ds_read_b128 a[52:55], v213 offset:3120
  v_mfma_f32_32x32x16_bf16 v[80:95], a[4:7], v[44:47], v[160:175]
  s_nop 11
  v_exp_f32 v80, v80
  v_exp_f32 v81, v81
  v_exp_f32 v82, v82
  v_exp_f32 v83, v83
  v_exp_f32 v84, v84
  v_exp_f32 v85, v85
  v_exp_f32 v86, v86
  v_exp_f32 v87, v87
  v_exp_f32 v88, v88
  v_exp_f32 v89, v89
  v_exp_f32 v90, v90
  v_exp_f32 v91, v91
  v_exp_f32 v92, v92
  v_exp_f32 v93, v93
  v_exp_f32 v94, v94
  v_exp_f32 v95, v95
  v_cvt_pk_bf16_f32 v80, v80, v81
  v_cvt_pk_bf16_f32 v81, v82, v83
  v_cvt_pk_bf16_f32 v82, v84, v85
  v_cvt_pk_bf16_f32 v83, v86, v87
  v_cvt_pk_bf16_f32 v84, v88, v89
  v_cvt_pk_bf16_f32 v85, v90, v91
  v_cvt_pk_bf16_f32 v86, v92, v93
  v_cvt_pk_bf16_f32 v87, v94, v95
  s_waitcnt lgkmcnt(1)
  v_mfma_f32_32x32x16_bf16 v[144:159], a[48:51], v[80:83], v[144:159]
  s_waitcnt lgkmcnt(0)
  v_mfma_f32_32x32x16_bf16 v[144:159], a[52:55], v[84:87], v[144:159]
L_mx81:
  s_nop 15
  s_sub_u32 s58, 7, s52
  s_lshr_b32 s58, s58, 3
  s_or_b32 s58, s58, s53
  s_cbranch_scc0 L_mx82
  ds_read_b128 a[40:43], v213 offset:0
  ds_read_b128 a[44:47], v213 offset:1040
  v_sub_f32 v176, v240, v48
  v_sub_f32 v177, v241, v48
  v_sub_f32 v178, v242, v48
  v_sub_f32 v179, v243, v48
  v_sub_f32 v180, v244, v48
  v_sub_f32 v181, v245, v48
  v_sub_f32 v182, v246, v48
  v_sub_f32 v183, v247, v48
  v_sub_f32 v184, v248, v48
  v_sub_f32 v185, v249, v48
  v_sub_f32 v186, v250, v48
  v_sub_f32 v187, v251, v48
  v_sub_f32 v188, v252, v48
  v_sub_f32 v189, v253, v48
  v_sub_f32 v190, v254, v48
  v_sub_f32 v191, v255, v48
  s_nop 1
  v_mfma_f32_32x32x16_bf16 v[64:79], a[0:3], v[44:47], v[176:191]
  s_nop 11
  v_exp_f32 v64, v64
  v_exp_f32 v65, v65
  v_exp_f32 v66, v66
  v_exp_f32 v67, v67
  v_exp_f32 v68, v68
  v_exp_f32 v69, v69
  v_exp_f32 v70, v70
  v_exp_f32 v71, v71
  v_exp_f32 v72, v72
  v_exp_f32 v73, v73
  v_exp_f32 v74, v74
  v_exp_f32 v75, v75
  v_exp_f32 v76, v76
  v_exp_f32 v77, v77
  v_exp_f32 v78, v78
  v_exp_f32 v79, v79
  v_cvt_pk_bf16_f32 v64, v64, v65
  v_cvt_pk_bf16_f32 v65, v66, v67
  v_cvt_pk_bf16_f32 v66, v68, v69
  v_cvt_pk_bf16_f32 v67, v70, v71
  v_cvt_pk_bf16_f32 v68, v72, v73
  v_cvt_pk_bf16_f32 v69, v74, v75
  v_cvt_pk_bf16_f32 v70, v76, v77
  v_cvt_pk_bf16_f32 v71, v78, v79
  s_waitcnt lgkmcnt(1)
  v_mfma_f32_32x32x16_bf16 v[144:159], a[40:43], v[64:67], v[144:159]
  s_waitcnt lgkmcnt(0)
  v_mfma_f32_32x32x16_bf16 v[144:159], a[44:47], v[68:71], v[144:159]
L_mx82:
  s_nop 15
  v_rcp_f32 v144, v144
  s_nop 0
  v_mul_f32 v152, v152, v144
  v_mul_f32 v153, v153, v144
  v_mul_f32 v154, v154, v144
  v_mul_f32 v155, v155, v144
  v_mul_f32 v156, v156, v144
  v_mul_f32 v157, v157, v144
  v_mul_f32 v158, v158, v144
  v_mul_f32 v159, v159, v144
  v_cvt_pk_bf16_f32 v152, v152, v153
  v_cvt_pk_bf16_f32 v153, v154, v155
  v_cvt_pk_bf16_f32 v154, v156, v157
  v_cvt_pk_bf16_f32 v155, v158, v159
  buffer_store_dwordx4 v[152:155], v219, s[36:39], 0 offen offset:1024 sc1
  s_waitcnt vmcnt(1)
  s_barrier
  s_mov_b32 s71, 12288
  buffer_store_dword v13, v14, s[36:39], s71 offen sc1
  v_readlane_b32 s84, v9, 0
  s_add_u32 m0, s81, 102400
  v_readlane_b32 s85, v9, 1
  s_nop 2
  buffer_load_dwordx4 v10, s[40:43], s84 offen lds
  buffer_load_dwordx4 v11, s[40:43], s84 offen offset:1024 lds
  s_add_u32 m0, s81, 110592
  v_readlane_b32 s86, v9, 2
  buffer_load_dwordx4 v10, s[40:43], s85 offen lds
  buffer_load_dwordx4 v11, s[40:43], s85 offen offset:1024 lds
  s_add_u32 m0, s81, 118784
  v_readlane_b32 s87, v9, 3
  s_nop 0
  buffer_load_dwordx4 v10, s[40:43], s86 offen lds
  buffer_load_dwordx4 v11, s[40:43], s86 offen offset:1024 lds
  s_add_u32 m0, s81, 126976
  v_readlane_b32 s84, v9, 4
  buffer_load_dwordx4 v10, s[40:43], s87 offen lds
  buffer_load_dwordx4 v11, s[40:43], s87 offen offset:1024 lds
  s_add_u32 m0, s81, 135168
  v_readlane_b32 s85, v9, 5
  s_nop 0
  buffer_load_dwordx4 v10, s[40:43], s84 offen lds
  buffer_load_dwordx4 v11, s[40:43], s84 offen offset:1024 lds
  s_add_u32 m0, s81, 143360
  v_readlane_b32 s86, v9, 6
  buffer_load_dwordx4 v10, s[40:43], s85 offen lds
  buffer_load_dwordx4 v11, s[40:43], s85 offen offset:1024 lds
  s_add_u32 m0, s81, 151552
  v_readlane_b32 s87, v9, 7
  s_nop 0
  buffer_load_dwordx4 v10, s[40:43], s86 offen lds
  buffer_load_dwordx4 v11, s[40:43], s86 offen offset:1024 lds
  s_cmp_lt_u32 s52, 2
  s_mov_b32 s82, 8192
  s_cselect_b32 s82, 8192, s82
  buffer_load_dword v25, v23, s[36:39], s82 offen sc1
  s_add_u32 m0, s81, 0
  v_readlane_b32 s84, v9, 8
  buffer_load_dwordx4 v10, s[40:43], s87 offen lds
  buffer_load_dwordx4 v11, s[40:43], s87 offen offset:1024 lds
  s_add_u32 m0, s81, 8192
  v_readlane_b32 s85, v9, 9
  s_nop 0
  buffer_load_dwordx4 v10, s[40:43], s84 offen lds
  buffer_load_dwordx4 v11, s[40:43], s84 offen offset:1024 lds
  s_add_u32 m0, s81, 16384
  v_readlane_b32 s86, v9, 10
  buffer_load_dwordx4 v10, s[40:43], s85 offen lds
  buffer_load_dwordx4 v11, s[40:43], s85 offen offset:1024 lds
  s_add_u32 m0, s81, 24576
  v_readlane_b32 s87, v9, 11
  s_nop 0
  buffer_load_dwordx4 v10, s[40:43], s86 offen lds
  buffer_load_dwordx4 v11, s[40:43], s86 offen offset:1024 lds
  s_waitcnt vmcnt(8)
  v_cmp_ne_u32 vcc, s56, v25
  s_nop 0
  s_cbranch_vccnz L_slow83
L_back83:
  v_readlane_b32 s88, v3, 0
  v_readlane_b32 s89, v3, 1
  v_readlane_b32 s90, v3, 2
  s_nop 2
  buffer_load_dwordx4 a[64:67], v15, s[36:39], s88 offen sc1
  v_readlane_b32 s91, v3, 3
  buffer_load_dwordx4 a[68:71], v15, s[36:39], s89 offen sc1
  v_readlane_b32 s88, v3, 4
  buffer_load_dwordx4 a[72:75], v15, s[36:39], s90 offen sc1
  v_readlane_b32 s89, v3, 5
  s_nop 0
  buffer_load_dwordx4 a[76:79], v15, s[36:39], s91 offen sc1
  v_readlane_b32 s90, v3, 6
  buffer_load_dwordx4 a[80:83], v15, s[36:39], s88 offen sc1
  v_readlane_b32 s91, v3, 7
  buffer_load_dwordx4 a[84:87], v15, s[36:39], s89 offen sc1
  v_readlane_b32 s88, v3, 8
  s_nop 0
  buffer_load_dwordx4 a[88:91], v15, s[36:39], s90 offen sc1
  v_readlane_b32 s89, v3, 9
  buffer_load_dwordx4 a[92:95], v15, s[36:39], s91 offen sc1
  v_readlane_b32 s90, v3, 10
  buffer_load_dwordx4 a[96:99], v15, s[36:39], s88 offen sc1
  v_readlane_b32 s91, v3, 11
  s_nop 0
  buffer_load_dwordx4 a[100:103], v15, s[36:39], s89 offen sc1
  v_readlane_b32 s88, v3, 12
  buffer_load_dwordx4 a[104:107], v15, s[36:39], s90 offen sc1
  v_readlane_b32 s89, v3, 13
  buffer_load_dwordx4 a[108:111], v15, s[36:39], s91 offen sc1
  v_readlane_b32 s90, v3, 14
  s_nop 0
  buffer_load_dwordx4 a[112:115], v15, s[36:39], s88 offen sc1
  v_readlane_b32 s91, v3, 15
  buffer_load_dwordx4 a[116:119], v15, s[36:39], s89 offen sc1
  v_readlane_b32 s88, v3, 16
  buffer_load_dwordx4 a[120:123], v15, s[36:39], s90 offen sc1
  v_readlane_b32 s89, v3, 17
  s_nop 0
  buffer_load_dwordx4 a[124:127], v15, s[36:39], s91 offen sc1
  s_cmp_lt_u32 s52, 2
  s_mov_b32 s82, 9216
  s_cselect_b32 s82, 9216, s82
  buffer_load_dword v25, v23, s[36:39], s82 offen sc1
  s_waitcnt vmcnt(0) lgkmcnt(0)
  s_nop 15
  s_branch L_attn_done
L_slow84:
  s_mov_b32 s83, 0x40000
L_spin84:
  buffer_load_dword v25, v23, s[36:39], s82 offen sc1
  s_waitcnt vmcnt(0)
  v_cmp_ne_u32 vcc, s56, v25
  s_cbranch_vccz L_back84
  s_sub_u32 s83, s83, 1
  s_cmp_lg_u32 s83, 0
  s_cbranch_scc1 L_spin84
  s_branch L_back84
L_slow85:
  s_mov_b32 s83, 0x40000
L_spin85:
  buffer_load_dword v25, v23, s[36:39], s82 offen sc1
  s_waitcnt vmcnt(0)
  v_cmp_ne_u32 vcc, s56, v25
  s_cbranch_vccz L_back85
  s_sub_u32 s83, s83, 1
  s_cmp_lg_u32 s83, 0
  s_cbranch_scc1 L_spin85
  s_branch L_back85
L_slow86:
  s_mov_b32 s83, 0x40000
L_spin86:
  buffer_load_dword v25, v23, s[36:39], s82 offen sc1
  s_waitcnt vmcnt(0)
  v_cmp_ne_u32 vcc, s56, v25
  s_cbranch_vccz L_back86
  s_sub_u32 s83, s83, 1
  s_cmp_lg_u32 s83, 0
  s_cbranch_scc1 L_spin86
  s_branch L_back86
L_slow87:
  s_mov_b32 s83, 0x40000
L_spin87:
  buffer_load_dword v25, v23, s[36:39], s82 offen sc1
  s_waitcnt vmcnt(0)
  v_cmp_ne_u32 vcc, s56, v25
  s_cbranch_vccz L_back87
  s_sub_u32 s83, s83, 1
  s_cmp_lg_u32 s83, 0
  s_cbranch_scc1 L_spin87
  s_branch L_back87
L_exit:
  s_endpgm
L_codeend:
.section .rodata,"a"
.p2align 6
.amdhsa_kernel recurrent_scan__sliding_block__glu_gated_glu__prompt_kernel
  .amdhsa_next_free_vgpr 512
  .amdhsa_next_free_sgpr 102
  .amdhsa_accum_offset 256
  .amdhsa_group_segment_fixed_size 0
  .amdhsa_kernarg_size 80
  .amdhsa_user_sgpr_count 2
  .amdhsa_user_sgpr_kernarg_segment_ptr 1
  .amdhsa_system_sgpr_workgroup_id_x 1
.end_amdhsa_kernel
```
